```python
import torch

def _softmax(x, axis=-1):
    return torch.softmax(x, dim=axis)
def _gelu(x):
    return torch.nn.functional.gelu(x, approximate="tanh")
def _silu(x):
    return torch.nn.functional.silu(x)
def _sigmoid(x):
    return torch.sigmoid(x)
def _layernorm(x, axis=-1, eps=1e-5):
    m = x.mean(dim=axis, keepdim=True)
    v = x.var(dim=axis, keepdim=True, unbiased=False)
    return (x - m) / torch.sqrt(v + eps)
def _scatter_add(tgt, idx, src, axis=0):
    return tgt.clone().index_add_(axis, idx, src)
def _segment_sum(src, seg, n):
    out = torch.zeros((n,) + src.shape[1:], dtype=src.dtype)
    return out.index_add_(0, seg, src)
def _pad(x, pw):
    flat = tuple(v for pair in reversed(pw) for v in pair)
    return torch.nn.functional.pad(x, flat)

kernel_name = 'recurrent_scan__spectral_fnet__mixer_s_mlp__prompt'

def setup_inputs():

    _w = (lambda a: (lambda t: t.to(torch.bfloat16) if t.is_floating_point() else t)(torch.as_tensor(a)))
    def _A_setup():
        B, S, D = 1, 2048, 512
        ns = torch.arange(S)[:, None] * torch.arange(S)[None, :]
        nd = torch.arange(D)[:, None] * torch.arange(D)[None, :]
        Ws_re = torch.cos(-2.0 * torch.pi * ns / S).to(float)
        Ws_im = torch.sin(-2.0 * torch.pi * ns / S).to(float)
        Wd_re = torch.cos(-2.0 * torch.pi * nd / D).to(float)
        Wd_im = torch.sin(-2.0 * torch.pi * nd / D).to(float)
        return {
            "x": _w((lambda *s: torch.randn(*s, dtype=torch.bfloat16) * 0.05)(B, S, D)),
            "dft_seq_re": _w(Ws_re),
            "dft_seq_im": _w(Ws_im),
            "dft_hid_re": _w(Wd_re),
            "dft_hid_im": _w(Wd_im),
        }
    _A_in = _A_setup()

    def _B_setup():
        B, S, D, F = 1, 2048, 512, 1792
        return {
            "x":  _w((lambda *s: torch.randn(*s, dtype=torch.bfloat16) * 0.05)(B, S, D)),
            "w1": _w((lambda *s: torch.randn(*s, dtype=torch.bfloat16) * 3.2)(D, D) * (D ** -0.5)),
            "w2": _w((lambda *s: torch.randn(*s, dtype=torch.bfloat16) * 3.2)(D, D) * (D ** -0.5)),
            "w3": _w((lambda *s: torch.randn(*s, dtype=torch.bfloat16) * 3.2)(D, F) * (D ** -0.5)),
            "w4": _w((lambda *s: torch.randn(*s, dtype=torch.bfloat16) * 1.6)(F, D) * (F ** -0.5)),
        }
    _B_in = _B_setup()

    return {
        "A_x": _A_in["x"],
        "A_dft_seq_re": _A_in["dft_seq_re"],
        "A_dft_seq_im": _A_in["dft_seq_im"],
        "A_dft_hid_re": _A_in["dft_hid_re"],
        "A_dft_hid_im": _A_in["dft_hid_im"],
        "B_x": _B_in["x"],
        "B_w1": _B_in["w1"],
        "B_w2": _B_in["w2"],
        "B_w3": _B_in["w3"],
        "B_w4": _B_in["w4"],
    }

def reference(A_x, A_dft_seq_re, A_dft_seq_im, A_dft_hid_re, A_dft_hid_im, B_x, B_w1, B_w2, B_w3, B_w4):
    def _A_ref(x, dft_seq_re, dft_seq_im, dft_hid_re, dft_hid_im):
        a = torch.einsum("bsd,ed->bse", x, dft_hid_re)
        b = torch.einsum("bsd,ed->bse", x, dft_hid_im)
        y = torch.einsum("ts,bse->bte", dft_seq_re, a) - torch.einsum("ts,bse->bte", dft_seq_im, b)
        return y

    def _B_ref(x, w1, w2, w3, w4):
        B, S, D = x.shape
        h = _gelu(_layernorm(x, axis=-1) @ w1)
        c = D // 4
        g0 = _pad(h[:, :, 0*c:1*c], ((0, 0), (1, 0), (0, 0)))[:, :S, :]
        g1 = _pad(h[:, :, 1*c:2*c], ((0, 0), (0, 1), (0, 0)))[:, 1:, :]
        g2 = _pad(h[:, :, 2*c:3*c], ((0, 0), (2, 0), (0, 0)))[:, :S, :]
        g3 = _pad(h[:, :, 3*c:   ], ((0, 0), (0, 2), (0, 0)))[:, 2:, :]
        hs = torch.concatenate([g0, g1, g2, g3], axis=-1) @ w2
        x1 = x + hs
        h2 = _gelu(_layernorm(x1, axis=-1) @ w3) @ w4
        return x1 + h2

    x = A_x
    xn = _layernorm(x, axis=-1)
    s = _A_ref(xn, A_dft_seq_re, A_dft_seq_im, A_dft_hid_re, A_dft_hid_im)
    g = _silu(_B_ref(xn, B_w1, B_w2, B_w3, B_w4))
    return x + s * g
```

```asm
; @launch grid=(256,1,1) block=(256,1,1) lds=163840
.amdgcn_target "amdgcn-amd-amdhsa--gfx950"
.text
.globl recurrent_scan__spectral_fnet__mixer_s_mlp__prompt_kernel
.p2align 8
.type recurrent_scan__spectral_fnet__mixer_s_mlp__prompt_kernel,@function
recurrent_scan__spectral_fnet__mixer_s_mlp__prompt_kernel:
    s_load_dwordx2 s[4:5], s[0:1], 0
    s_load_dwordx2 s[8:9], s[0:1], 48
    s_load_dwordx2 s[28:29], s[0:1], 96
    s_load_dwordx2 s[12:13], s[0:1], 56
    s_cmp_ge_u32 s2, 256
    s_cbranch_scc1 Lend
    s_getpc_b64 s[42:43]
Lpc:
    s_lshr_b32 s44, s2, 3
    v_lshrrev_b32 v41, 4, v0
    v_lshl_add_u32 v41, v41, 5, s44
    v_lshlrev_b32_e64 v41, 7, v41
    v_min_u32 v2, Lfin-Lpc, v41
    v_mov_b32_e64 v3, 0
    v_lshl_add_u64 v[2:3], v[2:3], 0, s[42:43]
    global_load_dword v1, v[2:3], off
    v_lshrrev_b32 v41, 6, v0
    v_and_b32 v0, 63, v0
    v_readfirstlane_b32 s38, v41
    s_and_b32 s41, s2, 7
    s_bfe_u32 s45, s2, 0x10006
    s_lshl1_add_u32 s36, s41, s45
    s_sub_u32 s41, 32, s36
    s_cmp_eq_u32 s36, 0
    s_cselect_b32 s41, 16, s41
    s_bitcmp1_b32 s2, 7
    s_cselect_b32 s36, s41, s36
    s_bfm_b32 s6, 1, 21
    s_mov_b32 s7, 0x20000
    v_lshrrev_b32 v45, 3, v0
    v_and_b32 v46, 7, v0
    v_lshrrev_b32 v50, 4, v0
    v_xor_b32 v41, v50, v46
    v_lshlrev_b32 v41, 4, v41
    v_lshl_add_u32 v68, v45, 16, v41
    s_lshr_b32 s63, s38, 1
    s_and_b32 s3, s38, 1
    s_lshl_b32 s41, s3, 5
    s_add_u32 s41, s41, s63
    s_lshl_b32 s41, s41, 5
    s_add_u32 s41, s41, s36
    s_lshl_b32 s55, s41, 10
    s_lshl_b32 s52, s38, 14
    v_xor_b32_e64 v69, 64, v68
    v_add_u32 v69, 523264, v69
    s_and_b32 s37, s44, 7
    s_add_u32 m0, s52, 0
    s_lshl_b32 s58, s37, 7
    s_or_b32 s58, s58, s55
    s_lshl2_add_u32 s39, s2, s38
    s_and_b32 s41, s39, 0x3e3
    s_waitcnt lgkmcnt(0)
    s_cbranch_scc0 Linit1
Lnoinit:
    buffer_load_dwordx4 v68, s[4:7], s58 offen offset:0  lds
    s_load_dword s101, s[8:9], 192
    s_load_dword s101, s[12:13], 192
    buffer_load_dwordx4 v69, s[4:7], s58 offen offset:1024  lds
    v_and_b32 v41, 2, v45
    v_lshlrev_b32_e64 v41, 1, v41
    s_add_u32 m0, s52, 8192
    s_xor_b32 s58, s58, 512
    buffer_load_dwordx4 v68, s[4:7], s58 offen offset:0  lds
    v_xor_b32_e64 v41, v41, v46
    buffer_load_dwordx4 v69, s[4:7], s58 offen offset:1024  lds
    v_lshlrev_b32_e64 v51, 4, v41
    v_lshl_add_u32 v28, v45, 10, v51
    v_add_u32 v29, 7168, v28
    s_lshl_b32 s50, s37, 7
    s_add_u32 s49, s50, s52
    s_lshl_b32 s53, s38, 11
    s_mov_b32 s10, 524288
    s_mov_b32 s11, 0x20000
    s_xor_b32 s49, s49, 128
    s_add_u32 m0, s53, 65536
    s_lshl_b32 s58, s37, 16
    s_or_b32 s58, s58, s49
    buffer_load_dwordx4 v28, s[8:11], s58 offen offset:0 lds
    s_xor_b32 s40, s63, s3
    s_lshl2_add_u32 s45, s44, s38
    s_mov_b32 s14, 524288
    buffer_load_dwordx4 v29, s[8:11], s58 offen offset:1024 lds
    s_mov_b32 s15, 0x20000
    s_mul_i32 s41, s39, 4
    s_mul_i32 s42, s45, 4
    v_and_b32 v41, 31, v0
    v_add_lshl_u32 v42, v41, s41, 7
    v_add_lshl_u32 v43, v41, s42, 10
    s_add_u32 m0, s53, 73728
    s_xor_b32 s58, s58, 0x40000
    buffer_load_dwordx4 v28, s[8:11], s58 offen offset:0 lds
    v_cmp_gt_u32 vcc, 32, v0
    v_or_b32 v43, 384, v43
    s_nop 0
    v_cndmask_b32 v42, v43, v42, vcc
    buffer_load_dwordx4 v29, s[8:11], s58 offen offset:1024 lds
    v_cmp_gt_u32 vcc, 4, v41
    v_mov_b32_e64 v43, 1073741824
    s_nop 0
    v_cndmask_b32 v2, v43, v42, vcc
    buffer_load_dword v1, v2, s[8:11], 0 offen
    s_add_u32 m0, s52, 2048
    s_add_u32 s47, s37, 1
    s_and_b32 s47, s47, 7
    s_lshl_b32 s58, s47, 7
    s_or_b32 s58, s58, s55
    buffer_load_dwordx4 v68, s[4:7], s58 offen offset:0  lds
    buffer_load_dword v1, v2, s[12:15], 0 offen
    buffer_load_dwordx4 v69, s[4:7], s58 offen offset:1024  lds
    s_load_dwordx2 s[16:17], s[0:1], 64
    s_load_dwordx2 s[20:21], s[0:1], 72
    s_load_dwordx2 s[24:25], s[0:1], 80
    s_load_dwordx2 s[32:33], s[0:1], 88
    v_and_b32 v49, 15, v0
    v_lshrrev_b32 v47, 5, v0
    v_and_b32_e64 v48, 31, v0
    s_mov_b32 s60, 0x3b000000
    s_mov_b32 s61, 0x3f803f80
    s_lshl_b32 s59, s38, 17
    s_add_u32 s59, s59, s50
    v_bfe_u32 v42, v0, 4, 1
    v_lshrrev_b32 v41, 1, v49
    v_lshlrev_b32 v41, 4, v41
    v_lshl_add_u32 v41, v49, 7, v41
    v_lshl_add_u32 v41, v42, 14, v41
    s_lshl_b32 s41, s63, 15
    s_lshl_b32 s42, s40, 13
    s_add_u32 s43, s41, s42
    v_lshl_add_u32 v43, v47, 4, s43
    v_xor_b32 v132, v43, v41
    v_xor_b32 v133, 32, v132
    v_xor_b32 v134, 64, v132
    v_xor_b32 v135, 96, v132
    v_xor_b32 v136, 8192, v132
    v_xor_b32 v137, 8224, v132
    v_xor_b32 v138, 8256, v132
    v_xor_b32 v139, 8288, v132
    v_mov_b32 v146, 0
    v_mov_b32 v147, 0
    s_lshl_b32 s43, s3, 6
    s_add_u32 s41, s41, s43
    v_lshl_add_u32 v43, v47, 3, s41
    v_xor_b32 v92, v43, v41
    v_xor_b32 v94, 16, v92
    v_xor_b32 v96, 32, v92
    v_xor_b32 v98, 48, v92
    v_bfe_u32 v41, v0, 3, 1
    v_lshlrev_b32_e64 v41, 6, v41
    v_lshl_add_u32 v41, v42, 5, v41
    v_and_b32_e64 v43, 3, v0
    v_lshl_add_u32 v41, v43, 3, v41
    v_bfe_u32 v43, v0, 2, 2
    v_lshl_add_u32 v41, v43, 7, v41
    v_lshl_add_u32 v24, v47, 9, v41
    v_xor_b32_e64 v88, s43, v24
    s_add_u32 s41, s42, 65536
    v_lshl_add_u32 v43, v47, 9, v88
    v_add_u32_e64 v140, s41, v43
    v_xor_b32 v141, 0x2000, v140
    v_bfe_u32 v41, v0, 2, 1
    v_cmp_eq_u32 vcc, v41, v42
    v_mov_b32 v43, s61
    v_mov_b32 v21, 0
    v_cndmask_b32 v52, 0, v43, vcc
    v_mov_b32 v53, v52
    v_mov_b32 v54, v52
    v_mov_b32 v55, v52
    s_waitcnt lgkmcnt(0)
    s_mul_i32 s41, s39, 14
    v_min_u32 v41, 13, v0
    v_add_lshl_u32 v3, v41, s41, 7
    s_mul_i32 s41, s2, 7
    s_xor_b32 s42, s38, 3
    s_lshl_b32 s42, s42, 12
    s_add_u32 s41, s41, s42
    v_min_u32 v41, 6, v45
    v_add_lshl_u32 v41, v41, s41, 10
    v_lshl_add_u32 v76, v46, 4, v41
    s_mov_b32 s18, 1835008
    s_mov_b32 s19, 0x20000
    s_mov_b32 s22, 1835008
    s_mov_b32 s23, 0x20000
    s_mov_b32 s30, 33554432
    s_mov_b32 s31, 0x20000
    s_lshl_b32 s41, s38, 7
    s_add_u32 s42, s41, 148992
    v_lshl_add_u32 v145, v48, 2, s42
    s_lshl1_add_u32 s41, s41, 147968
    v_lshl_add_u32 v244, v48, 3, s41
    v_mov_b32 v22, 0
    v_mov_b32 v23, 0
    v_mov_b32 v35, 0
    v_mov_b32 v36, 0
    v_mov_b32 v37, 0
    s_and_b32 s41, s37, 6
    s_lshl1_add_u32 s41, s41, 0x40000
    s_bfe_i32 s41, 0xe2f1, s41
    s_add_u32 s41, s36, s41
    s_and_b32 s46, s41, 31
    s_lshl_b32 s43, s63, 5
    s_add_u32 s41, s41, s43
    v_lshl_add_u32 v41, v48, 6, s41
    v_cmp_gt_u32 vcc, 0x800, v41
    v_bfe_u32 v42, v41, 5, 1
    v_lshlrev_b32_e64 v42, 15, v42
    v_cndmask_b32 v142, 0, -1, vcc
    v_bfe_u32 v43, v41, 6, 5
    v_lshl_add_u32 v42, v43, 4, v42
    v_lshl_add_u32 v89, v47, 9, v42
    s_lshl_b32 s51, s46, 16
    s_lshl1_add_u32 s41, s37, s3
    s_lshl_b32 s54, s41, 11
    s_add_u32 s51, s51, s54
    s_add_u32 s51, s51, 1048576
    s_xor_b32 s51, s51, 4096
    s_lshl_b32 s41, s37, 5
    s_lshl4_add_u32 s41, s3, s41
    s_lshl2_add_u32 s42, s40, s37
    s_and_b32 s42, s42, 7
    s_lshl_b32 s42, s42, 6
    v_lshrrev_b32 v41, 1, v48
    v_add_u32 v41, s41, v41
    v_cmp_eq_u32 vcc, 0, v41
    v_mov_b32 v42, 256
    v_lshlrev_b32 v43, 31, v41
    v_cndmask_b32 v41, v41, v42, vcc
    v_or_b32 v90, 1.0, v43
    v_cvt_f32_u32 v41, v41
    v_mul_f32 v41, s60, v41
    v_and_b32 v42, 1, v0
    v_mul_u32_u24 v91, 0x10001, v42
    v_lshlrev_b32 v91, 15, v91
    v_cvt_f32_u32 v42, v42
    v_mul_f32 v42, 0x3e800000, v42
    v_mov_b32 v43, 0x78
    v_bfe_i32 v43, v43, v46, 1
    v_and_b32 v144, 0x80008000, v43
    v_lshl_add_u32 v43, v47, 3, s42
    v_cvt_f32_u32_e64 v43, v43
    v_fma_f32 v116, v43, v41, v42
    v_mul_f32 v143, 0x41800000, v41
    v_add_f32 v117, v116, v41
    v_add_f32 v118, v117, v41
    v_add_f32 v119, v118, v41
    v_add_f32 v120, v119, v41
    v_add_f32 v121, v120, v41
    v_add_f32 v122, v121, v41
    v_add_f32 v123, v122, v41
    v_add_f32 v124, v116, v143
    v_add_f32 v125, v117, v143
    v_add_f32 v126, v118, v143
    v_add_f32 v127, v119, v143
    v_add_f32 v128, v120, v143
    v_add_f32 v129, v121, v143
    v_add_f32 v130, v122, v143
    v_add_f32 v131, v123, v143
    v_cos_f32 v143, v143
    v_cos_f32 v116, v116
    v_cos_f32 v117, v117
    v_cos_f32 v118, v118
    v_cos_f32 v119, v119
    v_cos_f32 v120, v120
    v_cos_f32 v121, v121
    v_cos_f32 v122, v122
    v_cos_f32 v123, v123
    v_cos_f32 v124, v124
    v_cos_f32 v125, v125
    v_cos_f32 v126, v126
    v_cos_f32 v127, v127
    v_cos_f32 v128, v128
    v_cos_f32 v129, v129
    v_cos_f32 v130, v130
    v_cos_f32 v131, v131
    v_add_f32_e64 v143, v143, v143
    v_cvt_pk_bf16_f32 v100, v116, v117
    v_cvt_pk_bf16_f32 v101, v118, v119
    v_cvt_pk_bf16_f32 v102, v120, v121
    v_cvt_pk_bf16_f32 v103, v122, v123
    v_fma_f32 v116, v124, v143, -v116
    v_fma_f32 v117, v125, v143, -v117
    v_fma_f32 v118, v126, v143, -v118
    v_fma_f32 v119, v127, v143, -v119
    v_fma_f32 v120, v128, v143, -v120
    v_fma_f32 v121, v129, v143, -v121
    v_fma_f32 v122, v130, v143, -v122
    v_fma_f32 v123, v131, v143, -v123
    v_xor_b32_dpp v104, v100, v144 quad_perm:[0,1,3,2] row_mask:0xf bank_mask:0xf
    v_xor_b32_dpp v105, v101, v144 quad_perm:[0,1,3,2] row_mask:0xf bank_mask:0xf
    v_xor_b32_dpp v106, v102, v144 quad_perm:[0,1,3,2] row_mask:0xf bank_mask:0xf
    v_xor_b32_dpp v107, v103, v144 quad_perm:[0,1,3,2] row_mask:0xf bank_mask:0xf
    s_add_u32 m0, s52, 10240
    s_xor_b32 s58, s58, 512
    buffer_load_dwordx4 v68, s[4:7], s58 offen offset:0  lds
    buffer_load_dwordx4 v69, s[4:7], s58 offen offset:1024  lds
    s_add_u32 m0, s53, 81920
    s_lshl_b32 s58, s47, 16
    s_or_b32 s58, s58, s49
    buffer_load_dwordx4 v28, s[8:11], s58 offen offset:0 lds
    buffer_load_dwordx4 v29, s[8:11], s58 offen offset:1024 lds
    s_add_u32 m0, s53, 90112
    s_xor_b32 s58, s58, 0x40000
    buffer_load_dwordx4 v28, s[8:11], s58 offen offset:0 lds
    s_waitcnt vmcnt(9)
    s_and_b32 s100, s39, 0x3e3
    s_cbranch_scc0 Linit2
Lnoinit2:
    s_barrier
    ds_read_b128 v[148:151], v132 offset:0
    ds_read_b128 v[152:155], v133 offset:0
    buffer_load_dwordx4 v29, s[8:11], s58 offen offset:1024 lds
    ds_read_b128 v[156:159], v134 offset:0
    ds_read_b128 v[160:163], v135 offset:0
    ds_read_b64_tr_b16 v[228:229], v140 offset:0
    ds_read_b64_tr_b16 v[230:231], v140 offset:512
    ds_read_b64_tr_b16 v[232:233], v140 offset:2048
    s_add_u32 m0, s52, 4096
    s_add_u32 s47, s37, 2
    s_and_b32 s47, s47, 7
    s_lshl_b32 s58, s47, 7
    s_or_b32 s58, s58, s55
    buffer_load_dwordx4 v68, s[4:7], s58 offen offset:0  lds
    ds_read_b64_tr_b16 v[234:235], v140 offset:2560
    ds_read_b64_tr_b16 v[236:237], v140 offset:4096
    buffer_load_dwordx4 v69, s[4:7], s58 offen offset:1024  lds
    ds_read_b64_tr_b16 v[238:239], v140 offset:4608
    ds_read_b128 a[192:195], v136 offset:0
    ds_read_b128 a[196:199], v137 offset:0
    ds_read_b128 a[200:203], v138 offset:0
    ds_read_b128 a[204:207], v139 offset:0
    ds_read_b64 v[92:93], v92
    ds_read_b64 v[94:95], v94
    ds_read_b64 v[96:97], v96
    ds_read_b64 v[98:99], v98
    s_waitcnt lgkmcnt(14)
    v_mfma_f32_16x16x32_bf16 v[8:11], v[52:55], v[148:151], 0
    s_add_u32 m0, s52, 12288
    s_xor_b32 s58, s58, 512
    buffer_load_dwordx4 v68, s[4:7], s58 offen offset:0  lds
    v_mfma_f32_16x16x32_bf16 v[8:11], v[52:55], v[152:155], v[8:11]
    v_mfma_f32_16x16x32_bf16 v[8:11], v[52:55], v[156:159], v[8:11]
    v_mfma_f32_16x16x32_bf16 v[8:11], v[52:55], v[160:163], v[8:11]
    buffer_load_dwordx4 v69, s[4:7], s58 offen offset:1024  lds
    v_dot2c_f32_bf16 v146, v148, v148
    v_dot2c_f32_bf16 v147, v149, v149
    v_dot2c_f32_bf16 v146, v150, v150
    v_dot2c_f32_bf16 v147, v151, v151
    v_dot2c_f32_bf16 v146, v152, v152
    v_dot2c_f32_bf16 v147, v153, v153
    s_add_u32 m0, s53, 98304
    s_lshl_b32 s58, s47, 16
    s_or_b32 s58, s58, s49
    buffer_load_dwordx4 v28, s[8:11], s58 offen offset:0 lds
    v_dot2c_f32_bf16 v146, v154, v154
    v_dot2c_f32_bf16 v147, v155, v155
    v_dot2c_f32_bf16 v146, v156, v156
    v_dot2c_f32_bf16 v147, v157, v157
    v_dot2c_f32_bf16 v146, v158, v158
    v_dot2c_f32_bf16 v147, v159, v159
    buffer_load_dwordx4 v29, s[8:11], s58 offen offset:1024 lds
    v_dot2c_f32_bf16 v146, v160, v160
    v_dot2c_f32_bf16 v147, v161, v161
    v_dot2c_f32_bf16 v146, v162, v162
    v_dot2c_f32_bf16 v147, v163, v163
    s_waitcnt lgkmcnt(12)
    v_mfma_f32_16x16x32_bf16 v[56:59], v[52:55], v[228:231], 0
    ds_read_b64_tr_b16 v[240:241], v140 offset:6144
    v_mfma_f32_32x32x16_bf16 v[212:227], v[228:231], v[148:151], 0
    ds_read_b64_tr_b16 v[242:243], v140 offset:6656
    s_add_u32 m0, s53, 106496
    s_xor_b32 s58, s58, 0x40000
    buffer_load_dwordx4 v28, s[8:11], s58 offen offset:0 lds
    s_waitcnt lgkmcnt(12)
    v_mfma_f32_16x16x32_bf16 v[56:59], v[52:55], v[232:235], v[56:59]
    ds_read_b64_tr_b16 v[228:229], v141 offset:0
    v_mfma_f32_32x32x16_bf16 v[212:227], v[232:235], v[152:155], v[212:227]
    ds_read_b64_tr_b16 v[230:231], v141 offset:512
    buffer_load_dwordx4 v29, s[8:11], s58 offen offset:1024 lds
    s_waitcnt lgkmcnt(12)
    v_mfma_f32_16x16x32_bf16 v[56:59], v[52:55], v[236:239], v[56:59]
    ds_read_b64_tr_b16 v[232:233], v141 offset:2048
    v_mfma_f32_32x32x16_bf16 v[212:227], v[236:239], v[156:159], v[212:227]
    ds_read_b64_tr_b16 v[234:235], v141 offset:2560
    s_waitcnt lgkmcnt(4)
    v_mfma_f32_16x16x32_bf16 v[56:59], v[52:55], v[240:243], v[56:59]
    ds_read_b64_tr_b16 v[236:237], v141 offset:4096
    v_mfma_f32_32x32x16_bf16 v[212:227], v[240:243], v[160:163], v[212:227]
    ds_read_b64_tr_b16 v[238:239], v141 offset:4608
    s_add_u32 m0, s52, 6144
    s_add_u32 s47, s37, 3
    s_and_b32 s47, s47, 7
    s_lshl_b32 s58, s47, 7
    s_or_b32 s58, s58, s55
    buffer_load_dwordx4 v68, s[4:7], s58 offen offset:0  lds
    s_waitcnt lgkmcnt(4)
    v_mfma_f32_32x32x16_bf16 v[212:227], v[228:231], a[192:195], v[212:227]
    ds_read_b64_tr_b16 v[240:241], v141 offset:6144
    ds_read_b64_tr_b16 v[242:243], v141 offset:6656
    buffer_load_dwordx4 v69, s[4:7], s58 offen offset:1024  lds
    s_waitcnt lgkmcnt(4)
    v_mfma_f32_32x32x16_bf16 v[212:227], v[232:235], a[196:199], v[212:227]
    s_waitcnt vmcnt(10)
    s_barrier
    ds_read_b128 v[164:167], v132 offset:2048
    ds_read_b128 v[168:171], v133 offset:2048
    ds_read_b128 v[172:175], v134 offset:2048
    ds_read_b128 v[176:179], v135 offset:2048
    ds_read_b64_tr_b16 v[228:229], v140 offset:16384
    ds_read_b64_tr_b16 v[230:231], v140 offset:16896
    s_waitcnt lgkmcnt(8)
    v_mfma_f32_32x32x16_bf16 v[212:227], v[236:239], a[200:203], v[212:227]
    ds_read_b64_tr_b16 v[232:233], v140 offset:18432
    ds_read_b64_tr_b16 v[234:235], v140 offset:18944
    s_add_u32 m0, s52, 14336
    s_xor_b32 s58, s58, 512
    buffer_load_dwordx4 v68, s[4:7], s58 offen offset:0  lds
    s_waitcnt lgkmcnt(8)
    v_mfma_f32_32x32x16_bf16 v[212:227], v[240:243], a[204:207], v[212:227]
    ds_read_b64_tr_b16 v[236:237], v140 offset:20480
    ds_read_b64_tr_b16 v[238:239], v140 offset:20992
    s_waitcnt lgkmcnt(6)
    v_mfma_f32_16x16x32_bf16 v[8:11], v[52:55], v[164:167], v[8:11]
    ds_read_b128 a[208:211], v136 offset:2048
    v_mfma_f32_16x16x32_bf16 v[8:11], v[52:55], v[168:171], v[8:11]
    ds_read_b128 a[212:215], v137 offset:2048
    buffer_load_dwordx4 v69, s[4:7], s58 offen offset:1024  lds
    v_mfma_f32_16x16x32_bf16 v[8:11], v[52:55], v[172:175], v[8:11]
    ds_read_b128 a[216:219], v138 offset:2048
    v_mfma_f32_16x16x32_bf16 v[8:11], v[52:55], v[176:179], v[8:11]
    ds_read_b128 a[220:223], v139 offset:2048
    v_dot2c_f32_bf16 v146, v164, v164
    s_add_u32 m0, s53, 114688
    s_lshl_b32 s58, s47, 16
    s_or_b32 s58, s58, s49
    buffer_load_dwordx4 v28, s[8:11], s58 offen offset:0 lds
    v_dot2c_f32_bf16 v147, v165, v165
    v_dot2c_f32_bf16 v146, v166, v166
    v_dot2c_f32_bf16 v147, v167, v167
    v_dot2c_f32_bf16 v146, v168, v168
    v_dot2c_f32_bf16 v147, v169, v169
    v_dot2c_f32_bf16 v146, v170, v170
    buffer_load_dwordx4 v29, s[8:11], s58 offen offset:1024 lds
    v_dot2c_f32_bf16 v147, v171, v171
    v_dot2c_f32_bf16 v146, v172, v172
    v_dot2c_f32_bf16 v147, v173, v173
    v_dot2c_f32_bf16 v146, v174, v174
    v_dot2c_f32_bf16 v147, v175, v175
    v_dot2c_f32_bf16 v146, v176, v176
    v_dot2c_f32_bf16 v147, v177, v177
    v_dot2c_f32_bf16 v146, v178, v178
    s_add_u32 m0, s53, 122880
    s_xor_b32 s58, s58, 0x40000
    buffer_load_dwordx4 v28, s[8:11], s58 offen offset:0 lds
    v_dot2c_f32_bf16 v147, v179, v179
    s_waitcnt lgkmcnt(8)
    v_mfma_f32_16x16x32_bf16 v[56:59], v[52:55], v[228:231], v[56:59]
    ds_read_b64_tr_b16 v[240:241], v140 offset:22528
    v_mfma_f32_32x32x16_bf16 v[212:227], v[228:231], v[164:167], v[212:227]
    ds_read_b64_tr_b16 v[242:243], v140 offset:23040
    buffer_load_dwordx4 v29, s[8:11], s58 offen offset:1024 lds
    s_waitcnt lgkmcnt(8)
    v_mfma_f32_16x16x32_bf16 v[56:59], v[52:55], v[232:235], v[56:59]
    ds_read_b64_tr_b16 v[228:229], v141 offset:16384
    v_mfma_f32_32x32x16_bf16 v[212:227], v[232:235], v[168:171], v[212:227]
    ds_read_b64_tr_b16 v[230:231], v141 offset:16896
    s_add_u32 m0, s52, 0
    s_add_u32 s58, s59, 0
    buffer_load_dwordx4 v28, s[12:15], s58 offen offset:0 lds
    s_waitcnt lgkmcnt(8)
    v_mfma_f32_16x16x32_bf16 v[56:59], v[52:55], v[236:239], v[56:59]
    ds_read_b64_tr_b16 v[232:233], v141 offset:18432
    v_mfma_f32_32x32x16_bf16 v[212:227], v[236:239], v[172:175], v[212:227]
    ds_read_b64_tr_b16 v[234:235], v141 offset:18944
    buffer_load_dwordx4 v29, s[12:15], s58 offen offset:1024 lds
    s_waitcnt lgkmcnt(4)
    v_mfma_f32_16x16x32_bf16 v[56:59], v[52:55], v[240:243], v[56:59]
    ds_read_b64_tr_b16 v[236:237], v141 offset:20480
    v_mfma_f32_32x32x16_bf16 v[212:227], v[240:243], v[176:179], v[212:227]
    ds_read_b64_tr_b16 v[238:239], v141 offset:20992
    s_add_u32 m0, s52, 8192
    s_add_u32 s58, s59, 65536
    buffer_load_dwordx4 v28, s[12:15], s58 offen offset:0 lds
    s_waitcnt lgkmcnt(4)
    v_mfma_f32_32x32x16_bf16 v[212:227], v[228:231], a[208:211], v[212:227]
    ds_read_b64_tr_b16 v[240:241], v141 offset:22528
    ds_read_b64_tr_b16 v[242:243], v141 offset:23040
    s_waitcnt lgkmcnt(4)
    v_mfma_f32_32x32x16_bf16 v[212:227], v[232:235], a[212:215], v[212:227]
    s_waitcnt vmcnt(11)
    s_barrier
    ds_read_b128 v[180:183], v132 offset:4096
    ds_read_b128 v[184:187], v133 offset:4096
    ds_read_b128 v[188:191], v134 offset:4096
    ds_read_b128 v[192:195], v135 offset:4096
    ds_read_b64_tr_b16 v[228:229], v140 offset:32768
    ds_read_b64_tr_b16 v[230:231], v140 offset:33280
    buffer_load_dwordx4 v29, s[12:15], s58 offen offset:1024 lds
    s_waitcnt lgkmcnt(8)
    v_mfma_f32_32x32x16_bf16 v[212:227], v[236:239], a[216:219], v[212:227]
    ds_read_b64_tr_b16 v[232:233], v140 offset:34816
    ds_read_b64_tr_b16 v[234:235], v140 offset:35328
    s_waitcnt lgkmcnt(8)
    v_mfma_f32_32x32x16_bf16 v[212:227], v[240:243], a[220:223], v[212:227]
    ds_read_b64_tr_b16 v[236:237], v140 offset:36864
    ds_read_b64_tr_b16 v[238:239], v140 offset:37376
    s_add_u32 m0, s52, 2048
    s_add_u32 s58, s59, 16384
    buffer_load_dwordx4 v28, s[12:15], s58 offen offset:0 lds
    s_waitcnt lgkmcnt(6)
    v_mfma_f32_16x16x32_bf16 v[8:11], v[52:55], v[180:183], v[8:11]
    ds_read_b128 a[224:227], v136 offset:4096
    v_mfma_f32_16x16x32_bf16 v[8:11], v[52:55], v[184:187], v[8:11]
    ds_read_b128 a[228:231], v137 offset:4096
    v_mfma_f32_16x16x32_bf16 v[8:11], v[52:55], v[188:191], v[8:11]
    ds_read_b128 a[232:235], v138 offset:4096
    v_mfma_f32_16x16x32_bf16 v[8:11], v[52:55], v[192:195], v[8:11]
    ds_read_b128 a[236:239], v139 offset:4096
    buffer_load_dwordx4 v29, s[12:15], s58 offen offset:1024 lds
    v_dot2c_f32_bf16 v146, v180, v180
    v_dot2c_f32_bf16 v147, v181, v181
    v_dot2c_f32_bf16 v146, v182, v182
    v_dot2c_f32_bf16 v147, v183, v183
    v_dot2c_f32_bf16 v146, v184, v184
    v_dot2c_f32_bf16 v147, v185, v185
    v_dot2c_f32_bf16 v146, v186, v186
    v_dot2c_f32_bf16 v147, v187, v187
    s_add_u32 m0, s52, 10240
    s_add_u32 s58, s59, 81920
    buffer_load_dwordx4 v28, s[12:15], s58 offen offset:0 lds
    v_dot2c_f32_bf16 v146, v188, v188
    v_dot2c_f32_bf16 v147, v189, v189
    v_dot2c_f32_bf16 v146, v190, v190
    v_dot2c_f32_bf16 v147, v191, v191
    v_dot2c_f32_bf16 v146, v192, v192
    v_dot2c_f32_bf16 v147, v193, v193
    v_dot2c_f32_bf16 v146, v194, v194
    buffer_load_dwordx4 v29, s[12:15], s58 offen offset:1024 lds
    buffer_load_dword v1, v3, s[16:19], 0 offen
    buffer_load_dwordx4 v[72:75], v76, s[20:23], 0 offen offset:384
    v_dot2c_f32_bf16 v147, v195, v195
    s_waitcnt lgkmcnt(8)
    v_mfma_f32_16x16x32_bf16 v[56:59], v[52:55], v[228:231], v[56:59]
    ds_read_b64_tr_b16 v[240:241], v140 offset:38912
    v_mfma_f32_32x32x16_bf16 v[212:227], v[228:231], v[180:183], v[212:227]
    ds_read_b64_tr_b16 v[242:243], v140 offset:39424
    s_waitcnt lgkmcnt(8)
    v_mfma_f32_16x16x32_bf16 v[56:59], v[52:55], v[232:235], v[56:59]
    ds_read_b64_tr_b16 v[228:229], v141 offset:32768
    v_mfma_f32_32x32x16_bf16 v[212:227], v[232:235], v[184:187], v[212:227]
    ds_read_b64_tr_b16 v[230:231], v141 offset:33280
    s_waitcnt lgkmcnt(8)
    v_mfma_f32_16x16x32_bf16 v[56:59], v[52:55], v[236:239], v[56:59]
    ds_read_b64_tr_b16 v[232:233], v141 offset:34816
    v_mfma_f32_32x32x16_bf16 v[212:227], v[236:239], v[188:191], v[212:227]
    ds_read_b64_tr_b16 v[234:235], v141 offset:35328
    s_waitcnt lgkmcnt(4)
    v_mfma_f32_16x16x32_bf16 v[56:59], v[52:55], v[240:243], v[56:59]
    ds_read_b64_tr_b16 v[236:237], v141 offset:36864
    v_mfma_f32_32x32x16_bf16 v[212:227], v[240:243], v[192:195], v[212:227]
    ds_read_b64_tr_b16 v[238:239], v141 offset:37376
    s_waitcnt lgkmcnt(4)
    v_mfma_f32_32x32x16_bf16 v[212:227], v[228:231], a[224:227], v[212:227]
    ds_read_b64_tr_b16 v[240:241], v141 offset:38912
    ds_read_b64_tr_b16 v[242:243], v141 offset:39424
    s_waitcnt lgkmcnt(4)
    v_mfma_f32_32x32x16_bf16 v[212:227], v[232:235], a[228:231], v[212:227]
    s_waitcnt vmcnt(10)
    s_barrier
    ds_read_b128 v[196:199], v132 offset:6144
    ds_read_b128 v[200:203], v133 offset:6144
    ds_read_b128 v[204:207], v134 offset:6144
    ds_read_b128 v[208:211], v135 offset:6144
    ds_read_b64_tr_b16 v[228:229], v140 offset:49152
    ds_read_b64_tr_b16 v[230:231], v140 offset:49664
    s_add_u32 m0, s52, 4096
    s_add_u32 s58, s59, 32768
    buffer_load_dwordx4 v28, s[12:15], s58 offen offset:0 lds
    s_waitcnt lgkmcnt(8)
    v_mfma_f32_32x32x16_bf16 v[212:227], v[236:239], a[232:235], v[212:227]
    ds_read_b64_tr_b16 v[232:233], v140 offset:51200
    ds_read_b64_tr_b16 v[234:235], v140 offset:51712
    ds_write_b32 v145, v56
    buffer_load_dwordx4 v29, s[12:15], s58 offen offset:1024 lds
    s_waitcnt lgkmcnt(9)
    v_mfma_f32_32x32x16_bf16 v[212:227], v[240:243], a[236:239], v[212:227]
    ds_read_b64_tr_b16 v[236:237], v140 offset:53248
    ds_read_b64_tr_b16 v[238:239], v140 offset:53760
    s_waitcnt lgkmcnt(7)
    v_mfma_f32_16x16x32_bf16 v[8:11], v[52:55], v[196:199], v[8:11]
    ds_read_b128 a[240:243], v136 offset:6144
    v_mfma_f32_16x16x32_bf16 v[8:11], v[52:55], v[200:203], v[8:11]
    ds_read_b128 a[244:247], v137 offset:6144
    v_mfma_f32_16x16x32_bf16 v[8:11], v[52:55], v[204:207], v[8:11]
    ds_read_b128 a[248:251], v138 offset:6144
    s_add_u32 m0, s52, 12288
    s_add_u32 s58, s59, 98304
    buffer_load_dwordx4 v28, s[12:15], s58 offen offset:0 lds
    v_mfma_f32_16x16x32_bf16 v[8:11], v[52:55], v[208:211], v[8:11]
    ds_read_b128 a[252:255], v139 offset:6144
    v_dot2c_f32_bf16 v146, v196, v196
    buffer_load_dwordx4 v29, s[12:15], s58 offen offset:1024 lds
    v_dot2c_f32_bf16 v147, v197, v197
    v_dot2c_f32_bf16 v146, v198, v198
    v_dot2c_f32_bf16 v147, v199, v199
    v_dot2c_f32_bf16 v146, v200, v200
    v_dot2c_f32_bf16 v147, v201, v201
    v_dot2c_f32_bf16 v146, v202, v202
    v_dot2c_f32_bf16 v147, v203, v203
    v_dot2c_f32_bf16 v146, v204, v204
    v_dot2c_f32_bf16 v147, v205, v205
    v_dot2c_f32_bf16 v146, v206, v206
    v_dot2c_f32_bf16 v147, v207, v207
    v_dot2c_f32_bf16 v146, v208, v208
    v_dot2c_f32_bf16 v147, v209, v209
    v_dot2c_f32_bf16 v146, v210, v210
    v_dot2c_f32_bf16 v147, v211, v211
    s_lshl_b32 s55, s46, 10
    s_lshl_b32 s47, s38, 12
    s_add_u32 s47, s47, 65536
    v_add_f32 v42, v146, v147
    v_add_f32_e64 v147, v146, v147
    v_mov_b32 v146, v8
    s_waitcnt lgkmcnt(9)
    v_mfma_f32_16x16x32_bf16 v[60:63], v[52:55], v[228:231], 0
    ds_read_b64_tr_b16 v[240:241], v140 offset:55296
    v_mfma_f32_32x32x16_bf16 v[212:227], v[228:231], v[196:199], v[212:227]
    ds_read_b64_tr_b16 v[242:243], v140 offset:55808
    v_permlane32_swap_b32 v147, v42
    v_add_f32 v147, v147, v42
    ds_write_b64 v244, v[146:147]
    s_waitcnt lgkmcnt(10)
    v_mfma_f32_16x16x32_bf16 v[60:63], v[52:55], v[232:235], v[60:63]
    ds_read_b64_tr_b16 v[228:229], v141 offset:49152
    v_mfma_f32_32x32x16_bf16 v[212:227], v[232:235], v[200:203], v[212:227]
    ds_read_b64_tr_b16 v[230:231], v141 offset:49664
    v_xor_b32 v244, 256, v244
    v_xor_b32 v145, 256, v145
    s_waitcnt lgkmcnt(9)
    v_mfma_f32_16x16x32_bf16 v[60:63], v[52:55], v[236:239], v[60:63]
    ds_read_b64_tr_b16 v[232:233], v141 offset:51200
    v_mfma_f32_32x32x16_bf16 v[212:227], v[236:239], v[204:207], v[212:227]
    ds_read_b64_tr_b16 v[234:235], v141 offset:51712
    s_waitcnt lgkmcnt(4)
    s_barrier
    ds_read_b64 v[4:5], v244
    ds_read_b32 v6, v145
    s_cmp_eq_u32 s38, 3
    s_cbranch_scc1 LroleB
    v_mfma_f32_16x16x32_bf16 v[60:63], v[52:55], v[240:243], v[60:63]
    ds_read_b64_tr_b16 v[236:237], v141 offset:53248
    v_mfma_f32_32x32x16_bf16 v[212:227], v[240:243], v[208:211], v[212:227]
    ds_read_b64_tr_b16 v[238:239], v141 offset:53760
    s_add_u32 m0, s52, 6144
    s_add_u32 s58, s59, 49152
    buffer_load_dwordx4 v28, s[12:15], s58 offen offset:0 lds
    v_mul_u32_u24 v64, 3584, v45
    v_add_u32 v64, v64, v51
    s_waitcnt lgkmcnt(6)
    v_mfma_f32_16x16x32_bf16 v[60:63], v[52:55], v[228:231], v[60:63]
    ds_read_b64_tr_b16 v[240:241], v141 offset:55296
    v_mfma_f32_32x32x16_bf16 v[212:227], v[228:231], a[240:243], v[212:227]
    ds_read_b64_tr_b16 v[242:243], v141 offset:55808
    buffer_load_dwordx4 v29, s[12:15], s58 offen offset:1024 lds
    s_waitcnt lgkmcnt(5)
    v_add_f32 v146, v146, v4
    v_add_f32 v147, v147, v5
    s_waitcnt lgkmcnt(4)
    v_add_f32_e64 v56, v56, v6
    v_mul_f32 v70, 0xbb000000, v146
    v_mfma_f32_16x16x32_bf16 v[60:63], v[52:55], v[232:235], v[60:63]
    v_mfma_f32_32x32x16_bf16 v[212:227], v[232:235], a[244:247], v[212:227]
    s_add_u32 m0, s52, 14336
    s_add_u32 s58, s59, 114688
    buffer_load_dwordx4 v28, s[12:15], s58 offen offset:0 lds
    v_cmp_gt_u32 vcc, 32, v0
    v_cvt_pk_bf16_f32 v41, v70, v70
    v_and_b32 v42, 0xffff0000, v41
    v_sub_f32_e64 v42, v70, v42
    s_waitcnt lgkmcnt(2)
    v_mfma_f32_16x16x32_bf16 v[60:63], v[52:55], v[236:239], v[60:63]
    v_mfma_f32_32x32x16_bf16 v[212:227], v[236:239], a[248:251], v[212:227]
    buffer_load_dwordx4 v29, s[12:15], s58 offen offset:1024 lds
    v_cvt_pk_bf16_f32 v35, v42, v42
    v_cndmask_b32 v34, v35, v41, vcc
    v_and_b32 v35, 0xffff0000, v35
    v_sub_f32 v42, v42, v35
    v_cvt_pk_bf16_f32 v42, v70, v42
    v_cndmask_b32 v35, 0, v42, vcc
    s_waitcnt lgkmcnt(0)
    v_mfma_f32_16x16x32_bf16 v[60:63], v[52:55], v[240:243], v[60:63]
    v_mfma_f32_32x32x16_bf16 v[212:227], v[240:243], a[252:255], v[212:227]
    v_mul_f32_e64 v43, v70, v70
    v_fma_f32 v43, v147, s60, -v43
    v_max_f32_e64 v43, 0, v43
    v_add_f32 v4, 0x3727c5ac, v43
    v_rsq_f32 v71, v4
    s_lshl_b32 s41, s63, 7
    s_add_u32 s41, s41, 147456
    v_mul_f32_e64 v4, v71, v71
    v_fmaak_f32 v4, v4, v43, 0x3727c5ac
    v_rsq_f32_e64 v4, v4
    v_lshl_add_u32 v5, v48, 2, s41
    v_mul_f32 v4, v4, v71
    v_add_f32 v56, v56, v60
    v_cvt_pk_bf16_f32 v41, v56, v56
    v_and_b32 v41, 0xffff0000, v41
    v_sub_f32_e64 v42, v56, v41
    v_cvt_pk_bf16_f32 v20, v41, v42
    v_and_b32 v21, 0xffff0000, v20
    v_sub_f32_e64 v42, v42, v21
    v_cvt_pk_bf16_f32 v21, v42, v41
    s_nop 1
    v_mfma_f32_32x32x16_bf16 v[212:227], v[20:23], v[34:37], v[212:227]
    v_rcp_f32 v250, v4
    v_mul_f32 v246, 0xc0135761, v4
    v_mul_f32 v43, v4, v4
    v_mul_f32 v43, v43, v4
    v_mul_f32 v248, 0xbdd2d3e8, v43
    v_mul_f32_e64 v70, v70, v71
    ds_write_b32 v5, v71
    s_mul_i32 s42, s37, 3
    s_add_u32 s42, s42, s38
    s_lshl_b32 s48, s42, 7
    s_lshl_b32 s62, s42, 12
    v_add_u32 v65, 27648, v64
    v_add_u32 v66, 55296, v64
    v_add_u32 v67, 82944, v64
    s_add_u32 m0, s47, 65536
    s_add_u32 s58, s48, 0
    buffer_load_dwordx4 v64, s[16:19], s58 offen offset:0 lds
    v_pk_mul_f32 v[4:5], v[212:213], v[212:213]
    v_pk_mul_f32 v[6:7], v[214:215], v[214:215]
    v_pk_mul_f32 v[8:9], v[216:217], v[216:217]
    v_pk_mul_f32 v[10:11], v[218:219], v[218:219]
    v_pk_fma_f32 v[4:5], v[4:5], v[248:249], v[246:247] op_sel_hi:[1,0,0]
    v_pk_fma_f32 v[6:7], v[6:7], v[248:249], v[246:247] op_sel_hi:[1,0,0]
    v_pk_fma_f32 v[8:9], v[8:9], v[248:249], v[246:247] op_sel_hi:[1,0,0]
    v_pk_fma_f32 v[10:11], v[10:11], v[248:249], v[246:247] op_sel_hi:[1,0,0]
    v_pk_mul_f32 v[4:5], v[4:5], v[212:213]
    v_pk_mul_f32 v[6:7], v[6:7], v[214:215]
    v_pk_mul_f32 v[8:9], v[8:9], v[216:217]
    v_pk_mul_f32 v[10:11], v[10:11], v[218:219]
    v_exp_f32 v4, v4
    v_exp_f32 v5, v5
    v_exp_f32 v6, v6
    buffer_load_dwordx4 v65, s[16:19], s58 offen offset:1024 lds
    v_exp_f32 v7, v7
    v_exp_f32 v8, v8
    v_exp_f32 v9, v9
    v_exp_f32 v10, v10
    v_exp_f32_e64 v11, v11
    v_pk_fma_f32 v[4:5], v[4:5], v[250:251], v[250:251] op_sel_hi:[1,0,0]
    v_pk_fma_f32 v[6:7], v[6:7], v[250:251], v[250:251] op_sel_hi:[1,0,0]
    v_pk_fma_f32 v[8:9], v[8:9], v[250:251], v[250:251] op_sel_hi:[1,0,0]
    v_pk_fma_f32 v[10:11], v[10:11], v[250:251], v[250:251] op_sel_hi:[1,0,0]
    v_rcp_f32 v4, v4
    v_rcp_f32 v5, v5
    v_rcp_f32_e64 v6, v6
    buffer_load_dwordx4 v66, s[16:19], s58 offen offset:2048 lds
    v_rcp_f32 v7, v7
    v_rcp_f32 v8, v8
    v_rcp_f32 v9, v9
    v_rcp_f32 v10, v10
    v_rcp_f32_e64 v11, v11
    v_pk_mul_f32 v[4:5], v[4:5], v[212:213]
    v_pk_mul_f32 v[6:7], v[6:7], v[214:215]
    v_pk_mul_f32 v[8:9], v[8:9], v[216:217]
    v_pk_mul_f32 v[10:11], v[10:11], v[218:219]
    v_cvt_pk_bf16_f32 v12, v4, v5
    v_cvt_pk_bf16_f32 v13, v6, v7
    v_cvt_pk_bf16_f32 v14, v8, v9
    v_cvt_pk_bf16_f32 v15, v10, v11
    v_and_b32_e64 v12, v142, v12
    buffer_load_dwordx4 v67, s[16:19], s58 offen offset:3072 lds
    v_and_b32 v13, v142, v13
    v_and_b32 v14, v142, v14
    v_and_b32_e64 v15, v142, v15
    buffer_store_dwordx4 v[12:15], v89, s[28:31], s51 offen offset:0 sc1
    v_pk_mul_f32 v[4:5], v[220:221], v[220:221]
    v_pk_mul_f32 v[6:7], v[222:223], v[222:223]
    v_pk_mul_f32 v[8:9], v[224:225], v[224:225]
    v_pk_mul_f32 v[10:11], v[226:227], v[226:227]
    v_pk_fma_f32 v[4:5], v[4:5], v[248:249], v[246:247] op_sel_hi:[1,0,0]
    v_pk_fma_f32 v[6:7], v[6:7], v[248:249], v[246:247] op_sel_hi:[1,0,0]
    v_pk_fma_f32 v[8:9], v[8:9], v[248:249], v[246:247] op_sel_hi:[1,0,0]
    v_pk_fma_f32 v[10:11], v[10:11], v[248:249], v[246:247] op_sel_hi:[1,0,0]
    v_pk_mul_f32 v[4:5], v[4:5], v[220:221]
    v_pk_mul_f32 v[6:7], v[6:7], v[222:223]
    v_pk_mul_f32 v[8:9], v[8:9], v[224:225]
    v_pk_mul_f32 v[10:11], v[10:11], v[226:227]
    s_add_u32 m0, s47, 0
    s_add_u32 s58, s48, 114688
    buffer_load_dwordx4 v64, s[16:19], s58 offen offset:0 lds
    v_exp_f32 v4, v4
    v_exp_f32 v5, v5
    v_exp_f32 v6, v6
    v_exp_f32 v7, v7
    v_exp_f32 v8, v8
    v_exp_f32 v9, v9
    v_exp_f32 v10, v10
    v_exp_f32_e64 v11, v11
    v_pk_fma_f32 v[4:5], v[4:5], v[250:251], v[250:251] op_sel_hi:[1,0,0]
    v_pk_fma_f32 v[6:7], v[6:7], v[250:251], v[250:251] op_sel_hi:[1,0,0]
    buffer_load_dwordx4 v65, s[16:19], s58 offen offset:1024 lds
    v_pk_fma_f32 v[8:9], v[8:9], v[250:251], v[250:251] op_sel_hi:[1,0,0]
    v_pk_fma_f32 v[10:11], v[10:11], v[250:251], v[250:251] op_sel_hi:[1,0,0]
    v_rcp_f32 v4, v4
    v_rcp_f32 v5, v5
    v_rcp_f32 v6, v6
    v_rcp_f32 v7, v7
    v_rcp_f32 v8, v8
    v_rcp_f32 v9, v9
    v_rcp_f32 v10, v10
    v_rcp_f32 v11, v11
    v_pk_mul_f32 v[4:5], v[4:5], v[220:221]
    buffer_load_dwordx4 v66, s[16:19], s58 offen offset:2048 lds
    v_pk_mul_f32 v[6:7], v[6:7], v[222:223]
    v_pk_mul_f32 v[8:9], v[8:9], v[224:225]
    v_pk_mul_f32 v[10:11], v[10:11], v[226:227]
    v_cvt_pk_bf16_f32 v16, v4, v5
    v_cvt_pk_bf16_f32 v17, v6, v7
    v_cvt_pk_bf16_f32 v18, v8, v9
    v_cvt_pk_bf16_f32 v19, v10, v11
    v_and_b32 v16, v142, v16
    v_and_b32 v17, v142, v17
    v_and_b32 v18, v142, v18
    v_and_b32 v19, v142, v19
    buffer_store_dwordx4 v[16:19], v89, s[28:31], s51 offen offset:1024 sc1
    buffer_load_dwordx4 v67, s[16:19], s58 offen offset:3072 lds
    v_add_u32 v24, s47, v24
    v_xor_b32 v25, 64, v24
    v_add_u32 v26, 0x10000, v24
    v_add_u32 v27, 0x10000, v25
    v_lshlrev_b32_e64 v44, 4, v0
    v_mfma_f32_32x32x16_bf16 v[212:227], v[148:151], v[100:103], 0
    v_cvt_pk_bf16_f32 v108, v124, v125
    v_cvt_pk_bf16_f32 v109, v126, v127
    v_cvt_pk_bf16_f32 v110, v128, v129
    v_cvt_pk_bf16_f32 v111, v130, v131
    v_mfma_f32_32x32x16_bf16 v[228:243], a[192:195], v[100:103], 0
    s_add_u32 m0, s47, 16384
    s_add_u32 s58, s48, 229376
    buffer_load_dwordx4 v64, s[16:19], s58 offen offset:0 lds
    v_fma_f32 v124, v116, v143, -v124
    v_fma_f32 v125, v117, v143, -v125
    v_fma_f32 v126, v118, v143, -v126
    v_fma_f32 v127, v119, v143, -v127
    v_mfma_f32_32x32x16_bf16 v[212:227], v[180:183], v[104:107], v[212:227]
    v_fma_f32 v128, v120, v143, -v128
    v_fma_f32 v129, v121, v143, -v129
    v_fma_f32 v130, v122, v143, -v130
    v_fma_f32 v131, v123, v143, -v131
    v_mfma_f32_32x32x16_bf16 v[228:243], a[224:227], v[104:107], v[228:243]
    buffer_load_dwordx4 v65, s[16:19], s58 offen offset:1024 lds
    v_xor_b32_dpp v112, v108, v144 quad_perm:[0,1,3,2] row_mask:0xf bank_mask:0xf
    v_xor_b32_dpp v113, v109, v144 quad_perm:[0,1,3,2] row_mask:0xf bank_mask:0xf
    v_xor_b32_dpp v114, v110, v144 quad_perm:[0,1,3,2] row_mask:0xf bank_mask:0xf
    v_xor_b32_dpp v115, v111, v144 quad_perm:[0,1,3,2] row_mask:0xf bank_mask:0xf
    v_mfma_f32_32x32x16_bf16 v[212:227], v[152:155], v[108:111], v[212:227]
    v_cvt_pk_bf16_f32 v100, v116, v117
    v_cvt_pk_bf16_f32 v101, v118, v119
    v_cvt_pk_bf16_f32 v102, v120, v121
    v_cvt_pk_bf16_f32 v103, v122, v123
    v_mfma_f32_32x32x16_bf16 v[228:243], a[196:199], v[108:111], v[228:243]
    buffer_load_dwordx4 v66, s[16:19], s58 offen offset:2048 lds
    v_fma_f32 v116, v124, v143, -v116
    v_fma_f32 v117, v125, v143, -v117
    v_fma_f32 v118, v126, v143, -v118
    v_fma_f32 v119, v127, v143, -v119
    v_mfma_f32_32x32x16_bf16 v[212:227], v[184:187], v[112:115], v[212:227]
    v_fma_f32 v120, v128, v143, -v120
    v_fma_f32 v121, v129, v143, -v121
    v_fma_f32 v122, v130, v143, -v122
    v_fma_f32 v123, v131, v143, -v123
    v_mfma_f32_32x32x16_bf16 v[228:243], a[228:231], v[112:115], v[228:243]
    buffer_load_dwordx4 v67, s[16:19], s58 offen offset:3072 lds
    v_xor_b32_dpp v104, v100, v144 quad_perm:[0,1,3,2] row_mask:0xf bank_mask:0xf
    v_xor_b32_dpp v105, v101, v144 quad_perm:[0,1,3,2] row_mask:0xf bank_mask:0xf
    v_xor_b32_dpp v106, v102, v144 quad_perm:[0,1,3,2] row_mask:0xf bank_mask:0xf
    v_xor_b32_dpp v107, v103, v144 quad_perm:[0,1,3,2] row_mask:0xf bank_mask:0xf
    v_mfma_f32_32x32x16_bf16 v[212:227], v[156:159], v[100:103], v[212:227]
    v_cvt_pk_bf16_f32 v108, v124, v125
    v_cvt_pk_bf16_f32 v109, v126, v127
    v_cvt_pk_bf16_f32 v110, v128, v129
    v_cvt_pk_bf16_f32 v111, v130, v131
    v_mfma_f32_32x32x16_bf16 v[228:243], a[200:203], v[100:103], v[228:243]
    s_add_u32 m0, s47, 32768
    s_add_u32 s58, s48, 344064
    buffer_load_dwordx4 v64, s[16:19], s58 offen offset:0 lds
    v_fma_f32 v124, v116, v143, -v124
    v_fma_f32 v125, v117, v143, -v125
    v_fma_f32 v126, v118, v143, -v126
    v_fma_f32 v127, v119, v143, -v127
    s_waitcnt vmcnt(6)
    s_barrier
    v_mfma_f32_32x32x16_bf16 v[212:227], v[188:191], v[104:107], v[212:227]
    ds_read_b64_tr_b16 a[64:65], v88 offset:0
    ds_read_b64_tr_b16 a[66:67], v88 offset:1024
    v_fma_f32 v128, v120, v143, -v128
    v_fma_f32 v129, v121, v143, -v129
    v_fma_f32 v130, v122, v143, -v130
    buffer_load_dwordx4 v65, s[16:19], s58 offen offset:1024 lds
    v_fma_f32 v131, v123, v143, -v131
    v_mfma_f32_32x32x16_bf16 v[228:243], a[232:235], v[104:107], v[228:243]
    ds_read_b64_tr_b16 a[68:69], v88 offset:2048
    ds_read_b64_tr_b16 a[70:71], v88 offset:3072
    v_xor_b32_dpp v112, v108, v144 quad_perm:[0,1,3,2] row_mask:0xf bank_mask:0xf
    v_xor_b32_dpp v113, v109, v144 quad_perm:[0,1,3,2] row_mask:0xf bank_mask:0xf
    v_xor_b32_dpp v114, v110, v144 quad_perm:[0,1,3,2] row_mask:0xf bank_mask:0xf
    v_xor_b32_dpp v115, v111, v144 quad_perm:[0,1,3,2] row_mask:0xf bank_mask:0xf
    v_mfma_f32_32x32x16_bf16 v[212:227], v[160:163], v[108:111], v[212:227]
    ds_read_b64_tr_b16 a[72:73], v88 offset:4096
    ds_read_b64_tr_b16 a[74:75], v88 offset:5120
    v_cvt_pk_bf16_f32 v100, v116, v117
    ds_read_b64_tr_b16 a[0:1], v26 offset:0
    ds_read_b64_tr_b16 a[2:3], v26 offset:1024
    buffer_load_dwordx4 v66, s[16:19], s58 offen offset:2048 lds
    v_cvt_pk_bf16_f32 v101, v118, v119
    v_cvt_pk_bf16_f32 v102, v120, v121
    v_cvt_pk_bf16_f32 v103, v122, v123
    v_mfma_f32_32x32x16_bf16 v[228:243], a[204:207], v[108:111], v[228:243]
    ds_read_b64_tr_b16 a[76:77], v88 offset:6144
    ds_read_b64_tr_b16 a[78:79], v88 offset:7168
    v_fma_f32 v116, v124, v143, -v116
    v_fma_f32 v117, v125, v143, -v117
    v_fma_f32 v118, v126, v143, -v118
    v_fma_f32 v119, v127, v143, -v119
    ds_read_b64_tr_b16 a[4:5], v27 offset:0
    ds_read_b64_tr_b16 a[6:7], v27 offset:1024
    buffer_load_dwordx4 v67, s[16:19], s58 offen offset:3072 lds
    v_mfma_f32_32x32x16_bf16 v[212:227], v[192:195], v[112:115], v[212:227]
    ds_read_b64_tr_b16 a[80:81], v88 offset:8192
    ds_read_b64_tr_b16 a[82:83], v88 offset:9216
    v_fma_f32 v120, v128, v143, -v120
    v_fma_f32 v121, v129, v143, -v121
    v_fma_f32 v122, v130, v143, -v122
    v_fma_f32 v123, v131, v143, -v123
    v_mfma_f32_32x32x16_bf16 v[228:243], a[236:239], v[112:115], v[228:243]
    ds_read_b64_tr_b16 a[84:85], v88 offset:10240
    ds_read_b64_tr_b16 a[8:9], v26 offset:2048
    ds_read_b64_tr_b16 a[10:11], v26 offset:3072
    s_add_u32 m0, s47, 49152
    s_add_u32 s58, s48, 458752
    buffer_load_dwordx4 v64, s[16:19], s58 offen offset:0 lds
    ds_read_b64_tr_b16 a[86:87], v88 offset:11264
    v_xor_b32_dpp v104, v100, v144 quad_perm:[0,1,3,2] row_mask:0xf bank_mask:0xf
    v_xor_b32_dpp v105, v101, v144 quad_perm:[0,1,3,2] row_mask:0xf bank_mask:0xf
    v_xor_b32_dpp v106, v102, v144 quad_perm:[0,1,3,2] row_mask:0xf bank_mask:0xf
    v_xor_b32_dpp v107, v103, v144 quad_perm:[0,1,3,2] row_mask:0xf bank_mask:0xf
    v_mfma_f32_32x32x16_bf16 v[212:227], v[164:167], v[100:103], v[212:227]
    ds_read_b64_tr_b16 a[88:89], v88 offset:12288
    ds_read_b64_tr_b16 a[90:91], v88 offset:13312
    ds_read_b64_tr_b16 a[12:13], v27 offset:2048
    ds_read_b64_tr_b16 a[14:15], v27 offset:3072
    buffer_load_dwordx4 v65, s[16:19], s58 offen offset:1024 lds
    v_cvt_pk_bf16_f32 v108, v124, v125
    v_cvt_pk_bf16_f32 v109, v126, v127
    v_cvt_pk_bf16_f32 v110, v128, v129
    v_cvt_pk_bf16_f32 v111, v130, v131
    v_mfma_f32_32x32x16_bf16 v[228:243], a[208:211], v[100:103], v[228:243]
    ds_read_b64_tr_b16 a[92:93], v88 offset:14336
    ds_read_b64_tr_b16 a[94:95], v88 offset:15360
    v_fma_f32 v124, v116, v143, -v124
    v_fma_f32 v125, v117, v143, -v125
    v_fma_f32 v126, v118, v143, -v126
    v_fma_f32 v127, v119, v143, -v127
    s_waitcnt vmcnt(10)
    ds_read_b64_tr_b16 a[16:17], v24 offset:0
    ds_read_b64_tr_b16 a[18:19], v24 offset:1024
    buffer_load_dwordx4 v66, s[16:19], s58 offen offset:2048 lds
    ds_read_b64_tr_b16 a[96:97], v88 offset:16384
    ds_read_b64_tr_b16 a[98:99], v88 offset:17408
    ds_read_b64_tr_b16 a[100:101], v88 offset:18432
    ds_read_b64_tr_b16 a[102:103], v88 offset:19456
    ds_read_b64_tr_b16 a[104:105], v88 offset:20480
    ds_read_b64_tr_b16 a[106:107], v88 offset:21504
    ds_read_b64_tr_b16 a[20:21], v25 offset:0
    ds_read_b64_tr_b16 a[22:23], v25 offset:1024
    buffer_load_dwordx4 v67, s[16:19], s58 offen offset:3072 lds
    ds_read_b64_tr_b16 a[108:109], v88 offset:22528
    ds_read_b64_tr_b16 a[110:111], v88 offset:23552
    ds_read_b64_tr_b16 a[112:113], v88 offset:24576
    ds_read_b64_tr_b16 a[114:115], v88 offset:25600
    ds_read_b64_tr_b16 a[116:117], v88 offset:26624
    ds_read_b64_tr_b16 a[118:119], v88 offset:27648
    ds_read_b64_tr_b16 a[120:121], v88 offset:28672
    ds_read_b64_tr_b16 a[24:25], v24 offset:2048
    ds_read_b64_tr_b16 a[26:27], v24 offset:3072
    s_add_u32 m0, s47, 65536
    s_add_u32 s58, s48, 573440
    s_waitcnt lgkmcnt(15)
    buffer_load_dwordx4 v64, s[16:19], s58 offen offset:0 lds
    ds_read_b64_tr_b16 a[122:123], v88 offset:29696
    ds_read_b64_tr_b16 a[124:125], v88 offset:30720
    ds_read_b64_tr_b16 a[126:127], v88 offset:31744
    ds_read_b64_tr_b16 a[128:129], v88 offset:32768
    ds_read_b64_tr_b16 a[130:131], v88 offset:33792
    ds_read_b64_tr_b16 a[28:29], v25 offset:2048
    ds_read_b64_tr_b16 a[30:31], v25 offset:3072
    buffer_load_dwordx4 v65, s[16:19], s58 offen offset:1024 lds
    ds_read_b64_tr_b16 a[132:133], v88 offset:34816
    ds_read_b64_tr_b16 a[134:135], v88 offset:35840
    ds_read_b64_tr_b16 a[136:137], v88 offset:36864
    ds_read_b64_tr_b16 a[138:139], v88 offset:37888
    ds_read_b64_tr_b16 a[140:141], v88 offset:38912
    ds_read_b64_tr_b16 a[142:143], v88 offset:39936
    ds_read_b64_tr_b16 a[144:145], v88 offset:40960
    s_waitcnt vmcnt(10)
    ds_read_b64_tr_b16 a[32:33], v24 offset:16384
    ds_read_b64_tr_b16 a[34:35], v24 offset:17408
    buffer_load_dwordx4 v66, s[16:19], s58 offen offset:2048 lds
    ds_read_b64_tr_b16 a[146:147], v88 offset:41984
    ds_read_b64_tr_b16 a[148:149], v88 offset:43008
    ds_read_b64_tr_b16 a[150:151], v88 offset:44032
    ds_read_b64_tr_b16 a[152:153], v88 offset:45056
    ds_read_b64_tr_b16 a[154:155], v88 offset:46080
    ds_read_b64_tr_b16 a[156:157], v88 offset:47104
    ds_read_b64_tr_b16 a[36:37], v25 offset:16384
    ds_read_b64_tr_b16 a[38:39], v25 offset:17408
    buffer_load_dwordx4 v67, s[16:19], s58 offen offset:3072 lds
    ds_read_b64_tr_b16 a[158:159], v88 offset:48128
    ds_read_b64_tr_b16 a[160:161], v88 offset:49152
    ds_read_b64_tr_b16 a[162:163], v88 offset:50176
    ds_read_b64_tr_b16 a[164:165], v88 offset:51200
    ds_read_b64_tr_b16 a[166:167], v88 offset:52224
    ds_read_b64_tr_b16 a[168:169], v88 offset:53248
    ds_read_b64_tr_b16 a[170:171], v88 offset:54272
    ds_read_b64_tr_b16 a[40:41], v24 offset:18432
    ds_read_b64_tr_b16 a[42:43], v24 offset:19456
    s_add_u32 m0, s47, 0
    s_add_u32 s58, s48, 688128
    s_waitcnt lgkmcnt(15)
    buffer_load_dwordx4 v64, s[16:19], s58 offen offset:0 lds
    ds_read_b64_tr_b16 a[172:173], v88 offset:55296
    ds_read_b64_tr_b16 a[174:175], v88 offset:56320
    ds_read_b64_tr_b16 a[176:177], v88 offset:57344
    ds_read_b64_tr_b16 a[178:179], v88 offset:58368
    ds_read_b64_tr_b16 a[180:181], v88 offset:59392
    ds_read_b64_tr_b16 a[44:45], v25 offset:18432
    ds_read_b64_tr_b16 a[46:47], v25 offset:19456
    buffer_load_dwordx4 v65, s[16:19], s58 offen offset:1024 lds
    ds_read_b64_tr_b16 a[182:183], v88 offset:60416
    ds_read_b64_tr_b16 a[184:185], v88 offset:61440
    ds_read_b64_tr_b16 a[186:187], v88 offset:62464
    ds_read_b64_tr_b16 a[188:189], v88 offset:63488
    ds_read_b64_tr_b16 a[190:191], v88 offset:64512
    s_lshl_b32 s52, s36, 16
    s_lshl_b32 s45, s63, 15
    s_lshl_b32 s41, s3, 12
    s_waitcnt vmcnt(10)
    ds_read_b64_tr_b16 a[48:49], v24 offset:32768
    ds_read_b64_tr_b16 a[50:51], v24 offset:33792
    buffer_load_dwordx4 v66, s[16:19], s58 offen offset:2048 lds
    s_add_u32 s45, s45, s41
    s_add_u32 s46, s45, s52
    s_waitcnt lgkmcnt(0)
    s_barrier
    s_add_u32 m0, s45, 0
    s_add_u32 s58, s46, 1048576
    buffer_load_dwordx4 v44, s[28:31], s58 offen offset:0 sc1 lds
    buffer_load_dwordx4 v44, s[28:31], s58 offen offset:1024 sc1 lds
    buffer_load_dwordx4 v44, s[28:31], s58 offen offset:2048 sc1 lds
    buffer_load_dwordx4 v44, s[28:31], s58 offen offset:3072 sc1 lds
    v_mfma_f32_32x32x16_bf16 v[212:227], v[196:199], v[104:107], v[212:227]
    ds_read_b64_tr_b16 a[52:53], v25 offset:32768
    ds_read_b64_tr_b16 a[54:55], v25 offset:33792
    v_fma_f32 v128, v120, v143, -v128
    v_fma_f32 v129, v121, v143, -v129
    v_fma_f32 v130, v122, v143, -v130
    v_fma_f32 v131, v123, v143, -v131
    v_mfma_f32_32x32x16_bf16 v[228:243], a[240:243], v[104:107], v[228:243]
    s_add_u32 m0, s45, 8192
    s_add_u32 s58, s46, 1056768
    buffer_load_dwordx4 v44, s[28:31], s58 offen offset:0 sc1 lds
    v_xor_b32_dpp v112, v108, v144 quad_perm:[0,1,3,2] row_mask:0xf bank_mask:0xf
    v_xor_b32_dpp v113, v109, v144 quad_perm:[0,1,3,2] row_mask:0xf bank_mask:0xf
    v_xor_b32_dpp v114, v110, v144 quad_perm:[0,1,3,2] row_mask:0xf bank_mask:0xf
    v_xor_b32_dpp v115, v111, v144 quad_perm:[0,1,3,2] row_mask:0xf bank_mask:0xf
    s_lshl_b32 s41, s38, 11
    s_add_u32 s41, s41, 155648
    v_add_u32 v42, s41, v44
    buffer_load_dwordx4 v44, s[28:31], s58 offen offset:1024 sc1 lds
    ds_write_b128 v42, v[92:95] offset:0
    v_lshlrev_b32_e64 v72, 16, v92
    v_and_b32 v73, 0xffff0000, v92
    v_lshlrev_b32_e64 v74, 16, v93
    v_and_b32 v75, 0xffff0000, v93
    buffer_load_dwordx4 v44, s[28:31], s58 offen offset:2048 sc1 lds
    v_lshlrev_b32_e64 v76, 16, v94
    v_and_b32 v77, 0xffff0000, v94
    v_lshlrev_b32_e64 v78, 16, v95
    v_and_b32 v79, 0xffff0000, v95
    ds_write_b128 v42, v[96:99] offset:1024
    buffer_load_dwordx4 v44, s[28:31], s58 offen offset:3072 sc1 lds
    v_lshlrev_b32_e64 v80, 16, v96
    v_and_b32 v81, 0xffff0000, v96
    v_lshlrev_b32_e64 v82, 16, v97
    v_and_b32 v83, 0xffff0000, v97
    v_lshlrev_b32_e64 v84, 16, v98
    v_and_b32 v85, 0xffff0000, v98
    v_lshlrev_b32_e64 v86, 16, v99
    v_and_b32 v87, 0xffff0000, v99
    v_mov_b32_e64 v132, v71
    s_add_u32 m0, s45, 16384
    s_add_u32 s58, s46, 1064960
    buffer_load_dwordx4 v44, s[28:31], s58 offen offset:0 sc1 lds
    v_mov_b32 v133, v70
    s_lshl_b32 s41, s63, 15
    v_add_u32_e64 v51, s41, v44
    v_pk_fma_f32 v[72:73], v[72:73], v[132:133], v[132:133] op_sel:[0,0,1] op_sel_hi:[1,0,1]
    v_pk_fma_f32 v[74:75], v[74:75], v[132:133], v[132:133] op_sel:[0,0,1] op_sel_hi:[1,0,1]
    v_pk_fma_f32 v[76:77], v[76:77], v[132:133], v[132:133] op_sel:[0,0,1] op_sel_hi:[1,0,1]
    v_pk_fma_f32 v[78:79], v[78:79], v[132:133], v[132:133] op_sel:[0,0,1] op_sel_hi:[1,0,1]
    buffer_load_dwordx4 v44, s[28:31], s58 offen offset:1024 sc1 lds
    v_pk_fma_f32 v[80:81], v[80:81], v[132:133], v[132:133] op_sel:[0,0,1] op_sel_hi:[1,0,1]
    v_pk_fma_f32 v[82:83], v[82:83], v[132:133], v[132:133] op_sel:[0,0,1] op_sel_hi:[1,0,1]
    v_pk_fma_f32 v[84:85], v[84:85], v[132:133], v[132:133] op_sel:[0,0,1] op_sel_hi:[1,0,1]
    v_pk_fma_f32 v[86:87], v[86:87], v[132:133], v[132:133] op_sel:[0,0,1] op_sel_hi:[1,0,1]
    v_mov_b32_e64 v68, 0
    v_mov_b32 v69, 0
    s_add_u32 s44, s54, s52
    s_add_u32 s44, s44, 3145728
    v_mfma_f32_16x16x32_bf16 v[56:59], v[52:55], a[0:3], 0
    ds_read_b64_tr_b16 a[56:57], v24 offset:34816
    ds_read_b64_tr_b16 a[58:59], v24 offset:35840
    buffer_load_dwordx4 v44, s[28:31], s58 offen offset:2048 sc1 lds
    v_lshlrev_b32 v43, 3, v0
    v_cmp_gt_u32 vcc, 32, v0
    v_mov_b32 v12, 1073741824
    s_lshl_b32 s43, s36, 13
    v_mfma_f32_16x16x32_bf16 v[60:63], v[52:55], a[4:7], 0
    ds_read_b64_tr_b16 a[60:61], v25 offset:34816
    ds_read_b64_tr_b16 a[62:63], v25 offset:35840
    buffer_load_dwordx4 v44, s[28:31], s58 offen offset:3072 sc1 lds
    v_cndmask_b32 v43, v12, v43, vcc
    s_lshr_b32 s42, s54, 2
    s_add_u32 s43, s43, s42
    s_lshl_b32 s42, s63, 8
    s_add_u32 m0, s45, 24576
    s_add_u32 s58, s46, 1073152
    buffer_load_dwordx4 v44, s[28:31], s58 offen offset:0 sc1 lds
    s_add_u32 s43, s43, s42
    s_add_u32 s43, s43, 5242880
    v_cvt_f32_u32 v41, v48
    v_mul_f32 v41, 0x3d000000, v41
    v_cvt_f32_u32_e64 v42, v47
    s_waitcnt vmcnt(9)
    s_barrier
    ds_read_b128 v[148:151], v51 offset:0
    ds_read_b128 v[152:155], v51 offset:1024
    ds_read_b128 v[156:159], v51 offset:2048
    s_waitcnt lgkmcnt(2)
    v_mfma_f32_32x32x16_bf16 v[72:87], a[64:67], v[148:151], v[72:87]
    ds_read_b128 v[160:163], v51 offset:3072
    buffer_load_dwordx4 v44, s[28:31], s58 offen offset:1024 sc1 lds
    v_mul_f32 v42, 4.0, v42
    v_mul_f32_e64 v42, v42, v41
    v_fmamk_f32 v132, v41, 0x00000000, v42
    v_fmamk_f32 v133, v41, 0x3f800000, v42
    s_waitcnt lgkmcnt(2)
    v_mfma_f32_32x32x16_bf16 v[72:87], a[68:71], v[152:155], v[72:87]
    ds_read_b128 v[148:151], v51 offset:4096
    buffer_load_dwordx4 v44, s[28:31], s58 offen offset:2048 sc1 lds
    v_fmamk_f32 v134, v41, 0x40000000, v42
    v_fmamk_f32 v135, v41, 0x40400000, v42
    v_fmamk_f32 v136, v41, 0x41000000, v42
    v_fmamk_f32 v137, v41, 0x41100000, v42
    s_waitcnt lgkmcnt(2)
    v_mfma_f32_32x32x16_bf16 v[72:87], a[72:75], v[156:159], v[72:87]
    ds_read_b128 v[152:155], v51 offset:5120
    buffer_load_dwordx4 v44, s[28:31], s58 offen offset:3072 sc1 lds
    v_fmamk_f32 v138, v41, 0x41200000, v42
    v_fmamk_f32 v139, v41, 0x41300000, v42
    v_cos_f32 v4, v132
    s_waitcnt lgkmcnt(2)
    v_mfma_f32_32x32x16_bf16 v[72:87], a[76:79], v[160:163], v[72:87]
    ds_read_b128 v[156:159], v51 offset:6144
    v_cos_f32 v5, v133
    v_cos_f32 v6, v134
    v_cos_f32 v7, v135
    s_waitcnt lgkmcnt(2)
    v_mfma_f32_32x32x16_bf16 v[72:87], a[80:83], v[148:151], v[72:87]
    ds_read_b128 v[160:163], v51 offset:7168
    v_cos_f32 v8, v136
    v_cos_f32 v9, v137
    v_cos_f32 v10, v138
    s_waitcnt lgkmcnt(2)
    v_mfma_f32_32x32x16_bf16 v[72:87], a[84:87], v[152:155], v[72:87]
    s_waitcnt vmcnt(8)
    s_barrier
    buffer_load_dword v1, v3, s[20:23], 0 offen
    ds_read_b128 v[148:151], v51 offset:8192
    s_add_u32 m0, s47, 0
    s_add_u32 s58, s48, 688128
    buffer_load_dwordx4 v67, s[16:19], s58 offen offset:3072 lds
    s_waitcnt lgkmcnt(2)
    v_mfma_f32_32x32x16_bf16 v[72:87], a[88:91], v[156:159], v[72:87]
    ds_read_b128 v[152:155], v51 offset:9216
    v_cos_f32_e64 v11, v139
    v_cvt_pk_bf16_f32 v180, v4, v5
    v_cvt_pk_bf16_f32 v181, v6, v7
    v_cvt_pk_bf16_f32 v182, v8, v9
    v_cvt_pk_bf16_f32 v183, v10, v11
    v_xor_b32 v184, v91, v180
    s_waitcnt lgkmcnt(2)
    v_mfma_f32_32x32x16_bf16 v[72:87], a[92:95], v[160:163], v[72:87]
    ds_read_b128 v[156:159], v51 offset:10240
    v_xor_b32 v185, v91, v181
    v_xor_b32 v186, v91, v182
    v_xor_b32 v187, v91, v183
    v_sin_f32 v4, v132
    v_sin_f32 v5, v133
    s_waitcnt lgkmcnt(2)
    v_mfma_f32_32x32x16_bf16 v[72:87], a[96:99], v[148:151], v[72:87]
    ds_read_b128 v[160:163], v51 offset:11264
    s_add_u32 m0, s47, 16384
    s_add_u32 s58, s48, 802816
    buffer_load_dwordx4 v64, s[16:19], s58 offen offset:0 lds
    s_waitcnt lgkmcnt(2)
    v_mfma_f32_32x32x16_bf16 v[72:87], a[100:103], v[152:155], v[72:87]
    ds_read_b128 v[148:151], v51 offset:12288
    v_sin_f32 v6, v134
    v_sin_f32_e64 v7, v135
    v_sin_f32 v8, v136
    s_waitcnt lgkmcnt(2)
    v_mfma_f32_32x32x16_bf16 v[72:87], a[104:107], v[156:159], v[72:87]
    ds_read_b128 v[152:155], v51 offset:13312
    v_sin_f32 v9, v137
    v_sin_f32 v10, v138
    v_sin_f32_e64 v11, v139
    v_cvt_pk_bf16_f32 v188, v4, v5
    s_waitcnt lgkmcnt(2)
    v_mfma_f32_32x32x16_bf16 v[72:87], a[108:111], v[160:163], v[72:87]
    ds_read_b128 v[156:159], v51 offset:14336
    buffer_load_dwordx4 v65, s[16:19], s58 offen offset:1024 lds
    v_cvt_pk_bf16_f32 v189, v6, v7
    v_cvt_pk_bf16_f32 v190, v8, v9
    v_cvt_pk_bf16_f32 v191, v10, v11
    v_xor_b32_e64 v192, v91, v188
    s_waitcnt lgkmcnt(2)
    v_mfma_f32_32x32x16_bf16 v[72:87], a[112:115], v[148:151], v[72:87]
    ds_read_b128 v[160:163], v51 offset:15360
    v_xor_b32 v193, v91, v189
    v_xor_b32 v194, v91, v190
    v_xor_b32 v195, v91, v191
    s_waitcnt lgkmcnt(2)
    v_mfma_f32_32x32x16_bf16 v[72:87], a[116:119], v[152:155], v[72:87]
    s_waitcnt vmcnt(8)
    s_barrier
    ds_read_b128 v[148:151], v51 offset:16384
    s_waitcnt lgkmcnt(2)
    v_mfma_f32_32x32x16_bf16 v[72:87], a[120:123], v[156:159], v[72:87]
    ds_read_b128 v[152:155], v51 offset:17408
    buffer_load_dwordx4 v66, s[16:19], s58 offen offset:2048 lds
    s_waitcnt lgkmcnt(2)
    v_mfma_f32_32x32x16_bf16 v[72:87], a[124:127], v[160:163], v[72:87]
    ds_read_b128 v[156:159], v51 offset:18432
    s_waitcnt lgkmcnt(2)
    v_mfma_f32_32x32x16_bf16 v[72:87], a[128:131], v[148:151], v[72:87]
    ds_read_b128 v[160:163], v51 offset:19456
    s_waitcnt lgkmcnt(2)
    v_mfma_f32_32x32x16_bf16 v[72:87], a[132:135], v[152:155], v[72:87]
    ds_read_b128 v[148:151], v51 offset:20480
    buffer_load_dwordx4 v67, s[16:19], s58 offen offset:3072 lds
    s_waitcnt lgkmcnt(2)
    v_mfma_f32_32x32x16_bf16 v[72:87], a[136:139], v[156:159], v[72:87]
    ds_read_b128 v[152:155], v51 offset:21504
    ds_read_b64_tr_b16 a[64:65], v24 offset:49152
    ds_read_b64_tr_b16 a[66:67], v24 offset:50176
    s_waitcnt lgkmcnt(4)
    v_mfma_f32_32x32x16_bf16 v[72:87], a[140:143], v[160:163], v[72:87]
    ds_read_b128 v[156:159], v51 offset:22528
    ds_read_b64_tr_b16 a[68:69], v25 offset:49152
    ds_read_b64_tr_b16 a[70:71], v25 offset:50176
    s_waitcnt lgkmcnt(6)
    v_mfma_f32_32x32x16_bf16 v[72:87], a[144:147], v[148:151], v[72:87]
    ds_read_b128 v[160:163], v51 offset:23552
    s_add_u32 m0, s47, 32768
    s_add_u32 s58, s48, 917504
    buffer_load_dwordx4 v64, s[16:19], s58 offen offset:0 lds
    s_waitcnt lgkmcnt(6)
    v_mfma_f32_32x32x16_bf16 v[72:87], a[148:151], v[152:155], v[72:87]
    s_waitcnt vmcnt(7)
    s_barrier
    ds_read_b128 v[148:151], v51 offset:24576
    ds_read_b64_tr_b16 a[72:73], v24 offset:51200
    ds_read_b64_tr_b16 a[74:75], v24 offset:52224
    s_waitcnt lgkmcnt(6)
    v_mfma_f32_32x32x16_bf16 v[72:87], a[152:155], v[156:159], v[72:87]
    ds_read_b128 v[152:155], v51 offset:25600
    ds_read_b64_tr_b16 a[76:77], v25 offset:51200
    ds_read_b64_tr_b16 a[78:79], v25 offset:52224
    s_waitcnt lgkmcnt(6)
    v_mfma_f32_32x32x16_bf16 v[72:87], a[156:159], v[160:163], v[72:87]
    ds_read_b128 v[156:159], v51 offset:26624
    buffer_load_dwordx4 v65, s[16:19], s58 offen offset:1024 lds
    s_waitcnt lgkmcnt(6)
    v_mfma_f32_32x32x16_bf16 v[72:87], a[160:163], v[148:151], v[72:87]
    ds_read_b128 v[160:163], v51 offset:27648
    s_waitcnt lgkmcnt(4)
    v_mfma_f32_32x32x16_bf16 v[72:87], a[164:167], v[152:155], v[72:87]
    ds_read_b128 v[148:151], v51 offset:28672
    s_waitcnt lgkmcnt(2)
    v_mfma_f32_32x32x16_bf16 v[72:87], a[168:171], v[156:159], v[72:87]
    ds_read_b128 v[152:155], v51 offset:29696
    buffer_load_dwordx4 v66, s[16:19], s58 offen offset:2048 lds
    s_waitcnt lgkmcnt(2)
    v_mfma_f32_32x32x16_bf16 v[72:87], a[172:175], v[160:163], v[72:87]
    ds_read_b128 v[156:159], v51 offset:30720
    s_waitcnt lgkmcnt(2)
    v_mfma_f32_32x32x16_bf16 v[72:87], a[176:179], v[148:151], v[72:87]
    ds_read_b128 v[160:163], v51 offset:31744
    s_waitcnt lgkmcnt(2)
    v_mfma_f32_32x32x16_bf16 v[72:87], a[180:183], v[152:155], v[72:87]
    s_waitcnt lgkmcnt(1)
    v_mfma_f32_32x32x16_bf16 v[72:87], a[184:187], v[156:159], v[72:87]
    buffer_load_dwordx4 v67, s[16:19], s58 offen offset:3072 lds
    ds_read_b64_tr_b16 a[80:81], v26 offset:0
    ds_read_b64_tr_b16 a[82:83], v26 offset:1024
    s_waitcnt lgkmcnt(2)
    v_mfma_f32_32x32x16_bf16 v[72:87], a[188:191], v[160:163], v[72:87]
    ds_read_b64_tr_b16 a[84:85], v27 offset:0
    ds_read_b64_tr_b16 a[86:87], v27 offset:1024
    ds_read_b64_tr_b16 a[88:89], v26 offset:2048
    ds_read_b64_tr_b16 a[90:91], v26 offset:3072
    s_nop 7
    v_cvt_pk_bf16_f32 v12, v72, v73
    v_cvt_pk_bf16_f32 v13, v74, v75
    v_cvt_pk_bf16_f32 v14, v76, v77
    v_cvt_pk_bf16_f32 v15, v78, v79
    v_cvt_pk_bf16_f32 v16, v80, v81
    v_cvt_pk_bf16_f32 v17, v82, v83
    v_cvt_pk_bf16_f32 v18, v84, v85
    v_cvt_pk_bf16_f32 v19, v86, v87
    buffer_store_dwordx4 v[12:15], v51, s[28:31], s44 offen offset:0 sc1
    buffer_store_dwordx4 v[16:19], v51, s[28:31], s44 offen offset:1024 sc1
    v_dot2c_f32_bf16 v68, s61, v12
    v_dot2c_f32_bf16 v69, v12, v12
    v_dot2c_f32_bf16 v68, s61, v13
    v_dot2c_f32_bf16 v69, v13, v13
    v_dot2c_f32_bf16 v68, s61, v14
    v_dot2c_f32_bf16 v69, v14, v14
    v_dot2c_f32_bf16 v68, s61, v15
    v_dot2c_f32_bf16 v69, v15, v15
    v_dot2c_f32_bf16 v68, s61, v16
    v_dot2c_f32_bf16 v69, v16, v16
    v_dot2c_f32_bf16 v68, s61, v17
    v_dot2c_f32_bf16 v69, v17, v17
    v_dot2c_f32_bf16 v68, s61, v18
    v_dot2c_f32_bf16 v69, v18, v18
    v_dot2c_f32_bf16 v68, s61, v19
    v_dot2c_f32_bf16 v69, v19, v19
    s_nop 1
    v_mov_b32_e64 v148, v68
    v_mov_b32 v149, v69
    s_nop 0
    v_permlane32_swap_b32 v68, v148
    v_permlane32_swap_b32 v69, v149
    v_pk_add_f32 v[68:69], v[68:69], v[148:149]
    buffer_store_dwordx2 v[68:69], v43, s[28:31], s43 offen sc1
    s_add_u32 s41, s28, 17825408
    s_addc_u32 s42, s29, 0
    s_cmp_eq_u32 s37, 3
    s_cselect_b32 s20, s41, s20
    s_cselect_b32 s21, s42, s21
    s_lshl_b32 s41, s63, 7
    s_add_u32 s41, s41, 147456
    v_lshl_add_u32 v68, v47, 4, s41
    ds_read_b128 v[148:151], v68 offset:0
    ds_read_b128 v[152:155], v68 offset:32
    ds_read_b128 v[156:159], v68 offset:64
    ds_read_b128 v[160:163], v68 offset:96
    v_mfma_f32_32x32x16_bf16 v[212:227], v[168:171], v[108:111], v[212:227]
    s_add_u32 m0, s47, 49152
    s_add_u32 s58, s48, 1032192
    buffer_load_dwordx4 v64, s[16:19], s58 offen offset:0 lds
    v_cvt_pk_bf16_f32 v100, v116, v117
    v_cvt_pk_bf16_f32 v101, v118, v119
    v_mfma_f32_32x32x16_bf16 v[228:243], a[212:215], v[108:111], v[228:243]
    ds_read_b64_tr_b16 a[92:93], v27 offset:2048
    ds_read_b64_tr_b16 a[94:95], v27 offset:3072
    v_cvt_pk_bf16_f32 v102, v120, v121
    v_cvt_pk_bf16_f32 v103, v122, v123
    v_mfma_f32_32x32x16_bf16 v[212:227], v[200:203], v[112:115], v[212:227]
    s_waitcnt vmcnt(12)
    ds_read_b64_tr_b16 a[96:97], v24 offset:0
    ds_read_b64_tr_b16 a[98:99], v24 offset:1024
    v_xor_b32_dpp v104, v100, v144 quad_perm:[0,1,3,2] row_mask:0xf bank_mask:0xf
    v_xor_b32_dpp v105, v101, v144 quad_perm:[0,1,3,2] row_mask:0xf bank_mask:0xf
    v_mfma_f32_32x32x16_bf16 v[228:243], a[244:247], v[112:115], v[228:243]
    ds_read_b64_tr_b16 a[100:101], v25 offset:0
    ds_read_b64_tr_b16 a[102:103], v25 offset:1024
    v_xor_b32_dpp v106, v102, v144 quad_perm:[0,1,3,2] row_mask:0xf bank_mask:0xf
    v_xor_b32_dpp v107, v103, v144 quad_perm:[0,1,3,2] row_mask:0xf bank_mask:0xf
    v_mfma_f32_32x32x16_bf16 v[212:227], v[172:175], v[100:103], v[212:227]
    buffer_load_dwordx4 v65, s[16:19], s58 offen offset:1024 lds
    v_cvt_pk_bf16_f32 v108, v124, v125
    v_cvt_pk_bf16_f32 v109, v126, v127
    v_mfma_f32_32x32x16_bf16 v[228:243], a[216:219], v[100:103], v[228:243]
    ds_read_b64_tr_b16 a[104:105], v24 offset:2048
    ds_read_b64_tr_b16 a[106:107], v24 offset:3072
    v_cvt_pk_bf16_f32 v110, v128, v129
    v_cvt_pk_bf16_f32 v111, v130, v131
    v_mfma_f32_32x32x16_bf16 v[212:227], v[204:207], v[104:107], v[212:227]
    ds_read_b64_tr_b16 a[108:109], v25 offset:2048
    ds_read_b64_tr_b16 a[110:111], v25 offset:3072
    v_xor_b32_dpp v112, v108, v144 quad_perm:[0,1,3,2] row_mask:0xf bank_mask:0xf
    v_xor_b32_dpp v113, v109, v144 quad_perm:[0,1,3,2] row_mask:0xf bank_mask:0xf
    v_mfma_f32_32x32x16_bf16 v[228:243], a[248:251], v[104:107], v[228:243]
    s_waitcnt vmcnt(9)
    ds_read_b64_tr_b16 a[112:113], v24 offset:16384
    ds_read_b64_tr_b16 a[114:115], v24 offset:17408
    v_xor_b32_dpp v114, v110, v144 quad_perm:[0,1,3,2] row_mask:0xf bank_mask:0xf
    v_xor_b32_dpp v115, v111, v144 quad_perm:[0,1,3,2] row_mask:0xf bank_mask:0xf
    v_mfma_f32_32x32x16_bf16 v[212:227], v[176:179], v[108:111], v[212:227]
    buffer_load_dwordx4 v66, s[16:19], s58 offen offset:2048 lds
    v_mfma_f32_32x32x16_bf16 v[228:243], a[220:223], v[108:111], v[228:243]
    ds_read_b64_tr_b16 a[116:117], v25 offset:16384
    ds_read_b64_tr_b16 a[118:119], v25 offset:17408
    v_mfma_f32_32x32x16_bf16 v[212:227], v[208:211], v[112:115], v[212:227]
    ds_read_b64_tr_b16 a[120:121], v24 offset:18432
    ds_read_b64_tr_b16 a[122:123], v24 offset:19456
    v_mfma_f32_32x32x16_bf16 v[228:243], a[252:255], v[112:115], v[228:243]
    ds_read_b64_tr_b16 a[124:125], v25 offset:18432
    ds_read_b64_tr_b16 a[126:127], v25 offset:19456
    buffer_load_dwordx4 v67, s[16:19], s58 offen offset:3072 lds
    v_mov_b32 v32, 0
    v_mov_b32_e64 v33, 0
    v_add_u32 v30, 14336, v28
    v_add_u32 v31, 21504, v28
    s_mov_b32 s26, 2097152
    s_mov_b32 s27, 0x20000
    s_bfe_i32 s57, s37, 0x10002
    s_or_b32 s57, s57, 1
    s_nop 0
    v_pk_fma_f32 v[212:213], v[228:229], v[90:91], v[212:213] op_sel_hi:[1,0,1]
    v_pk_fma_f32 v[214:215], v[230:231], v[90:91], v[214:215] op_sel_hi:[1,0,1]
    v_pk_fma_f32 v[216:217], v[232:233], v[90:91], v[216:217] op_sel_hi:[1,0,1]
    v_pk_fma_f32 v[218:219], v[234:235], v[90:91], v[218:219] op_sel_hi:[1,0,1]
    v_pk_fma_f32 v[220:221], v[236:237], v[90:91], v[220:221] op_sel_hi:[1,0,1]
    v_pk_fma_f32 v[222:223], v[238:239], v[90:91], v[222:223] op_sel_hi:[1,0,1]
    v_pk_fma_f32 v[224:225], v[240:241], v[90:91], v[224:225] op_sel_hi:[1,0,1]
    v_pk_fma_f32 v[226:227], v[242:243], v[90:91], v[226:227] op_sel_hi:[1,0,1]
    s_waitcnt lgkmcnt(15)
    v_pk_mul_f32 v[212:213], v[212:213], v[148:149]
    v_pk_mul_f32 v[214:215], v[214:215], v[150:151]
    s_waitcnt lgkmcnt(15)
    v_pk_mul_f32 v[216:217], v[216:217], v[152:153]
    v_pk_mul_f32 v[218:219], v[218:219], v[154:155]
    s_waitcnt lgkmcnt(15)
    v_pk_mul_f32 v[220:221], v[220:221], v[156:157]
    v_pk_mul_f32 v[222:223], v[222:223], v[158:159]
    s_waitcnt lgkmcnt(15)
    v_pk_mul_f32 v[224:225], v[224:225], v[160:161]
    v_pk_mul_f32 v[226:227], v[226:227], v[162:163]
    v_cvt_pk_bf16_f32 v100, v212, v213
    s_waitcnt vmcnt(7)
    ds_read_b64_tr_b16 a[128:129], v24 offset:32768
    ds_read_b64_tr_b16 a[130:131], v24 offset:33792
    s_add_u32 m0, s47, 65536
    s_add_u32 s58, s48, 1146880
    s_waitcnt lgkmcnt(15)
    buffer_load_dwordx4 v64, s[16:19], s58 offen offset:0 lds
    v_cvt_pk_bf16_f32 v101, v214, v215
    v_cvt_pk_bf16_f32 v102, v216, v217
    v_cvt_pk_bf16_f32 v103, v218, v219
    v_cvt_pk_bf16_f32 v104, v220, v221
    v_cvt_pk_bf16_f32 v105, v222, v223
    v_cvt_pk_bf16_f32 v106, v224, v225
    v_cvt_pk_bf16_f32 v107, v226, v227
    v_xor_b32_dpp v108, v100, v91 quad_perm:[1,0,3,2] row_mask:0xf bank_mask:0xf
    v_xor_b32_dpp v109, v101, v91 quad_perm:[1,0,3,2] row_mask:0xf bank_mask:0xf
    v_xor_b32_dpp v110, v102, v91 quad_perm:[1,0,3,2] row_mask:0xf bank_mask:0xf
    v_xor_b32_dpp v111, v103, v91 quad_perm:[1,0,3,2] row_mask:0xf bank_mask:0xf
    v_xor_b32_dpp v112, v104, v91 quad_perm:[1,0,3,2] row_mask:0xf bank_mask:0xf
    v_xor_b32_dpp v113, v105, v91 quad_perm:[1,0,3,2] row_mask:0xf bank_mask:0xf
    v_xor_b32_dpp v114, v106, v91 quad_perm:[1,0,3,2] row_mask:0xf bank_mask:0xf
    v_xor_b32_dpp v115, v107, v91 quad_perm:[1,0,3,2] row_mask:0xf bank_mask:0xf
    v_mfma_f32_32x32x16_bf16 v[148:163], v[100:103], v[180:183], 0
    s_lshl_b32 s41, s3, 7
    ds_read_b64_tr_b16 a[132:133], v25 offset:32768
    ds_read_b64_tr_b16 a[134:135], v25 offset:33792
    buffer_load_dwordx4 v65, s[16:19], s58 offen offset:1024 lds
    s_lshl2_add_u32 s41, s63, s41
    s_add_u32 s41, s41, 36864
    v_xor_b32_e64 v41, v47, v46
    v_lshl_add_u32 v41, v41, 4, s41
    v_lshl_add_u32 v132, v48, 8, v41
    v_mfma_f32_32x32x16_bf16 v[148:163], v[104:107], v[184:187], v[148:163]
    v_xor_b32 v133, 32, v132
    v_xor_b32 v134, 64, v132
    v_xor_b32 v135, 96, v132
    s_lshl_b32 s41, s38, 11
    s_add_u32 s41, s41, 36864
    v_xor_b32 v41, v50, v0
    v_mfma_f32_32x32x16_bf16 v[148:163], v[108:111], v[188:191], v[148:163]
    v_lshl_add_u32 v137, v41, 4, s41
    v_xor_b32_e64 v138, 64, v137
    v_mul_u32_u24 v41, 73728, v50
    v_lshl_add_u32 v136, v49, 4, v41
    s_mul_i32 s41, s38, 589824
    s_mul_i32 s42, s36, 2304
    ds_read_b64_tr_b16 a[136:137], v24 offset:34816
    ds_read_b64_tr_b16 a[138:139], v24 offset:35840
    buffer_load_dwordx4 v66, s[16:19], s58 offen offset:2048 lds
    v_mfma_f32_32x32x16_bf16 v[148:163], v[112:115], v[192:195], v[148:163]
    s_add_u32 s41, s41, s42
    s_lshl_b32 s42, s37, 8
    s_add_u32 s41, s41, s42
    s_add_u32 s45, s41, 5505024
    s_add_u32 s46, s45, 294912
    s_mul_i32 s53, s36, 229376
    s_add_u32 s53, s53, 8388608
    s_add_u32 s62, s62, s53
    s_lshl_b32 s41, s38, 16
    s_add_u32 s49, s50, s41
    s_add_u32 s50, s49, 196608
    s_mul_i32 s41, s37, 196608
    s_add_u32 s51, s49, s41
    v_mov_b32 v43, v136
    v_mov_b32 v68, v137
    v_mov_b32 v69, v138
    v_cvt_pk_bf16_f32 v4, v148, v149
    v_cvt_pk_bf16_f32 v5, v150, v151
    v_cvt_pk_bf16_f32 v6, v152, v153
    v_cvt_pk_bf16_f32 v7, v154, v155
    ds_read_b64_tr_b16 a[140:141], v25 offset:34816
    ds_read_b64_tr_b16 a[142:143], v25 offset:35840
    buffer_load_dwordx4 v67, s[16:19], s58 offen offset:3072 lds
    v_cvt_pk_bf16_f32 v8, v156, v157
    v_cvt_pk_bf16_f32 v9, v158, v159
    v_cvt_pk_bf16_f32 v10, v160, v161
    v_cvt_pk_bf16_f32 v11, v162, v163
    s_add_u32 m0, s47, 0
    s_add_u32 s58, s48, 1261568
    s_waitcnt lgkmcnt(15)
    buffer_load_dwordx4 v64, s[16:19], s58 offen offset:0 lds
    buffer_load_dwordx4 v65, s[16:19], s58 offen offset:1024 lds
    s_waitcnt vmcnt(10)
    s_waitcnt lgkmcnt(0)
    s_barrier
    ds_write2_b32 v132, v4, v5 offset0:0 offset1:2
    ds_write2_b32 v133, v6, v7 offset0:0 offset1:2
    ds_write2_b32 v134, v8, v9 offset0:0 offset1:2
    ds_write2_b32 v135, v10, v11 offset0:0 offset1:2
    buffer_load_dwordx4 v66, s[16:19], s58 offen offset:2048 lds
    buffer_load_dwordx4 v67, s[16:19], s58 offen offset:3072 lds
    s_add_u32 m0, s47, 16384
    s_add_u32 s58, s48, 1376256
    buffer_load_dwordx4 v64, s[16:19], s58 offen offset:0 lds
    buffer_load_dwordx4 v65, s[16:19], s58 offen offset:1024 lds
    buffer_load_dwordx4 v66, s[16:19], s58 offen offset:2048 lds
    buffer_load_dwordx4 v67, s[16:19], s58 offen offset:3072 lds
    s_add_u32 m0, s47, 32768
    s_add_u32 s58, s48, 1490944
    buffer_load_dwordx4 v64, s[16:19], s58 offen offset:0 lds
    buffer_load_dwordx4 v65, s[16:19], s58 offen offset:1024 lds
    buffer_load_dwordx4 v66, s[16:19], s58 offen offset:2048 lds
    s_waitcnt vmcnt(15)
    v_mfma_f32_16x16x32_bf16 v[56:59], v[52:55], a[8:11], v[56:59]
    ds_read_b64_tr_b16 a[144:145], v24 offset:49152
    v_mfma_f32_16x16x32_bf16 v[60:63], v[52:55], a[12:15], v[60:63]
    ds_read_b64_tr_b16 a[146:147], v24 offset:50176
    buffer_load_dwordx4 v67, s[16:19], s58 offen offset:3072 lds
    v_mfma_f32_16x16x32_bf16 v[56:59], v[52:55], a[16:19], v[56:59]
    ds_read_b64_tr_b16 a[148:149], v25 offset:49152
    v_mfma_f32_16x16x32_bf16 v[60:63], v[52:55], a[20:23], v[60:63]
    ds_read_b64_tr_b16 a[150:151], v25 offset:50176
    v_mfma_f32_16x16x32_bf16 v[56:59], v[52:55], a[24:27], v[56:59]
    ds_read_b64_tr_b16 a[152:153], v24 offset:51200
    v_mfma_f32_16x16x32_bf16 v[60:63], v[52:55], a[28:31], v[60:63]
    ds_read_b64_tr_b16 a[154:155], v24 offset:52224
    v_mfma_f32_16x16x32_bf16 v[56:59], v[52:55], a[32:35], v[56:59]
    ds_read_b64_tr_b16 a[156:157], v25 offset:51200
    v_mfma_f32_16x16x32_bf16 v[60:63], v[52:55], a[36:39], v[60:63]
    ds_read_b64_tr_b16 a[158:159], v25 offset:52224
    s_add_u32 m0, s47, 49152
    s_add_u32 s58, s48, 1605632
    s_waitcnt lgkmcnt(0)
    buffer_load_dwordx4 v64, s[16:19], s58 offen offset:0 lds
    buffer_load_dwordx4 v65, s[16:19], s58 offen offset:1024 lds
    buffer_load_dwordx4 v66, s[16:19], s58 offen offset:2048 lds
    s_waitcnt vmcnt(15)
    v_mfma_f32_16x16x32_bf16 v[56:59], v[52:55], a[40:43], v[56:59]
    ds_read_b64_tr_b16 a[160:161], v26 offset:0
    v_mfma_f32_16x16x32_bf16 v[60:63], v[52:55], a[44:47], v[60:63]
    ds_read_b64_tr_b16 a[162:163], v26 offset:1024
    buffer_load_dwordx4 v67, s[16:19], s58 offen offset:3072 lds
    v_mfma_f32_16x16x32_bf16 v[56:59], v[52:55], a[48:51], v[56:59]
    ds_read_b64_tr_b16 a[164:165], v27 offset:0
    v_mfma_f32_16x16x32_bf16 v[60:63], v[52:55], a[52:55], v[60:63]
    ds_read_b64_tr_b16 a[166:167], v27 offset:1024
    v_mfma_f32_16x16x32_bf16 v[56:59], v[52:55], a[56:59], v[56:59]
    ds_read_b64_tr_b16 a[168:169], v26 offset:2048
    v_mfma_f32_16x16x32_bf16 v[60:63], v[52:55], a[60:63], v[60:63]
    ds_read_b64_tr_b16 a[170:171], v26 offset:3072
    v_mfma_f32_16x16x32_bf16 v[56:59], v[52:55], a[64:67], v[56:59]
    ds_read_b64_tr_b16 a[172:173], v27 offset:2048
    v_mfma_f32_16x16x32_bf16 v[60:63], v[52:55], a[68:71], v[60:63]
    ds_read_b64_tr_b16 a[174:175], v27 offset:3072
    s_add_u32 m0, s47, 65536
    s_add_u32 s58, s48, 1720320
    s_waitcnt lgkmcnt(0)
    buffer_load_dwordx4 v64, s[16:19], s58 offen offset:0 lds
    buffer_load_dwordx4 v65, s[16:19], s58 offen offset:1024 lds
    buffer_load_dwordx4 v66, s[16:19], s58 offen offset:2048 lds
    s_waitcnt vmcnt(15)
    v_mfma_f32_16x16x32_bf16 v[56:59], v[52:55], a[72:75], v[56:59]
    ds_read_b64_tr_b16 a[176:177], v24 offset:0
    v_mfma_f32_16x16x32_bf16 v[60:63], v[52:55], a[76:79], v[60:63]
    ds_read_b64_tr_b16 a[178:179], v24 offset:1024
    buffer_load_dwordx4 v67, s[16:19], s58 offen offset:3072 lds
    v_mfma_f32_16x16x32_bf16 v[56:59], v[52:55], a[80:83], v[56:59]
    ds_read_b64_tr_b16 a[180:181], v25 offset:0
    v_mfma_f32_16x16x32_bf16 v[60:63], v[52:55], a[84:87], v[60:63]
    ds_read_b64_tr_b16 a[182:183], v25 offset:1024
    v_mfma_f32_16x16x32_bf16 v[56:59], v[52:55], a[88:91], v[56:59]
    ds_read_b64_tr_b16 a[184:185], v24 offset:2048
    v_mfma_f32_16x16x32_bf16 v[60:63], v[52:55], a[92:95], v[60:63]
    ds_read_b64_tr_b16 a[186:187], v24 offset:3072
    v_mfma_f32_16x16x32_bf16 v[56:59], v[52:55], a[96:99], v[56:59]
    ds_read_b64_tr_b16 a[188:189], v25 offset:2048
    v_mfma_f32_16x16x32_bf16 v[60:63], v[52:55], a[100:103], v[60:63]
    ds_read_b64_tr_b16 a[190:191], v25 offset:3072
    s_waitcnt vmcnt(12)
    v_mfma_f32_16x16x32_bf16 v[56:59], v[52:55], a[104:107], v[56:59]
    ds_read_b64_tr_b16 a[192:193], v24 offset:16384
    v_mfma_f32_16x16x32_bf16 v[60:63], v[52:55], a[108:111], v[60:63]
    ds_read_b64_tr_b16 a[194:195], v24 offset:17408
    v_mfma_f32_16x16x32_bf16 v[56:59], v[52:55], a[112:115], v[56:59]
    ds_read_b64_tr_b16 a[196:197], v25 offset:16384
    v_mfma_f32_16x16x32_bf16 v[60:63], v[52:55], a[116:119], v[60:63]
    ds_read_b64_tr_b16 a[198:199], v25 offset:17408
    v_mfma_f32_16x16x32_bf16 v[56:59], v[52:55], a[120:123], v[56:59]
    ds_read_b64_tr_b16 a[200:201], v24 offset:18432
    v_mfma_f32_16x16x32_bf16 v[60:63], v[52:55], a[124:127], v[60:63]
    ds_read_b64_tr_b16 a[202:203], v24 offset:19456
    v_mfma_f32_16x16x32_bf16 v[56:59], v[52:55], a[128:131], v[56:59]
    ds_read_b64_tr_b16 a[204:205], v25 offset:18432
    v_mfma_f32_16x16x32_bf16 v[60:63], v[52:55], a[132:135], v[60:63]
    ds_read_b64_tr_b16 a[206:207], v25 offset:19456
    s_waitcnt vmcnt(8)
    v_mfma_f32_16x16x32_bf16 v[56:59], v[52:55], a[136:139], v[56:59]
    ds_read_b64_tr_b16 a[208:209], v24 offset:32768
    v_mfma_f32_16x16x32_bf16 v[60:63], v[52:55], a[140:143], v[60:63]
    ds_read_b64_tr_b16 a[210:211], v24 offset:33792
    v_mfma_f32_16x16x32_bf16 v[56:59], v[52:55], a[144:147], v[56:59]
    ds_read_b64_tr_b16 a[212:213], v25 offset:32768
    v_mfma_f32_16x16x32_bf16 v[60:63], v[52:55], a[148:151], v[60:63]
    ds_read_b64_tr_b16 a[214:215], v25 offset:33792
    v_mfma_f32_16x16x32_bf16 v[56:59], v[52:55], a[152:155], v[56:59]
    ds_read_b64_tr_b16 a[216:217], v24 offset:34816
    v_mfma_f32_16x16x32_bf16 v[60:63], v[52:55], a[156:159], v[60:63]
    ds_read_b64_tr_b16 a[218:219], v24 offset:35840
    v_mfma_f32_16x16x32_bf16 v[56:59], v[52:55], a[160:163], v[56:59]
    ds_read_b64_tr_b16 a[220:221], v25 offset:34816
    v_mfma_f32_16x16x32_bf16 v[60:63], v[52:55], a[164:167], v[60:63]
    ds_read_b64_tr_b16 a[222:223], v25 offset:35840
    s_waitcnt vmcnt(4)
    v_mfma_f32_16x16x32_bf16 v[56:59], v[52:55], a[168:171], v[56:59]
    ds_read_b64_tr_b16 a[224:225], v24 offset:49152
    v_mfma_f32_16x16x32_bf16 v[60:63], v[52:55], a[172:175], v[60:63]
    ds_read_b64_tr_b16 a[226:227], v24 offset:50176
    s_waitcnt lgkmcnt(15)
    v_mfma_f32_16x16x32_bf16 v[56:59], v[52:55], a[176:179], v[56:59]
    ds_read_b64_tr_b16 a[228:229], v25 offset:49152
    s_waitcnt lgkmcnt(15)
    v_mfma_f32_16x16x32_bf16 v[60:63], v[52:55], a[180:183], v[60:63]
    ds_read_b64_tr_b16 a[230:231], v25 offset:50176
    s_waitcnt lgkmcnt(15)
    v_mfma_f32_16x16x32_bf16 v[56:59], v[52:55], a[184:187], v[56:59]
    ds_read_b64_tr_b16 a[232:233], v24 offset:51200
    s_waitcnt lgkmcnt(15)
    v_mfma_f32_16x16x32_bf16 v[60:63], v[52:55], a[188:191], v[60:63]
    ds_read_b64_tr_b16 a[234:235], v24 offset:52224
    s_waitcnt lgkmcnt(15)
    v_mfma_f32_16x16x32_bf16 v[56:59], v[52:55], a[192:195], v[56:59]
    ds_read_b64_tr_b16 a[236:237], v25 offset:51200
    s_waitcnt lgkmcnt(15)
    v_mfma_f32_16x16x32_bf16 v[60:63], v[52:55], a[196:199], v[60:63]
    ds_read_b64_tr_b16 a[238:239], v25 offset:52224
    s_waitcnt vmcnt(0)
    s_waitcnt lgkmcnt(15)
    v_mfma_f32_16x16x32_bf16 v[56:59], v[52:55], a[200:203], v[56:59]
    ds_read_b64_tr_b16 a[240:241], v26 offset:0
    s_waitcnt lgkmcnt(15)
    v_mfma_f32_16x16x32_bf16 v[60:63], v[52:55], a[204:207], v[60:63]
    ds_read_b64_tr_b16 a[242:243], v26 offset:1024
    s_waitcnt lgkmcnt(15)
    v_mfma_f32_16x16x32_bf16 v[56:59], v[52:55], a[208:211], v[56:59]
    ds_read_b64_tr_b16 a[244:245], v27 offset:0
    s_waitcnt lgkmcnt(15)
    v_mfma_f32_16x16x32_bf16 v[60:63], v[52:55], a[212:215], v[60:63]
    ds_read_b64_tr_b16 a[246:247], v27 offset:1024
    s_waitcnt lgkmcnt(14)
    v_mfma_f32_16x16x32_bf16 v[56:59], v[52:55], a[216:219], v[56:59]
    ds_read_b64_tr_b16 a[248:249], v26 offset:2048
    s_waitcnt lgkmcnt(13)
    v_mfma_f32_16x16x32_bf16 v[60:63], v[52:55], a[220:223], v[60:63]
    ds_read_b64_tr_b16 a[250:251], v26 offset:3072
    s_waitcnt lgkmcnt(12)
    v_mfma_f32_16x16x32_bf16 v[56:59], v[52:55], a[224:227], v[56:59]
    ds_read_b64_tr_b16 a[252:253], v27 offset:2048
    s_waitcnt lgkmcnt(11)
    v_mfma_f32_16x16x32_bf16 v[60:63], v[52:55], a[228:231], v[60:63]
    ds_read_b64_tr_b16 a[254:255], v27 offset:3072
    s_waitcnt lgkmcnt(10)
    v_mfma_f32_16x16x32_bf16 v[56:59], v[52:55], a[232:235], v[56:59]
    s_waitcnt lgkmcnt(8)
    v_mfma_f32_16x16x32_bf16 v[60:63], v[52:55], a[236:239], v[60:63]
    s_waitcnt lgkmcnt(6)
    v_mfma_f32_16x16x32_bf16 v[56:59], v[52:55], a[240:243], v[56:59]
    s_waitcnt lgkmcnt(4)
    v_mfma_f32_16x16x32_bf16 v[60:63], v[52:55], a[244:247], v[60:63]
    s_waitcnt lgkmcnt(2)
    v_mfma_f32_16x16x32_bf16 v[56:59], v[52:55], a[248:251], v[56:59]
    s_waitcnt lgkmcnt(0)
    v_mfma_f32_16x16x32_bf16 v[60:63], v[52:55], a[252:255], v[60:63]
    s_nop 5
    v_cvt_pk_bf16_f32 v41, v56, v56
    v_and_b32 v41, 0xffff0000, v41
    v_sub_f32 v42, v56, v41
    v_cvt_pk_bf16_f32 v20, v41, v42
    v_and_b32 v21, 0xffff0000, v20
    v_sub_f32_e64 v42, v42, v21
    v_cvt_pk_bf16_f32 v21, v42, v41
    v_cvt_pk_bf16_f32 v41, v60, v60
    v_and_b32 v41, 0xffff0000, v41
    v_sub_f32_e64 v42, v60, v41
    v_cvt_pk_bf16_f32 v22, v41, v42
    v_and_b32 v23, 0xffff0000, v22
    v_sub_f32_e64 v42, v42, v23
    v_cvt_pk_bf16_f32 v23, v42, v41
    s_barrier
    ds_read_b128 v[232:235], v44 offset:0
    ds_read_b128 v[236:239], v44 offset:1024
    ds_read_b128 v[240:243], v44 offset:2048
    s_waitcnt lgkmcnt(2)
    v_mfma_f32_32x32x16_bf16 v[168:183], a[0:3], v[232:235], 0
    ds_read_b128 v[12:15], v68 offset:0
    ds_read_b128 v[16:19], v69 offset:1024
    v_lshlrev_b32_e64 v41, 3, v0
    v_add_u32 v41, 147456, v41
    v_mfma_f32_32x32x16_bf16 v[184:199], a[4:7], v[232:235], 0
    ds_read_b128 v[244:247], v44 offset:3072
    s_waitcnt lgkmcnt(4)
    v_mfma_f32_32x32x16_bf16 v[168:183], a[8:11], v[236:239], v[168:183]
    v_mfma_f32_32x32x16_bf16 v[184:199], a[12:15], v[236:239], v[184:199]
    ds_read_b128 v[232:235], v44 offset:4096
    s_waitcnt lgkmcnt(4)
    v_mfma_f32_32x32x16_bf16 v[168:183], a[16:19], v[240:243], v[168:183]
    s_waitcnt lgkmcnt(2)
    s_cmp_lg_u32 s37, 0
    s_cbranch_scc1 Lj0_4
    v_mov_b32 v68, 1073741824
    v_cmp_gt_u32 vcc, 8, v49
    s_nop 1
    v_cndmask_b32 v68, v68, v43, vcc
    v_cmp_eq_u32 vcc, 0, v49
    buffer_store_dwordx4 v[12:15], v68, s[28:31], s45 offen offset:2048 sc1
    buffer_store_dwordx4 v[16:19], v68, s[28:31], s46 offen offset:2048 sc1
    s_nop 0
    v_cndmask_b32 v12, v12, 0, vcc
    v_cndmask_b32 v13, v13, 0, vcc
    v_cndmask_b32 v16, v16, 0, vcc
    v_cndmask_b32 v17, v17, 0, vcc
Lj0_4:
    v_mfma_f32_32x32x16_bf16 v[184:199], a[20:23], v[240:243], v[184:199]
    ds_read_b128 v[236:239], v44 offset:5120
    s_waitcnt lgkmcnt(2)
    v_mfma_f32_32x32x16_bf16 v[168:183], a[24:27], v[244:247], v[168:183]
    v_mfma_f32_32x32x16_bf16 v[184:199], a[28:31], v[244:247], v[184:199]
    ds_read_b128 v[240:243], v44 offset:6144
    s_waitcnt lgkmcnt(2)
    v_mfma_f32_32x32x16_bf16 v[168:183], a[32:35], v[232:235], v[168:183]
    v_mfma_f32_32x32x16_bf16 v[184:199], a[36:39], v[232:235], v[184:199]
    ds_read_b128 v[244:247], v44 offset:7168
    s_waitcnt lgkmcnt(2)
    v_mfma_f32_32x32x16_bf16 v[168:183], a[40:43], v[236:239], v[168:183]
    v_mfma_f32_32x32x16_bf16 v[184:199], a[44:47], v[236:239], v[184:199]
    ds_read_b128 v[232:235], v44 offset:8192
    s_waitcnt lgkmcnt(2)
    v_mfma_f32_32x32x16_bf16 v[168:183], a[48:51], v[240:243], v[168:183]
    v_mfma_f32_32x32x16_bf16 v[184:199], a[52:55], v[240:243], v[184:199]
    ds_read_b128 v[236:239], v44 offset:9216
    s_waitcnt lgkmcnt(2)
    v_mfma_f32_32x32x16_bf16 v[168:183], a[56:59], v[244:247], v[168:183]
    v_mfma_f32_32x32x16_bf16 v[184:199], a[60:63], v[244:247], v[184:199]
    ds_read_b128 v[240:243], v44 offset:10240
    s_waitcnt lgkmcnt(2)
    v_mfma_f32_32x32x16_bf16 v[168:183], a[64:67], v[232:235], v[168:183]
    v_mfma_f32_32x32x16_bf16 v[184:199], a[68:71], v[232:235], v[184:199]
    ds_read_b128 v[244:247], v44 offset:11264
    s_waitcnt lgkmcnt(2)
    v_mfma_f32_32x32x16_bf16 v[168:183], a[72:75], v[236:239], v[168:183]
    buffer_store_dwordx4 v[12:15], v43, s[28:31], s45 offen sc1
    v_mfma_f32_32x32x16_bf16 v[184:199], a[76:79], v[236:239], v[184:199]
    ds_read_b128 v[232:235], v44 offset:12288
    s_waitcnt lgkmcnt(2)
    v_mfma_f32_32x32x16_bf16 v[168:183], a[80:83], v[240:243], v[168:183]
    buffer_store_dwordx4 v[16:19], v43, s[28:31], s46 offen sc1
    v_mfma_f32_32x32x16_bf16 v[184:199], a[84:87], v[240:243], v[184:199]
    ds_read_b128 v[236:239], v44 offset:13312
    s_waitcnt lgkmcnt(2)
    v_mfma_f32_32x32x16_bf16 v[168:183], a[88:91], v[244:247], v[168:183]
    s_add_u32 m0, s47, 0
    s_cmp_le_u32 s37, 0
    s_cselect_b32 s58, s50, s49
    s_add_u32 s58, s58, 0
    buffer_load_dwordx4 v28, s[20:23], s58 offen offset:0 sc1 lds
    v_mfma_f32_32x32x16_bf16 v[184:199], a[92:95], v[244:247], v[184:199]
    ds_read_b128 v[240:243], v44 offset:14336
    buffer_load_dwordx4 v29, s[20:23], s58 offen offset:1024 sc1 lds
    s_waitcnt lgkmcnt(2)
    v_mfma_f32_32x32x16_bf16 v[168:183], a[96:99], v[232:235], v[168:183]
    v_mfma_f32_32x32x16_bf16 v[184:199], a[100:103], v[232:235], v[184:199]
    ds_read_b128 v[244:247], v44 offset:15360
    buffer_load_dwordx4 v30, s[20:23], s58 offen offset:2048 sc1 lds
    s_waitcnt lgkmcnt(2)
    v_mfma_f32_32x32x16_bf16 v[168:183], a[104:107], v[236:239], v[168:183]
    v_mfma_f32_32x32x16_bf16 v[184:199], a[108:111], v[236:239], v[184:199]
    s_barrier
    ds_read_b128 v[232:235], v44 offset:16384
    buffer_load_dwordx4 v31, s[20:23], s58 offen offset:3072 sc1 lds
    ds_read_b64 v[200:201], v41 offset:0
    s_waitcnt lgkmcnt(3)
    v_mfma_f32_32x32x16_bf16 v[168:183], a[112:115], v[240:243], v[168:183]
    ds_read_b64 v[216:217], v41 offset:4096
    ds_read_b64 v[202:203], v41 offset:512
    ds_read_b64 v[218:219], v41 offset:4608
    ds_read_b64 v[204:205], v41 offset:1024
    v_mfma_f32_32x32x16_bf16 v[184:199], a[116:119], v[240:243], v[184:199]
    ds_read_b128 v[236:239], v44 offset:17408
    ds_read_b64 v[220:221], v41 offset:5120
    ds_read_b64 v[206:207], v41 offset:1536
    ds_read_b64 v[222:223], v41 offset:5632
    s_waitcnt lgkmcnt(10)
    v_mfma_f32_32x32x16_bf16 v[168:183], a[120:123], v[244:247], v[168:183]
    s_add_u32 m0, s47, 16384
    s_cmp_le_u32 s37, 0
    s_cselect_b32 s58, s50, s49
    s_add_u32 s58, s58, 32768
    buffer_load_dwordx4 v28, s[20:23], s58 offen offset:0 sc1 lds
    v_mfma_f32_32x32x16_bf16 v[184:199], a[124:127], v[244:247], v[184:199]
    ds_read_b128 v[240:243], v44 offset:18432
    buffer_load_dwordx4 v29, s[20:23], s58 offen offset:1024 sc1 lds
    ds_read_b64 v[208:209], v41 offset:2048
    s_waitcnt lgkmcnt(11)
    v_mfma_f32_32x32x16_bf16 v[168:183], a[128:131], v[232:235], v[168:183]
    ds_read_b64 v[224:225], v41 offset:6144
    ds_read_b64 v[210:211], v41 offset:2560
    ds_read_b64 v[226:227], v41 offset:6656
    ds_read_b64 v[212:213], v41 offset:3072
    v_mfma_f32_32x32x16_bf16 v[184:199], a[132:135], v[232:235], v[184:199]
    ds_read_b128 v[244:247], v44 offset:19456
    buffer_load_dwordx4 v30, s[20:23], s58 offen offset:2048 sc1 lds
    ds_read_b64 v[228:229], v41 offset:7168
    s_waitcnt lgkmcnt(11)
    v_mfma_f32_32x32x16_bf16 v[168:183], a[136:139], v[236:239], v[168:183]
    ds_read_b64 v[214:215], v41 offset:3584
    ds_read_b64 v[230:231], v41 offset:7680
    v_mfma_f32_32x32x16_bf16 v[184:199], a[140:143], v[236:239], v[184:199]
    ds_read_b128 v[232:235], v44 offset:20480
    buffer_load_dwordx4 v31, s[20:23], s58 offen offset:3072 sc1 lds
    s_waitcnt lgkmcnt(10)
    v_mfma_f32_32x32x16_bf16 v[168:183], a[144:147], v[240:243], v[168:183]
    v_mfma_f32_32x32x16_bf16 v[184:199], a[148:151], v[240:243], v[184:199]
    ds_read_b128 v[236:239], v44 offset:21504
    s_waitcnt lgkmcnt(5)
    v_mfma_f32_32x32x16_bf16 v[168:183], a[152:155], v[244:247], v[168:183]
    s_add_u32 m0, s47, 32768
    s_cmp_le_u32 s37, 1
    s_cselect_b32 s58, s50, s49
    s_add_u32 s58, s58, 196608
    buffer_load_dwordx4 v28, s[20:23], s58 offen offset:0 sc1 lds
    v_mfma_f32_32x32x16_bf16 v[184:199], a[156:159], v[244:247], v[184:199]
    ds_read_b128 v[240:243], v44 offset:22528
    buffer_load_dwordx4 v29, s[20:23], s58 offen offset:1024 sc1 lds
    v_add_f32 v200, v200, v216
    v_add_f32_e64 v201, v201, v217
    v_add_f32 v202, v202, v218
    s_waitcnt lgkmcnt(2)
    v_mfma_f32_32x32x16_bf16 v[168:183], a[160:163], v[232:235], v[168:183]
    v_add_f32 v203, v203, v219
    v_add_f32 v204, v204, v220
    v_add_f32 v205, v205, v221
    v_add_f32 v206, v206, v222
    v_add_f32 v207, v207, v223
    v_add_f32 v208, v208, v224
    v_add_f32_e64 v209, v209, v225
    v_mfma_f32_32x32x16_bf16 v[184:199], a[164:167], v[232:235], v[184:199]
    ds_read_b128 v[244:247], v44 offset:23552
    buffer_load_dwordx4 v30, s[20:23], s58 offen offset:2048 sc1 lds
    v_add_f32 v210, v210, v226
    v_add_f32 v211, v211, v227
    v_add_f32 v212, v212, v228
    s_waitcnt lgkmcnt(2)
    v_mfma_f32_32x32x16_bf16 v[168:183], a[168:171], v[236:239], v[168:183]
    v_add_f32 v213, v213, v229
    v_add_f32 v214, v214, v230
    v_add_f32 v215, v215, v231
    v_add_f32 v200, v200, v208
    v_add_f32 v201, v201, v209
    v_add_f32 v202, v202, v210
    v_add_f32_e64 v203, v203, v211
    v_mfma_f32_32x32x16_bf16 v[184:199], a[172:175], v[236:239], v[184:199]
    ds_read_b128 v[232:235], v44 offset:24576
    buffer_load_dwordx4 v31, s[20:23], s58 offen offset:3072 sc1 lds
    v_add_f32 v204, v204, v212
    v_add_f32 v205, v205, v213
    v_add_f32 v206, v206, v214
    s_waitcnt lgkmcnt(2)
    v_mfma_f32_32x32x16_bf16 v[168:183], a[176:179], v[240:243], v[168:183]
    v_add_f32 v207, v207, v215
    v_add_f32 v200, v200, v204
    v_add_f32 v201, v201, v205
    v_add_f32 v202, v202, v206
    v_add_f32 v203, v203, v207
    v_add_f32 v4, v200, v202
    v_add_f32_e64 v5, v201, v203
    v_mfma_f32_32x32x16_bf16 v[184:199], a[180:183], v[240:243], v[184:199]
    ds_read_b128 v[236:239], v44 offset:25600
    s_add_u32 m0, s47, 49152
    s_cmp_le_u32 s37, 1
    s_cselect_b32 s58, s50, s49
    s_add_u32 s58, s58, 229376
    buffer_load_dwordx4 v28, s[20:23], s58 offen offset:0 sc1 lds
    s_waitcnt lgkmcnt(2)
    v_mfma_f32_32x32x16_bf16 v[168:183], a[184:187], v[244:247], v[168:183]
    v_mul_f32 v50, 0xbb000000, v4
    v_mul_f32 v41, v50, v50
    v_fma_f32 v41, v5, s60, -v41
    v_max_f32_e64 v41, 0, v41
    v_add_f32 v41, 0x3727c5ac, v41
    v_rsq_f32_e64 v70, v41
    v_mfma_f32_32x32x16_bf16 v[184:199], a[188:191], v[244:247], v[184:199]
    ds_read_b128 v[240:243], v44 offset:26624
    buffer_load_dwordx4 v29, s[20:23], s58 offen offset:1024 sc1 lds
    v_mov_b32_e64 v51, v50
    v_mov_b32 v71, v70
    s_nop 0
    v_permlane32_swap_b32 v50, v51
    s_waitcnt lgkmcnt(2)
    v_mfma_f32_32x32x16_bf16 v[168:183], a[192:195], v[232:235], v[168:183]
    v_permlane32_swap_b32 v70, v71
    v_cmp_gt_u32 vcc, 32, v0
    v_cvt_pk_bf16_f32 v41, v50, v50
    v_and_b32 v42, 0xffff0000, v41
    v_sub_f32_e64 v42, v50, v42
    v_cvt_pk_bf16_f32 v35, v42, v42
    v_cndmask_b32 v34, v35, v41, vcc
    v_mfma_f32_32x32x16_bf16 v[184:199], a[196:199], v[232:235], v[184:199]
    ds_read_b128 v[244:247], v44 offset:27648
    buffer_load_dwordx4 v30, s[20:23], s58 offen offset:2048 sc1 lds
    v_and_b32 v35, 0xffff0000, v35
    v_sub_f32 v42, v42, v35
    v_cvt_pk_bf16_f32 v42, v50, v42
    s_waitcnt lgkmcnt(2)
    v_mfma_f32_32x32x16_bf16 v[168:183], a[200:203], v[236:239], v[168:183]
    s_waitcnt vmcnt(11)
    ds_read_b64_tr_b16 v[72:73], v24 offset:0
    ds_read_b64_tr_b16 v[74:75], v24 offset:1024
    v_cndmask_b32 v35, 0, v42, vcc
    v_rcp_f32 v252, v70
    v_mfma_f32_32x32x16_bf16 v[184:199], a[204:207], v[236:239], v[184:199]
    ds_read_b128 v[232:235], v44 offset:28672
    buffer_load_dwordx4 v31, s[20:23], s58 offen offset:3072 sc1 lds
    v_mul_f32 v248, 0xc0135761, v70
    v_mul_f32_e64 v6, v70, v70
    v_mul_f32 v6, v6, v70
    s_waitcnt lgkmcnt(4)
    v_mfma_f32_32x32x16_bf16 v[168:183], a[208:211], v[240:243], v[168:183]
    ds_read_b64_tr_b16 v[76:77], v25 offset:0
    ds_read_b64_tr_b16 v[78:79], v25 offset:1024
    ds_read_b64_tr_b16 v[80:81], v24 offset:2048
    ds_read_b64_tr_b16 v[82:83], v24 offset:3072
    v_mfma_f32_32x32x16_bf16 v[184:199], a[212:215], v[240:243], v[184:199]
    s_barrier
    ds_read_b128 v[236:239], v44 offset:29696
    s_add_u32 m0, s47, 65536
    s_cmp_le_u32 s37, 2
    s_cselect_b32 s58, s50, s49
    s_add_u32 s58, s58, 393216
    buffer_load_dwordx4 v28, s[20:23], s58 offen offset:0 sc1 lds
    s_waitcnt lgkmcnt(8)
    v_mfma_f32_32x32x16_bf16 v[168:183], a[216:219], v[244:247], v[168:183]
    ds_read_b64_tr_b16 v[84:85], v25 offset:2048
    ds_read_b64_tr_b16 v[86:87], v25 offset:3072
    v_mul_f32 v250, 0xbdd2d3e8, v6
    v_mfma_f32_32x32x16_bf16 v[184:199], a[220:223], v[244:247], v[184:199]
    ds_read_b128 v[240:243], v44 offset:30720
    buffer_load_dwordx4 v29, s[20:23], s58 offen offset:1024 sc1 lds
    s_waitcnt lgkmcnt(8)
    v_mfma_f32_32x32x16_bf16 v[168:183], a[224:227], v[232:235], v[168:183]
    v_mfma_f32_32x32x16_bf16 v[184:199], a[228:231], v[232:235], v[184:199]
    ds_read_b128 v[244:247], v44 offset:31744
    buffer_load_dwordx4 v30, s[20:23], s58 offen offset:2048 sc1 lds
    s_waitcnt lgkmcnt(4)
    v_mfma_f32_32x32x16_bf16 v[168:183], a[232:235], v[236:239], v[168:183]
    s_waitcnt vmcnt(11)
    ds_read_b64_tr_b16 v[88:89], v24 offset:16384
    ds_read_b64_tr_b16 v[90:91], v24 offset:17408
    v_mfma_f32_32x32x16_bf16 v[184:199], a[236:239], v[236:239], v[184:199]
    ds_read_b128 v[232:235], v44 offset:32768
    buffer_load_dwordx4 v31, s[20:23], s58 offen offset:3072 sc1 lds
    s_waitcnt lgkmcnt(4)
    v_mfma_f32_32x32x16_bf16 v[168:183], a[240:243], v[240:243], v[168:183]
    ds_read_b64_tr_b16 v[92:93], v25 offset:16384
    ds_read_b64_tr_b16 v[94:95], v25 offset:17408
    ds_read_b64_tr_b16 v[96:97], v24 offset:18432
    ds_read_b64_tr_b16 v[98:99], v24 offset:19456
    v_mfma_f32_32x32x16_bf16 v[184:199], a[244:247], v[240:243], v[184:199]
    ds_read_b128 v[236:239], v44 offset:33792
    ds_read_b64_tr_b16 v[100:101], v25 offset:18432
    ds_read_b64_tr_b16 v[102:103], v25 offset:19456
    s_waitcnt lgkmcnt(10)
    v_mfma_f32_32x32x16_bf16 v[168:183], a[248:251], v[244:247], v[168:183]
    s_add_u32 m0, s47, 0
    s_cmp_le_u32 s37, 2
    s_cselect_b32 s58, s50, s49
    s_add_u32 s58, s58, 425984
    buffer_load_dwordx4 v28, s[20:23], s58 offen offset:0 sc1 lds
    v_mfma_f32_32x32x16_bf16 v[184:199], a[252:255], v[244:247], v[184:199]
    ds_read_b128 v[240:243], v44 offset:34816
    buffer_load_dwordx4 v29, s[20:23], s58 offen offset:1024 sc1 lds
    v_mfma_f32_32x32x16_bf16 v[168:183], v[20:23], v[34:37], v[168:183]
    v_mfma_f32_32x32x16_bf16 v[184:199], v[20:23], v[32:35], v[184:199]
    buffer_load_dwordx4 v30, s[20:23], s58 offen offset:2048 sc1 lds
    buffer_load_dwordx4 v31, s[20:23], s58 offen offset:3072 sc1 lds
    s_nop 8
    v_pk_mul_f32 v[4:5], v[168:169], v[168:169]
    v_pk_mul_f32 v[6:7], v[170:171], v[170:171]
    v_pk_mul_f32 v[8:9], v[172:173], v[172:173]
    v_pk_mul_f32 v[10:11], v[174:175], v[174:175]
    v_pk_fma_f32 v[4:5], v[4:5], v[250:251], v[248:249] op_sel_hi:[1,0,0]
    v_pk_fma_f32 v[6:7], v[6:7], v[250:251], v[248:249] op_sel_hi:[1,0,0]
    v_pk_fma_f32 v[8:9], v[8:9], v[250:251], v[248:249] op_sel_hi:[1,0,0]
    v_pk_fma_f32 v[10:11], v[10:11], v[250:251], v[248:249] op_sel_hi:[1,0,0]
    v_pk_mul_f32 v[4:5], v[4:5], v[168:169]
    v_pk_mul_f32 v[6:7], v[6:7], v[170:171]
    v_pk_mul_f32 v[8:9], v[8:9], v[172:173]
    v_pk_mul_f32 v[10:11], v[10:11], v[174:175]
    v_exp_f32 v4, v4
    v_exp_f32 v5, v5
    v_exp_f32 v6, v6
    v_exp_f32 v7, v7
    v_exp_f32 v8, v8
    v_exp_f32 v9, v9
    v_exp_f32 v10, v10
    v_exp_f32_e64 v11, v11
    s_add_u32 m0, s47, 16384
    s_cmp_le_u32 s37, 3
    s_cselect_b32 s58, s50, s49
    s_add_u32 s58, s58, 589824
    s_waitcnt lgkmcnt(1)
    buffer_load_dwordx4 v28, s[20:23], s58 offen offset:0 sc1 lds
    v_pk_fma_f32 v[4:5], v[4:5], v[252:253], v[252:253] op_sel_hi:[1,0,0]
    v_pk_fma_f32 v[6:7], v[6:7], v[252:253], v[252:253] op_sel_hi:[1,0,0]
    v_pk_fma_f32 v[8:9], v[8:9], v[252:253], v[252:253] op_sel_hi:[1,0,0]
    v_pk_fma_f32 v[10:11], v[10:11], v[252:253], v[252:253] op_sel_hi:[1,0,0]
    v_rcp_f32 v4, v4
    v_rcp_f32 v5, v5
    v_rcp_f32 v6, v6
    v_rcp_f32 v7, v7
    v_rcp_f32 v8, v8
    v_rcp_f32 v9, v9
    v_rcp_f32 v10, v10
    v_rcp_f32_e64 v11, v11
    v_pk_mul_f32 v[4:5], v[4:5], v[168:169]
    v_pk_mul_f32 v[6:7], v[6:7], v[170:171]
    v_pk_mul_f32 v[8:9], v[8:9], v[172:173]
    v_pk_mul_f32 v[10:11], v[10:11], v[174:175]
    v_cvt_pk_bf16_f32 v168, v4, v5
    v_cvt_pk_bf16_f32 v169, v6, v7
    v_cvt_pk_bf16_f32 v170, v8, v9
    buffer_load_dwordx4 v29, s[20:23], s58 offen offset:1024 sc1 lds
    v_cvt_pk_bf16_f32 v171, v10, v11
    buffer_store_dwordx4 v[168:171], v44, s[28:31], s62 offen offset:0 sc1
    v_pk_mul_f32 v[4:5], v[176:177], v[176:177]
    v_pk_mul_f32 v[6:7], v[178:179], v[178:179]
    v_pk_mul_f32 v[8:9], v[180:181], v[180:181]
    v_pk_mul_f32 v[10:11], v[182:183], v[182:183]
    v_pk_fma_f32 v[4:5], v[4:5], v[250:251], v[248:249] op_sel_hi:[1,0,0]
    v_pk_fma_f32 v[6:7], v[6:7], v[250:251], v[248:249] op_sel_hi:[1,0,0]
    v_pk_fma_f32 v[8:9], v[8:9], v[250:251], v[248:249] op_sel_hi:[1,0,0]
    v_pk_fma_f32 v[10:11], v[10:11], v[250:251], v[248:249] op_sel_hi:[1,0,0]
    v_pk_mul_f32 v[4:5], v[4:5], v[176:177]
    v_pk_mul_f32 v[6:7], v[6:7], v[178:179]
    v_pk_mul_f32 v[8:9], v[8:9], v[180:181]
    v_pk_mul_f32 v[10:11], v[10:11], v[182:183]
    v_exp_f32 v4, v4
    v_exp_f32 v5, v5
    v_exp_f32 v6, v6
    v_exp_f32 v7, v7
    v_exp_f32 v8, v8
    v_exp_f32 v9, v9
    v_exp_f32_e64 v10, v10
    buffer_load_dwordx4 v30, s[20:23], s58 offen offset:2048 sc1 lds
    v_exp_f32_e64 v11, v11
    v_pk_fma_f32 v[4:5], v[4:5], v[252:253], v[252:253] op_sel_hi:[1,0,0]
    v_pk_fma_f32 v[6:7], v[6:7], v[252:253], v[252:253] op_sel_hi:[1,0,0]
    v_pk_fma_f32 v[8:9], v[8:9], v[252:253], v[252:253] op_sel_hi:[1,0,0]
    v_pk_fma_f32 v[10:11], v[10:11], v[252:253], v[252:253] op_sel_hi:[1,0,0]
    v_rcp_f32 v4, v4
    v_rcp_f32 v5, v5
    v_rcp_f32 v6, v6
    v_rcp_f32 v7, v7
    v_rcp_f32 v8, v8
    v_rcp_f32 v9, v9
    v_rcp_f32 v10, v10
    v_rcp_f32 v11, v11
    v_pk_mul_f32 v[4:5], v[4:5], v[176:177]
    v_pk_mul_f32 v[6:7], v[6:7], v[178:179]
    v_pk_mul_f32 v[8:9], v[8:9], v[180:181]
    v_pk_mul_f32 v[10:11], v[10:11], v[182:183]
    v_cvt_pk_bf16_f32 v176, v4, v5
    v_cvt_pk_bf16_f32 v177, v6, v7
    v_cvt_pk_bf16_f32 v178, v8, v9
    v_cvt_pk_bf16_f32 v179, v10, v11
    buffer_store_dwordx4 v[176:179], v44, s[28:31], s62 offen offset:1024 sc1
    buffer_load_dwordx4 v31, s[20:23], s58 offen offset:3072 sc1 lds
    v_pk_mul_f32 v[4:5], v[184:185], v[184:185]
    v_pk_mul_f32 v[6:7], v[186:187], v[186:187]
    v_pk_mul_f32 v[8:9], v[188:189], v[188:189]
    v_pk_mul_f32 v[10:11], v[190:191], v[190:191]
    v_pk_fma_f32 v[4:5], v[4:5], v[250:251], v[248:249] op_sel_hi:[1,0,0]
    v_pk_fma_f32 v[6:7], v[6:7], v[250:251], v[248:249] op_sel_hi:[1,0,0]
    v_pk_fma_f32 v[8:9], v[8:9], v[250:251], v[248:249] op_sel_hi:[1,0,0]
    v_pk_fma_f32 v[10:11], v[10:11], v[250:251], v[248:249] op_sel_hi:[1,0,0]
    v_pk_mul_f32 v[4:5], v[4:5], v[184:185]
    v_pk_mul_f32 v[6:7], v[6:7], v[186:187]
    v_pk_mul_f32 v[8:9], v[8:9], v[188:189]
    v_pk_mul_f32 v[10:11], v[10:11], v[190:191]
    v_exp_f32 v4, v4
    v_exp_f32 v5, v5
    v_exp_f32 v6, v6
    v_exp_f32 v7, v7
    v_exp_f32 v8, v8
    v_exp_f32 v9, v9
    v_exp_f32 v10, v10
    v_exp_f32 v11, v11
    v_pk_fma_f32 v[4:5], v[4:5], v[252:253], v[252:253] op_sel_hi:[1,0,0]
    v_pk_fma_f32 v[6:7], v[6:7], v[252:253], v[252:253] op_sel_hi:[1,0,0]
    v_pk_fma_f32 v[8:9], v[8:9], v[252:253], v[252:253] op_sel_hi:[1,0,0]
    v_pk_fma_f32 v[10:11], v[10:11], v[252:253], v[252:253] op_sel_hi:[1,0,0]
    v_rcp_f32 v4, v4
    v_rcp_f32 v5, v5
    v_rcp_f32 v6, v6
    v_rcp_f32 v7, v7
    v_rcp_f32 v8, v8
    v_rcp_f32 v9, v9
    v_rcp_f32 v10, v10
    v_rcp_f32 v11, v11
    v_pk_mul_f32 v[4:5], v[4:5], v[184:185]
    v_pk_mul_f32 v[6:7], v[6:7], v[186:187]
    v_pk_mul_f32 v[8:9], v[8:9], v[188:189]
    v_pk_mul_f32 v[10:11], v[10:11], v[190:191]
    v_cvt_pk_bf16_f32 v184, v4, v5
    v_cvt_pk_bf16_f32 v185, v6, v7
    v_cvt_pk_bf16_f32 v186, v8, v9
    v_cvt_pk_bf16_f32 v187, v10, v11
    buffer_store_dwordx4 v[184:187], v44, s[28:31], s62 offen offset:2048 sc1
    v_pk_mul_f32 v[4:5], v[192:193], v[192:193]
    v_pk_mul_f32 v[6:7], v[194:195], v[194:195]
    v_pk_mul_f32 v[8:9], v[196:197], v[196:197]
    v_pk_mul_f32 v[10:11], v[198:199], v[198:199]
    v_pk_fma_f32 v[4:5], v[4:5], v[250:251], v[248:249] op_sel_hi:[1,0,0]
    v_pk_fma_f32 v[6:7], v[6:7], v[250:251], v[248:249] op_sel_hi:[1,0,0]
    v_pk_fma_f32 v[8:9], v[8:9], v[250:251], v[248:249] op_sel_hi:[1,0,0]
    v_pk_fma_f32 v[10:11], v[10:11], v[250:251], v[248:249] op_sel_hi:[1,0,0]
    v_pk_mul_f32 v[4:5], v[4:5], v[192:193]
    v_pk_mul_f32 v[6:7], v[6:7], v[194:195]
    v_pk_mul_f32 v[8:9], v[8:9], v[196:197]
    v_pk_mul_f32 v[10:11], v[10:11], v[198:199]
    v_exp_f32 v4, v4
    v_exp_f32 v5, v5
    v_exp_f32 v6, v6
    v_exp_f32 v7, v7
    v_exp_f32 v8, v8
    v_exp_f32 v9, v9
    v_exp_f32 v10, v10
    v_exp_f32 v11, v11
    v_pk_fma_f32 v[4:5], v[4:5], v[252:253], v[252:253] op_sel_hi:[1,0,0]
    v_pk_fma_f32 v[6:7], v[6:7], v[252:253], v[252:253] op_sel_hi:[1,0,0]
    v_pk_fma_f32 v[8:9], v[8:9], v[252:253], v[252:253] op_sel_hi:[1,0,0]
    v_pk_fma_f32 v[10:11], v[10:11], v[252:253], v[252:253] op_sel_hi:[1,0,0]
    v_rcp_f32 v4, v4
    v_rcp_f32 v5, v5
    v_rcp_f32 v6, v6
    v_rcp_f32 v7, v7
    v_rcp_f32 v8, v8
    v_rcp_f32 v9, v9
    v_rcp_f32 v10, v10
    v_rcp_f32 v11, v11
    v_pk_mul_f32 v[4:5], v[4:5], v[192:193]
    v_pk_mul_f32 v[6:7], v[6:7], v[194:195]
    v_pk_mul_f32 v[8:9], v[8:9], v[196:197]
    v_pk_mul_f32 v[10:11], v[10:11], v[198:199]
    v_cvt_pk_bf16_f32 v192, v4, v5
    v_cvt_pk_bf16_f32 v193, v6, v7
    v_cvt_pk_bf16_f32 v194, v8, v9
    v_cvt_pk_bf16_f32 v195, v10, v11
    buffer_store_dwordx4 v[192:195], v44, s[28:31], s62 offen offset:3072 sc1
    v_mfma_f32_32x32x16_bf16 v[200:215], a[0:3], v[232:235], 0
    s_waitcnt vmcnt(20)
    ds_read_b64_tr_b16 v[104:105], v24 offset:32768
    ds_read_b64_tr_b16 v[106:107], v24 offset:33792
    v_cmp_gt_u32 vcc, 32, v0
    v_cvt_pk_bf16_f32 v41, v51, v51
    v_and_b32 v42, 0xffff0000, v41
    v_mfma_f32_32x32x16_bf16 v[216:231], a[4:7], v[232:235], 0
    ds_read_b128 v[244:247], v44 offset:35840
    ds_read_b64_tr_b16 v[108:109], v25 offset:32768
    ds_read_b64_tr_b16 v[110:111], v25 offset:33792
    v_sub_f32_e64 v42, v51, v42
    v_cvt_pk_bf16_f32 v35, v42, v42
    v_mfma_f32_32x32x16_bf16 v[200:215], a[8:11], v[236:239], v[200:215]
    ds_read_b64_tr_b16 v[112:113], v24 offset:34816
    ds_read_b64_tr_b16 v[114:115], v24 offset:35840
    ds_read_b64_tr_b16 v[116:117], v25 offset:34816
    ds_read_b64_tr_b16 v[118:119], v25 offset:35840
    v_mfma_f32_32x32x16_bf16 v[216:231], a[12:15], v[236:239], v[216:231]
    ds_read_b128 v[232:235], v44 offset:36864
    s_add_u32 m0, s47, 32768
    s_cmp_le_u32 s37, 3
    s_cselect_b32 s58, s50, s49
    s_add_u32 s58, s58, 622592
    s_waitcnt lgkmcnt(1)
    buffer_load_dwordx4 v28, s[20:23], s58 offen offset:0 sc1 lds
    v_mfma_f32_32x32x16_bf16 v[200:215], a[16:19], v[240:243], v[200:215]
    s_waitcnt vmcnt(17)
    ds_read_b64_tr_b16 v[120:121], v24 offset:49152
    ds_read_b64_tr_b16 v[122:123], v24 offset:50176
    v_cndmask_b32 v34, v35, v41, vcc
    v_and_b32 v35, 0xffff0000, v35
    v_sub_f32 v42, v42, v35
    v_mfma_f32_32x32x16_bf16 v[216:231], a[20:23], v[240:243], v[216:231]
    ds_read_b128 v[236:239], v44 offset:37888
    buffer_load_dwordx4 v29, s[20:23], s58 offen offset:1024 sc1 lds
    v_cvt_pk_bf16_f32 v42, v51, v42
    v_cndmask_b32 v35, 0, v42, vcc
    v_mfma_f32_32x32x16_bf16 v[200:215], a[24:27], v[244:247], v[200:215]
    ds_read_b64_tr_b16 v[124:125], v25 offset:49152
    ds_read_b64_tr_b16 v[126:127], v25 offset:50176
    ds_read_b64_tr_b16 v[128:129], v24 offset:51200
    ds_read_b64_tr_b16 v[130:131], v24 offset:52224
    v_mfma_f32_32x32x16_bf16 v[216:231], a[28:31], v[244:247], v[216:231]
    ds_read_b128 v[240:243], v44 offset:38912
    buffer_load_dwordx4 v30, s[20:23], s58 offen offset:2048 sc1 lds
    v_rcp_f32 v252, v71
    v_mul_f32 v248, 0xc0135761, v71
    s_waitcnt lgkmcnt(8)
    v_mfma_f32_32x32x16_bf16 v[200:215], a[32:35], v[232:235], v[200:215]
    ds_read_b64_tr_b16 v[132:133], v25 offset:51200
    ds_read_b64_tr_b16 v[134:135], v25 offset:52224
    v_mul_f32 v43, v71, v71
    v_mul_f32_e64 v43, v43, v71
    v_mul_f32 v250, 0xbdd2d3e8, v43
    s_add_u32 s62, s62, 114688
    v_mfma_f32_32x32x16_bf16 v[216:231], a[36:39], v[232:235], v[216:231]
    ds_read_b128 v[244:247], v44 offset:39936
    buffer_load_dwordx4 v31, s[20:23], s58 offen offset:3072 sc1 lds
    v_mul_u32_u24 v2, 2304, v47
    v_lshl_add_u32 v2, v48, 4, v2
    s_mul_i32 s41, s36, s57
    s_waitcnt lgkmcnt(8)
    v_mfma_f32_32x32x16_bf16 v[200:215], a[40:43], v[236:239], v[200:215]
    s_waitcnt vmcnt(16)
    ds_read_b64_tr_b16 v[136:137], v26 offset:0
    ds_read_b64_tr_b16 v[138:139], v26 offset:1024
    s_and_b32 s41, s41, 31
    s_mul_i32 s41, s41, 73728
    s_mul_i32 s42, s38, 18432
    v_mfma_f32_32x32x16_bf16 v[216:231], a[44:47], v[236:239], v[216:231]
    ds_read_b128 v[232:235], v44 offset:40960
    s_add_u32 m0, s47, 49152
    s_cmp_le_u32 s37, 4
    s_cselect_b32 s58, s50, s49
    s_add_u32 s58, s58, 786432
    s_waitcnt lgkmcnt(4)
    buffer_load_dwordx4 v28, s[20:23], s58 offen offset:0 sc1 lds
    v_mfma_f32_32x32x16_bf16 v[200:215], a[48:51], v[240:243], v[200:215]
    ds_read_b64_tr_b16 v[140:141], v27 offset:0
    ds_read_b64_tr_b16 v[142:143], v27 offset:1024
    ds_read_b64_tr_b16 v[144:145], v26 offset:2048
    ds_read_b64_tr_b16 v[146:147], v26 offset:3072
    v_mfma_f32_32x32x16_bf16 v[216:231], a[52:55], v[240:243], v[216:231]
    ds_read_b128 v[236:239], v44 offset:41984
    buffer_load_dwordx4 v29, s[20:23], s58 offen offset:1024 sc1 lds
    s_add_u32 s41, s41, s42
    s_lshl_b32 s42, s37, 9
    s_mul_i32 s42, s42, s57
    s_waitcnt lgkmcnt(8)
    v_mfma_f32_32x32x16_bf16 v[200:215], a[56:59], v[244:247], v[200:215]
    ds_read_b64_tr_b16 v[148:149], v27 offset:2048
    ds_read_b64_tr_b16 v[150:151], v27 offset:3072
    s_add_u32 s41, s41, s42
    s_and_b32 s42, s57, 3592
    s_add_u32 s45, s41, s42
    s_lshl_b32 s41, s38, 12
    v_mfma_f32_32x32x16_bf16 v[216:231], a[60:63], v[244:247], v[216:231]
    ds_read_b128 v[240:243], v44 offset:43008
    buffer_load_dwordx4 v30, s[20:23], s58 offen offset:2048 sc1 lds
    s_add_u32 s43, s53, s41
    s_add_u32 s44, s43, 12288
    v_lshrrev_b32_e64 v41, 1, v46
    s_waitcnt lgkmcnt(8)
    v_mfma_f32_32x32x16_bf16 v[200:215], a[64:67], v[232:235], v[200:215]
    s_waitcnt vmcnt(15)
    ds_read_b64_tr_b16 v[152:153], v24 offset:0
    ds_read_b64_tr_b16 v[154:155], v24 offset:1024
    v_lshlrev_b32 v41, 10, v41
    v_and_b32_e64 v42, 1, v0
    v_lshl_add_u32 v41, v42, 3, v41
    v_mfma_f32_32x32x16_bf16 v[216:231], a[68:71], v[232:235], v[216:231]
    ds_read_b128 v[244:247], v44 offset:44032
    buffer_load_dwordx4 v31, s[20:23], s58 offen offset:3072 sc1 lds
    v_lshl_add_u32 v42, v45, 4, v41
    s_lshl_b32 s41, s38, 7
    s_lshl_b32 s42, s37, 12
    s_waitcnt lgkmcnt(6)
    v_mfma_f32_32x32x16_bf16 v[200:215], a[72:75], v[236:239], v[200:215]
    ds_read_b64_tr_b16 v[156:157], v25 offset:0
    ds_read_b64_tr_b16 v[158:159], v25 offset:1024
    ds_read_b64_tr_b16 v[160:161], v24 offset:2048
    ds_read_b64_tr_b16 v[162:163], v24 offset:3072
    v_mfma_f32_32x32x16_bf16 v[216:231], a[76:79], v[236:239], v[216:231]
    ds_read_b128 v[232:235], v44 offset:45056
    s_add_u32 m0, s47, 65536
    s_cmp_le_u32 s37, 4
    s_cselect_b32 s58, s50, s49
    s_add_u32 s58, s58, 819200
    s_waitcnt lgkmcnt(9)
    buffer_load_dwordx4 v28, s[20:23], s58 offen offset:0 sc1 lds
    s_waitcnt lgkmcnt(8)
    v_mfma_f32_32x32x16_bf16 v[200:215], a[80:83], v[240:243], v[200:215]
    ds_read_b64_tr_b16 v[164:165], v25 offset:2048
    ds_read_b64_tr_b16 v[166:167], v25 offset:3072
    s_add_u32 s42, s42, s41
    s_add_u32 s41, s41, 155648
    v_add_u32 v41, s42, v42
    v_add_u32 v42, s41, v42
    v_mfma_f32_32x32x16_bf16 v[216:231], a[84:87], v[240:243], v[216:231]
    ds_read_b128 v[236:239], v44 offset:46080
    buffer_load_dwordx4 v29, s[20:23], s58 offen offset:1024 sc1 lds
    ds_read_b64 v[52:53], v41 offset:0
    s_waitcnt lgkmcnt(9)
    v_mfma_f32_32x32x16_bf16 v[200:215], a[88:91], v[244:247], v[200:215]
    s_waitcnt vmcnt(12)
    ds_read_b64_tr_b16 a[0:1], v24 offset:16384
    ds_read_b64_tr_b16 a[2:3], v24 offset:17408
    ds_read_b64 v[60:61], v42 offset:0
    v_mfma_f32_32x32x16_bf16 v[216:231], a[92:95], v[244:247], v[216:231]
    ds_read_b128 v[240:243], v44 offset:47104
    buffer_load_dwordx4 v30, s[20:23], s58 offen offset:2048 sc1 lds
    ds_read_b64 v[54:55], v41 offset:512
    s_waitcnt lgkmcnt(9)
    v_mfma_f32_32x32x16_bf16 v[200:215], a[96:99], v[232:235], v[200:215]
    ds_read_b64_tr_b16 a[4:5], v25 offset:16384
    ds_read_b64_tr_b16 a[6:7], v25 offset:17408
    ds_read_b64_tr_b16 a[8:9], v24 offset:18432
    ds_read_b64_tr_b16 a[10:11], v24 offset:19456
    v_mfma_f32_32x32x16_bf16 v[216:231], a[100:103], v[232:235], v[216:231]
    ds_read_b128 v[244:247], v44 offset:48128
    buffer_load_dwordx4 v31, s[20:23], s58 offen offset:3072 sc1 lds
    ds_read_b64 v[62:63], v42 offset:512
    s_waitcnt lgkmcnt(12)
    v_mfma_f32_32x32x16_bf16 v[200:215], a[104:107], v[236:239], v[200:215]
    ds_read_b64_tr_b16 a[12:13], v25 offset:18432
    ds_read_b64_tr_b16 a[14:15], v25 offset:19456
    ds_read_b64 v[56:57], v41 offset:32768
    ds_read_b64 v[64:65], v42 offset:4096
    v_mfma_f32_32x32x16_bf16 v[216:231], a[108:111], v[236:239], v[216:231]
    ds_read_b128 v[232:235], v44 offset:49152
    ds_read_b64 v[58:59], v41 offset:33280
    ds_read_b64 v[66:67], v42 offset:4608
    s_waitcnt lgkmcnt(14)
    v_mfma_f32_32x32x16_bf16 v[200:215], a[112:115], v[240:243], v[200:215]
    s_waitcnt vmcnt(12)
    s_barrier
    s_add_u32 m0, s47, 0
    s_cmp_le_u32 s37, 5
    s_cselect_b32 s58, s50, s49
    s_add_u32 s58, s58, 983040
    buffer_load_dwordx4 v28, s[20:23], s58 offen offset:0 sc1 lds
    v_mfma_f32_32x32x16_bf16 v[216:231], a[116:119], v[240:243], v[216:231]
    ds_read_b128 v[236:239], v44 offset:50176
    buffer_load_dwordx4 v29, s[20:23], s58 offen offset:1024 sc1 lds
    s_waitcnt lgkmcnt(9)
    v_mfma_f32_32x32x16_bf16 v[200:215], a[120:123], v[244:247], v[200:215]
    v_mfma_f32_32x32x16_bf16 v[216:231], a[124:127], v[244:247], v[216:231]
    ds_read_b128 v[240:243], v44 offset:51200
    buffer_load_dwordx4 v30, s[20:23], s58 offen offset:2048 sc1 lds
    s_waitcnt lgkmcnt(4)
    v_mfma_f32_32x32x16_bf16 v[200:215], a[128:131], v[232:235], v[200:215]
    s_waitcnt vmcnt(11)
    ds_read_b64_tr_b16 a[16:17], v24 offset:32768
    ds_read_b64_tr_b16 a[18:19], v24 offset:33792
    v_mfma_f32_32x32x16_bf16 v[216:231], a[132:135], v[232:235], v[216:231]
    ds_read_b128 v[244:247], v44 offset:52224
    buffer_load_dwordx4 v31, s[20:23], s58 offen offset:3072 sc1 lds
    s_waitcnt lgkmcnt(4)
    v_mfma_f32_32x32x16_bf16 v[200:215], a[136:139], v[236:239], v[200:215]
    ds_read_b64_tr_b16 a[20:21], v25 offset:32768
    ds_read_b64_tr_b16 a[22:23], v25 offset:33792
    ds_read_b64_tr_b16 a[24:25], v24 offset:34816
    ds_read_b64_tr_b16 a[26:27], v24 offset:35840
    v_mfma_f32_32x32x16_bf16 v[216:231], a[140:143], v[236:239], v[216:231]
    ds_read_b128 v[232:235], v44 offset:53248
    ds_read_b64_tr_b16 a[28:29], v25 offset:34816
    ds_read_b64_tr_b16 a[30:31], v25 offset:35840
    v_accvgpr_write_b32 a128, v168
    v_accvgpr_write_b32 a129, v169
    s_waitcnt lgkmcnt(10)
    v_mfma_f32_32x32x16_bf16 v[200:215], a[144:147], v[240:243], v[200:215]
    s_add_u32 m0, s47, 16384
    s_cmp_le_u32 s37, 5
    s_cselect_b32 s58, s50, s49
    s_add_u32 s58, s58, 1015808
    buffer_load_dwordx4 v28, s[20:23], s58 offen offset:0 sc1 lds
    v_mfma_f32_32x32x16_bf16 v[216:231], a[148:151], v[240:243], v[216:231]
    ds_read_b128 v[236:239], v44 offset:54272
    buffer_load_dwordx4 v29, s[20:23], s58 offen offset:1024 sc1 lds
    v_accvgpr_write_b32 a130, v170
    v_accvgpr_write_b32 a131, v171
    v_accvgpr_write_b32 a132, v176
    s_waitcnt lgkmcnt(8)
    v_mfma_f32_32x32x16_bf16 v[200:215], a[152:155], v[244:247], v[200:215]
    v_accvgpr_write_b32 a133, v177
    v_accvgpr_write_b32 a134, v178
    v_accvgpr_write_b32 a135, v179
    v_accvgpr_write_b32 a136, v184
    v_accvgpr_write_b32 a137, v185
    v_accvgpr_write_b32 a138, v186
    v_accvgpr_write_b32 a139, v187
    v_mfma_f32_32x32x16_bf16 v[216:231], a[156:159], v[244:247], v[216:231]
    ds_read_b128 v[240:243], v44 offset:55296
    buffer_load_dwordx4 v30, s[20:23], s58 offen offset:2048 sc1 lds
    v_accvgpr_write_b32 a140, v192
    v_accvgpr_write_b32 a141, v193
    v_accvgpr_write_b32 a142, v194
    s_waitcnt lgkmcnt(4)
    v_mfma_f32_32x32x16_bf16 v[200:215], a[160:163], v[232:235], v[200:215]
    s_waitcnt vmcnt(11)
    ds_read_b64_tr_b16 a[32:33], v24 offset:49152
    ds_read_b64_tr_b16 a[34:35], v24 offset:50176
    v_accvgpr_write_b32 a143, v195
    v_mfma_f32_32x32x16_bf16 v[216:231], a[164:167], v[232:235], v[216:231]
    ds_read_b128 v[244:247], v44 offset:56320
    buffer_load_dwordx4 v31, s[20:23], s58 offen offset:3072 sc1 lds
    s_waitcnt lgkmcnt(4)
    v_mfma_f32_32x32x16_bf16 v[200:215], a[168:171], v[236:239], v[200:215]
    ds_read_b64_tr_b16 a[36:37], v25 offset:49152
    ds_read_b64_tr_b16 a[38:39], v25 offset:50176
    ds_read_b64_tr_b16 a[40:41], v24 offset:51200
    ds_read_b64_tr_b16 a[42:43], v24 offset:52224
    v_mfma_f32_32x32x16_bf16 v[216:231], a[172:175], v[236:239], v[216:231]
    ds_read_b128 v[232:235], v44 offset:57344
    s_add_u32 m0, s47, 32768
    s_add_u32 s58, s51, 0
    buffer_load_dwordx4 v28, s[20:23], s58 offen offset:0 sc1 lds
    s_waitcnt lgkmcnt(8)
    v_mfma_f32_32x32x16_bf16 v[200:215], a[176:179], v[240:243], v[200:215]
    ds_read_b64_tr_b16 a[44:45], v25 offset:51200
    ds_read_b64_tr_b16 a[46:47], v25 offset:52224
    v_mfma_f32_32x32x16_bf16 v[216:231], a[180:183], v[240:243], v[216:231]
    ds_read_b128 v[236:239], v44 offset:58368
    buffer_load_dwordx4 v29, s[20:23], s58 offen offset:1024 sc1 lds
    s_waitcnt lgkmcnt(8)
    v_mfma_f32_32x32x16_bf16 v[200:215], a[184:187], v[244:247], v[200:215]
    v_mfma_f32_32x32x16_bf16 v[216:231], a[188:191], v[244:247], v[216:231]
    ds_read_b128 v[240:243], v44 offset:59392
    buffer_load_dwordx4 v30, s[20:23], s58 offen offset:2048 sc1 lds
    s_waitcnt lgkmcnt(4)
    v_mfma_f32_32x32x16_bf16 v[200:215], a[192:195], v[232:235], v[200:215]
    s_waitcnt vmcnt(11)
    ds_read_b64_tr_b16 a[48:49], v26 offset:0
    ds_read_b64_tr_b16 a[50:51], v26 offset:1024
    v_mfma_f32_32x32x16_bf16 v[216:231], a[196:199], v[232:235], v[216:231]
    ds_read_b128 v[244:247], v44 offset:60416
    buffer_load_dwordx4 v31, s[20:23], s58 offen offset:3072 sc1 lds
    s_waitcnt lgkmcnt(4)
    v_mfma_f32_32x32x16_bf16 v[200:215], a[200:203], v[236:239], v[200:215]
    ds_read_b64_tr_b16 a[52:53], v27 offset:0
    ds_read_b64_tr_b16 a[54:55], v27 offset:1024
    ds_read_b64_tr_b16 a[56:57], v26 offset:2048
    ds_read_b64_tr_b16 a[58:59], v26 offset:3072
    v_mfma_f32_32x32x16_bf16 v[216:231], a[204:207], v[236:239], v[216:231]
    ds_read_b128 v[232:235], v44 offset:61440
    s_add_u32 m0, s47, 49152
    s_add_u32 s58, s51, 32768
    buffer_load_dwordx4 v28, s[20:23], s58 offen offset:0 sc1 lds
    s_waitcnt lgkmcnt(8)
    v_mfma_f32_32x32x16_bf16 v[200:215], a[208:211], v[240:243], v[200:215]
    ds_read_b64_tr_b16 a[60:61], v27 offset:2048
    ds_read_b64_tr_b16 a[62:63], v27 offset:3072
    v_mfma_f32_32x32x16_bf16 v[216:231], a[212:215], v[240:243], v[216:231]
    ds_read_b128 v[236:239], v44 offset:62464
    buffer_load_dwordx4 v29, s[20:23], s58 offen offset:1024 sc1 lds
    s_waitcnt lgkmcnt(8)
    v_mfma_f32_32x32x16_bf16 v[200:215], a[216:219], v[244:247], v[200:215]
    v_mfma_f32_32x32x16_bf16 v[216:231], a[220:223], v[244:247], v[216:231]
    ds_read_b128 v[240:243], v44 offset:63488
    buffer_load_dwordx4 v30, s[20:23], s58 offen offset:2048 sc1 lds
    s_waitcnt lgkmcnt(4)
    v_mfma_f32_32x32x16_bf16 v[200:215], a[224:227], v[232:235], v[200:215]
    s_waitcnt vmcnt(11)
    ds_read_b64_tr_b16 a[64:65], v24 offset:0
    ds_read_b64_tr_b16 a[66:67], v24 offset:1024
    v_mfma_f32_32x32x16_bf16 v[216:231], a[228:231], v[232:235], v[216:231]
    ds_read_b128 v[244:247], v44 offset:64512
    buffer_load_dwordx4 v31, s[20:23], s58 offen offset:3072 sc1 lds
    s_waitcnt lgkmcnt(4)
    v_mfma_f32_32x32x16_bf16 v[200:215], a[232:235], v[236:239], v[200:215]
    s_barrier
    ds_read_b64_tr_b16 a[68:69], v25 offset:0
    ds_read_b64_tr_b16 a[70:71], v25 offset:1024
    v_mfma_f32_32x32x16_bf16 v[216:231], a[236:239], v[236:239], v[216:231]
    s_cmp_le_u32 s37, 0
    s_cselect_b32 s58, s44, s43
    s_add_u32 s58, s58, 0
    buffer_load_dwordx4 a[144:147], v44, s[28:31], s58 offen offset:0 sc1
    s_waitcnt lgkmcnt(5)
    v_mfma_f32_32x32x16_bf16 v[200:215], a[240:243], v[240:243], v[200:215]
    ds_read_b64_tr_b16 a[72:73], v24 offset:2048
    ds_read_b64_tr_b16 a[74:75], v24 offset:3072
    ds_read_b64_tr_b16 a[76:77], v25 offset:2048
    ds_read_b64_tr_b16 a[78:79], v25 offset:3072
    v_mfma_f32_32x32x16_bf16 v[216:231], a[244:247], v[240:243], v[216:231]
    buffer_load_dwordx4 a[148:151], v44, s[28:31], s58 offen offset:1024 sc1
    s_waitcnt lgkmcnt(6)
    v_mfma_f32_32x32x16_bf16 v[200:215], a[248:251], v[244:247], v[200:215]
    v_mfma_f32_32x32x16_bf16 v[216:231], a[252:255], v[244:247], v[216:231]
    buffer_load_dwordx4 a[152:155], v44, s[28:31], s58 offen offset:2048 sc1
    v_mfma_f32_32x32x16_bf16 v[200:215], v[20:23], v[34:37], v[200:215]
    v_mfma_f32_32x32x16_bf16 v[216:231], v[20:23], v[32:35], v[216:231]
    buffer_load_dwordx4 a[156:159], v44, s[28:31], s58 offen offset:3072 sc1
    s_cmp_le_u32 s37, 1
    s_cselect_b32 s58, s44, s43
    s_add_u32 s58, s58, 12288
    buffer_load_dwordx4 a[160:163], v44, s[28:31], s58 offen offset:0 sc1
    s_nop 5
    v_pk_mul_f32 v[4:5], v[200:201], v[200:201]
    v_pk_mul_f32 v[6:7], v[202:203], v[202:203]
    v_pk_mul_f32 v[8:9], v[204:205], v[204:205]
    v_pk_mul_f32 v[10:11], v[206:207], v[206:207]
    v_pk_fma_f32 v[4:5], v[4:5], v[250:251], v[248:249] op_sel_hi:[1,0,0]
    v_pk_fma_f32 v[6:7], v[6:7], v[250:251], v[248:249] op_sel_hi:[1,0,0]
    v_pk_fma_f32 v[8:9], v[8:9], v[250:251], v[248:249] op_sel_hi:[1,0,0]
    v_pk_fma_f32 v[10:11], v[10:11], v[250:251], v[248:249] op_sel_hi:[1,0,0]
    v_pk_mul_f32 v[4:5], v[4:5], v[200:201]
    v_pk_mul_f32 v[6:7], v[6:7], v[202:203]
    v_pk_mul_f32 v[8:9], v[8:9], v[204:205]
    v_pk_mul_f32 v[10:11], v[10:11], v[206:207]
    v_exp_f32 v4, v4
    v_exp_f32 v5, v5
    v_exp_f32 v6, v6
    v_exp_f32 v7, v7
    v_exp_f32 v8, v8
    v_exp_f32 v9, v9
    v_exp_f32 v10, v10
    v_exp_f32_e64 v11, v11
    v_pk_fma_f32 v[4:5], v[4:5], v[252:253], v[252:253] op_sel_hi:[1,0,0]
    v_pk_fma_f32 v[6:7], v[6:7], v[252:253], v[252:253] op_sel_hi:[1,0,0]
    buffer_load_dwordx4 a[164:167], v44, s[28:31], s58 offen offset:1024 sc1
    v_pk_fma_f32 v[8:9], v[8:9], v[252:253], v[252:253] op_sel_hi:[1,0,0]
    v_pk_fma_f32 v[10:11], v[10:11], v[252:253], v[252:253] op_sel_hi:[1,0,0]
    v_rcp_f32 v4, v4
    v_rcp_f32 v5, v5
    v_rcp_f32 v6, v6
    v_rcp_f32 v7, v7
    v_rcp_f32 v8, v8
    v_rcp_f32 v9, v9
    v_rcp_f32 v10, v10
    v_rcp_f32 v11, v11
    v_pk_mul_f32 v[4:5], v[4:5], v[200:201]
    v_pk_mul_f32 v[6:7], v[6:7], v[202:203]
    v_pk_mul_f32 v[8:9], v[8:9], v[204:205]
    v_pk_mul_f32 v[10:11], v[10:11], v[206:207]
    v_cvt_pk_bf16_f32 v200, v4, v5
    v_cvt_pk_bf16_f32 v201, v6, v7
    v_cvt_pk_bf16_f32 v202, v8, v9
    v_cvt_pk_bf16_f32 v203, v10, v11
    buffer_store_dwordx4 v[200:203], v44, s[28:31], s62 offen offset:0 sc1
    v_pk_mul_f32 v[4:5], v[208:209], v[208:209]
    v_pk_mul_f32 v[6:7], v[210:211], v[210:211]
    v_pk_mul_f32 v[8:9], v[212:213], v[212:213]
    buffer_load_dwordx4 a[168:171], v44, s[28:31], s58 offen offset:2048 sc1
    v_pk_mul_f32 v[10:11], v[214:215], v[214:215]
    v_pk_fma_f32 v[4:5], v[4:5], v[250:251], v[248:249] op_sel_hi:[1,0,0]
    v_pk_fma_f32 v[6:7], v[6:7], v[250:251], v[248:249] op_sel_hi:[1,0,0]
    v_pk_fma_f32 v[8:9], v[8:9], v[250:251], v[248:249] op_sel_hi:[1,0,0]
    v_pk_fma_f32 v[10:11], v[10:11], v[250:251], v[248:249] op_sel_hi:[1,0,0]
    v_pk_mul_f32 v[4:5], v[4:5], v[208:209]
    v_pk_mul_f32 v[6:7], v[6:7], v[210:211]
    v_pk_mul_f32 v[8:9], v[8:9], v[212:213]
    v_pk_mul_f32 v[10:11], v[10:11], v[214:215]
    v_exp_f32 v4, v4
    v_exp_f32 v5, v5
    v_exp_f32 v6, v6
    v_exp_f32 v7, v7
    v_exp_f32 v8, v8
    v_exp_f32 v9, v9
    v_exp_f32 v10, v10
    v_exp_f32 v11, v11
    v_pk_fma_f32 v[4:5], v[4:5], v[252:253], v[252:253] op_sel_hi:[1,0,0]
    v_pk_fma_f32 v[6:7], v[6:7], v[252:253], v[252:253] op_sel_hi:[1,0,0]
    v_pk_fma_f32 v[8:9], v[8:9], v[252:253], v[252:253] op_sel_hi:[1,0,0]
    v_pk_fma_f32 v[10:11], v[10:11], v[252:253], v[252:253] op_sel_hi:[1,0,0]
    v_rcp_f32 v4, v4
    v_rcp_f32 v5, v5
    buffer_load_dwordx4 a[172:175], v44, s[28:31], s58 offen offset:3072 sc1
    v_rcp_f32 v6, v6
    v_rcp_f32 v7, v7
    v_rcp_f32 v8, v8
    v_rcp_f32 v9, v9
    v_rcp_f32 v10, v10
    v_rcp_f32 v11, v11
    v_pk_mul_f32 v[4:5], v[4:5], v[208:209]
    v_pk_mul_f32 v[6:7], v[6:7], v[210:211]
    v_pk_mul_f32 v[8:9], v[8:9], v[212:213]
    v_pk_mul_f32 v[10:11], v[10:11], v[214:215]
    v_cvt_pk_bf16_f32 v208, v4, v5
    v_cvt_pk_bf16_f32 v209, v6, v7
    v_cvt_pk_bf16_f32 v210, v8, v9
    v_cvt_pk_bf16_f32 v211, v10, v11
    buffer_store_dwordx4 v[208:211], v44, s[28:31], s62 offen offset:1024 sc1
    v_pk_mul_f32 v[4:5], v[216:217], v[216:217]
    v_pk_mul_f32 v[6:7], v[218:219], v[218:219]
    v_pk_mul_f32 v[8:9], v[220:221], v[220:221]
    v_pk_mul_f32 v[10:11], v[222:223], v[222:223]
    v_pk_fma_f32 v[4:5], v[4:5], v[250:251], v[248:249] op_sel_hi:[1,0,0]
    v_pk_fma_f32 v[6:7], v[6:7], v[250:251], v[248:249] op_sel_hi:[1,0,0]
    v_pk_fma_f32 v[8:9], v[8:9], v[250:251], v[248:249] op_sel_hi:[1,0,0]
    v_pk_fma_f32 v[10:11], v[10:11], v[250:251], v[248:249] op_sel_hi:[1,0,0]
    v_pk_mul_f32 v[4:5], v[4:5], v[216:217]
    s_cmp_le_u32 s37, 2
    s_cselect_b32 s58, s44, s43
    s_add_u32 s58, s58, 24576
    buffer_load_dwordx4 a[176:179], v44, s[28:31], s58 offen offset:0 sc1
    v_pk_mul_f32 v[6:7], v[6:7], v[218:219]
    v_pk_mul_f32 v[8:9], v[8:9], v[220:221]
    v_pk_mul_f32 v[10:11], v[10:11], v[222:223]
    v_exp_f32 v4, v4
    v_exp_f32 v5, v5
    v_exp_f32 v6, v6
    v_exp_f32 v7, v7
    v_exp_f32 v8, v8
    v_exp_f32 v9, v9
    v_exp_f32 v10, v10
    v_exp_f32 v11, v11
    v_pk_fma_f32 v[4:5], v[4:5], v[252:253], v[252:253] op_sel_hi:[1,0,0]
    v_pk_fma_f32 v[6:7], v[6:7], v[252:253], v[252:253] op_sel_hi:[1,0,0]
    v_pk_fma_f32 v[8:9], v[8:9], v[252:253], v[252:253] op_sel_hi:[1,0,0]
    v_pk_fma_f32 v[10:11], v[10:11], v[252:253], v[252:253] op_sel_hi:[1,0,0]
    v_rcp_f32 v4, v4
    v_rcp_f32 v5, v5
    v_rcp_f32 v6, v6
    v_rcp_f32 v7, v7
    buffer_load_dwordx4 a[180:183], v44, s[28:31], s58 offen offset:1024 sc1
    v_rcp_f32 v8, v8
    v_rcp_f32 v9, v9
    v_rcp_f32 v10, v10
    v_rcp_f32 v11, v11
    v_pk_mul_f32 v[4:5], v[4:5], v[216:217]
    v_pk_mul_f32 v[6:7], v[6:7], v[218:219]
    v_pk_mul_f32 v[8:9], v[8:9], v[220:221]
    v_pk_mul_f32 v[10:11], v[10:11], v[222:223]
    v_cvt_pk_bf16_f32 v216, v4, v5
    v_cvt_pk_bf16_f32 v217, v6, v7
    v_cvt_pk_bf16_f32 v218, v8, v9
    v_cvt_pk_bf16_f32 v219, v10, v11
    buffer_store_dwordx4 v[216:219], v44, s[28:31], s62 offen offset:2048 sc1
    v_pk_mul_f32 v[4:5], v[224:225], v[224:225]
    v_pk_mul_f32 v[6:7], v[226:227], v[226:227]
    v_pk_mul_f32 v[8:9], v[228:229], v[228:229]
    v_pk_mul_f32 v[10:11], v[230:231], v[230:231]
    v_pk_fma_f32 v[4:5], v[4:5], v[250:251], v[248:249] op_sel_hi:[1,0,0]
    v_pk_fma_f32 v[6:7], v[6:7], v[250:251], v[248:249] op_sel_hi:[1,0,0]
    v_pk_fma_f32 v[8:9], v[8:9], v[250:251], v[248:249] op_sel_hi:[1,0,0]
    v_pk_fma_f32 v[10:11], v[10:11], v[250:251], v[248:249] op_sel_hi:[1,0,0]
    v_pk_mul_f32 v[4:5], v[4:5], v[224:225]
    v_pk_mul_f32 v[6:7], v[6:7], v[226:227]
    v_pk_mul_f32 v[8:9], v[8:9], v[228:229]
    v_pk_mul_f32 v[10:11], v[10:11], v[230:231]
    v_exp_f32_e64 v4, v4
    buffer_load_dwordx4 a[184:187], v44, s[28:31], s58 offen offset:2048 sc1
    v_exp_f32 v5, v5
    v_exp_f32 v6, v6
    v_exp_f32 v7, v7
    v_exp_f32 v8, v8
    v_exp_f32 v9, v9
    v_exp_f32 v10, v10
    v_exp_f32_e64 v11, v11
    v_pk_fma_f32 v[4:5], v[4:5], v[252:253], v[252:253] op_sel_hi:[1,0,0]
    v_pk_fma_f32 v[6:7], v[6:7], v[252:253], v[252:253] op_sel_hi:[1,0,0]
    v_pk_fma_f32 v[8:9], v[8:9], v[252:253], v[252:253] op_sel_hi:[1,0,0]
    v_pk_fma_f32 v[10:11], v[10:11], v[252:253], v[252:253] op_sel_hi:[1,0,0]
    v_rcp_f32 v4, v4
    v_rcp_f32 v5, v5
    v_rcp_f32 v6, v6
    v_rcp_f32 v7, v7
    v_rcp_f32 v8, v8
    v_rcp_f32 v9, v9
    v_rcp_f32 v10, v10
    v_rcp_f32 v11, v11
    buffer_load_dwordx4 a[188:191], v44, s[28:31], s58 offen offset:3072 sc1
    v_pk_mul_f32 v[4:5], v[4:5], v[224:225]
    v_pk_mul_f32 v[6:7], v[6:7], v[226:227]
    v_pk_mul_f32 v[8:9], v[8:9], v[228:229]
    v_pk_mul_f32 v[10:11], v[10:11], v[230:231]
    v_cvt_pk_bf16_f32 v224, v4, v5
    v_cvt_pk_bf16_f32 v225, v6, v7
    v_cvt_pk_bf16_f32 v226, v8, v9
    v_cvt_pk_bf16_f32 v227, v10, v11
    buffer_store_dwordx4 v[224:227], v44, s[28:31], s62 offen offset:3072 sc1
    s_waitcnt vmcnt(15)
    v_mfma_f32_32x32x16_bf16 v[168:183], v[72:75], a[144:147], 0
    s_cmp_le_u32 s37, 3
    s_cselect_b32 s58, s44, s43
    s_add_u32 s58, s58, 36864
    buffer_load_dwordx4 a[192:195], v44, s[28:31], s58 offen offset:0 sc1
    v_accvgpr_write_b32 a240, v200
    v_mfma_f32_32x32x16_bf16 v[184:199], v[76:79], a[144:147], 0
    ds_read_b64_tr_b16 a[80:81], v24 offset:16384
    ds_read_b64_tr_b16 a[82:83], v24 offset:17408
    v_accvgpr_write_b32 a241, v201
    v_accvgpr_write_b32 a242, v202
    s_waitcnt vmcnt(15)
    v_mfma_f32_32x32x16_bf16 v[168:183], v[80:83], a[148:151], v[168:183]
    buffer_load_dwordx4 a[196:199], v44, s[28:31], s58 offen offset:1024 sc1
    ds_read_b64_tr_b16 a[84:85], v25 offset:16384
    ds_read_b64_tr_b16 a[86:87], v25 offset:17408
    v_mfma_f32_32x32x16_bf16 v[184:199], v[84:87], a[148:151], v[184:199]
    ds_read_b64_tr_b16 a[88:89], v24 offset:18432
    ds_read_b64_tr_b16 a[90:91], v24 offset:19456
    v_accvgpr_write_b32 a243, v203
    v_accvgpr_write_b32 a244, v208
    v_accvgpr_write_b32 a245, v209
    s_waitcnt vmcnt(15)
    v_mfma_f32_32x32x16_bf16 v[168:183], v[88:91], a[152:155], v[168:183]
    buffer_load_dwordx4 a[200:203], v44, s[28:31], s58 offen offset:2048 sc1
    ds_read_b64_tr_b16 a[92:93], v25 offset:18432
    ds_read_b64_tr_b16 a[94:95], v25 offset:19456
    v_mfma_f32_32x32x16_bf16 v[184:199], v[92:95], a[152:155], v[184:199]
    ds_read_b64_tr_b16 a[96:97], v24 offset:32768
    ds_read_b64_tr_b16 a[98:99], v24 offset:33792
    v_accvgpr_write_b32 a246, v210
    v_accvgpr_write_b32 a247, v211
    s_waitcnt vmcnt(15)
    v_mfma_f32_32x32x16_bf16 v[168:183], v[96:99], a[156:159], v[168:183]
    buffer_load_dwordx4 a[204:207], v44, s[28:31], s58 offen offset:3072 sc1
    ds_read_b64_tr_b16 a[100:101], v25 offset:32768
    ds_read_b64_tr_b16 a[102:103], v25 offset:33792
    v_mfma_f32_32x32x16_bf16 v[184:199], v[100:103], a[156:159], v[184:199]
    ds_read_b64_tr_b16 a[104:105], v24 offset:34816
    ds_read_b64_tr_b16 a[106:107], v24 offset:35840
    v_accvgpr_write_b32 a248, v216
    v_accvgpr_write_b32 a249, v217
    v_accvgpr_write_b32 a250, v218
    s_waitcnt vmcnt(15)
    v_mfma_f32_32x32x16_bf16 v[168:183], v[104:107], a[160:163], v[168:183]
    s_cmp_le_u32 s37, 4
    s_cselect_b32 s58, s44, s43
    s_add_u32 s58, s58, 49152
    buffer_load_dwordx4 a[208:211], v44, s[28:31], s58 offen offset:0 sc1
    v_accvgpr_write_b32 a251, v219
    v_mfma_f32_32x32x16_bf16 v[184:199], v[108:111], a[160:163], v[184:199]
    ds_read_b64_tr_b16 a[108:109], v25 offset:34816
    ds_read_b64_tr_b16 a[110:111], v25 offset:35840
    v_accvgpr_write_b32 a252, v224
    v_accvgpr_write_b32 a253, v225
    v_accvgpr_write_b32 a254, v226
    s_waitcnt vmcnt(15)
    v_mfma_f32_32x32x16_bf16 v[168:183], v[112:115], a[164:167], v[168:183]
    buffer_load_dwordx4 a[212:215], v44, s[28:31], s58 offen offset:1024 sc1
    v_accvgpr_write_b32 a255, v227
    s_lshl_b32 s41, s63, 5
    s_add_u32 s41, s41, s36
    v_lshl_add_u32 v41, v48, 6, s41
    v_mfma_f32_32x32x16_bf16 v[184:199], v[116:119], a[164:167], v[184:199]
    ds_read_b64_tr_b16 a[112:113], v24 offset:49152
    ds_read_b64_tr_b16 a[114:115], v24 offset:50176
    v_mul_i32_i24_e64 v41, s57, v41
    v_cvt_f32_i32 v41, v41
    s_waitcnt vmcnt(14)
    v_mfma_f32_32x32x16_bf16 v[168:183], v[120:123], a[168:171], v[168:183]
    buffer_load_dwordx4 a[216:219], v44, s[28:31], s58 offen offset:2048 sc1
    ds_read_b64_tr_b16 a[116:117], v25 offset:49152
    ds_read_b64_tr_b16 a[118:119], v25 offset:50176
    v_mfma_f32_32x32x16_bf16 v[184:199], v[124:127], a[168:171], v[184:199]
    ds_read_b64_tr_b16 a[120:121], v24 offset:51200
    ds_read_b64_tr_b16 a[122:123], v24 offset:52224
    v_mul_f32 v41, 0x3a000000, v41
    v_cvt_f32_u32_e64 v43, v47
    v_mul_f32 v43, 2.0, v43
    s_waitcnt vmcnt(14)
    v_mfma_f32_32x32x16_bf16 v[168:183], v[128:131], a[172:175], v[168:183]
    buffer_load_dwordx4 a[220:223], v44, s[28:31], s58 offen offset:3072 sc1
    ds_read_b64_tr_b16 a[124:125], v25 offset:51200
    ds_read_b64_tr_b16 a[126:127], v25 offset:52224
    v_mfma_f32_32x32x16_bf16 v[184:199], v[132:135], a[172:175], v[184:199]
    v_mul_f32 v43, v43, v41
    v_mul_f32 v68, 4.0, v41
    v_cos_f32_e64 v68, v68
    v_fmamk_f32 v20, v41, 0x00000000, v43
    v_fmamk_f32 v21, v41, 0x42000000, v43
    s_waitcnt vmcnt(13)
    v_mfma_f32_32x32x16_bf16 v[168:183], v[136:139], a[176:179], v[168:183]
    s_cmp_le_u32 s37, 5
    s_cselect_b32 s58, s44, s43
    s_add_u32 s58, s58, 61440
    buffer_load_dwordx4 a[224:227], v44, s[28:31], s58 offen offset:0 sc1
    v_fmamk_f32 v22, v41, 0x3f800000, v43
    v_mfma_f32_32x32x16_bf16 v[184:199], v[140:143], a[176:179], v[184:199]
    v_fmamk_f32 v23, v41, 0x42040000, v43
    v_cos_f32 v232, v20
    v_sin_f32 v233, v20
    s_waitcnt vmcnt(13)
    v_mfma_f32_32x32x16_bf16 v[168:183], v[144:147], a[180:183], v[168:183]
    buffer_load_dwordx4 a[228:231], v44, s[28:31], s58 offen offset:1024 sc1
    v_cos_f32 v234, v21
    v_sin_f32 v235, v21
    v_mfma_f32_32x32x16_bf16 v[184:199], v[148:151], a[180:183], v[184:199]
    v_cos_f32 v236, v22
    v_sin_f32 v237, v22
    v_cos_f32 v238, v23
    s_waitcnt vmcnt(12)
    v_mfma_f32_32x32x16_bf16 v[168:183], v[152:155], a[184:187], v[168:183]
    buffer_load_dwordx4 a[232:235], v44, s[28:31], s58 offen offset:2048 sc1
    v_sin_f32_e64 v239, v23
    v_fmamk_f32 v20, v41, 0x40800000, v43
    v_fmamk_f32 v21, v41, 0x42100000, v43
    v_mfma_f32_32x32x16_bf16 v[184:199], v[156:159], a[184:187], v[184:199]
    v_fmamk_f32 v22, v41, 0x40a00000, v43
    v_fmamk_f32 v23, v41, 0x42140000, v43
    v_cos_f32_e64 v240, v20
    v_sin_f32 v241, v20
    s_waitcnt vmcnt(12)
    v_mfma_f32_32x32x16_bf16 v[168:183], v[160:163], a[188:191], v[168:183]
    buffer_load_dwordx4 a[236:239], v44, s[28:31], s58 offen offset:3072 sc1
    v_cos_f32 v242, v21
    v_sin_f32 v243, v21
    v_mfma_f32_32x32x16_bf16 v[184:199], v[164:167], a[188:191], v[184:199]
    v_cos_f32 v244, v22
    v_sin_f32 v245, v22
    v_cos_f32_e64 v246, v23
    s_waitcnt vmcnt(12)
    s_waitcnt lgkmcnt(0)
    s_barrier
    s_waitcnt vmcnt(11)
    v_mfma_f32_32x32x16_bf16 v[168:183], a[0:3], a[192:195], v[168:183]
    s_add_u32 m0, s47, 65536
    s_add_u32 s58, s45, 5505024
    buffer_load_dwordx4 v2, s[28:31], s58 offen sc1 lds
    v_mfma_f32_32x32x16_bf16 v[184:199], a[4:7], a[192:195], v[184:199]
    v_sin_f32 v247, v23
    v_add_f32 v68, v68, v68
    v_cvt_pk_bf16_f32 v200, v232, v233
    v_cvt_pk_bf16_f32 v201, v234, v235
    v_cvt_pk_bf16_f32 v202, v236, v237
    s_waitcnt vmcnt(11)
    v_mfma_f32_32x32x16_bf16 v[168:183], a[8:11], a[196:199], v[168:183]
    s_add_u32 m0, s47, 66560
    s_add_u32 s58, s45, 5509632
    buffer_load_dwordx4 v2, s[28:31], s58 offen sc1 lds
    v_cvt_pk_bf16_f32 v203, v238, v239
    v_fma_f32 v232, v240, v68, -v232
    v_mfma_f32_32x32x16_bf16 v[184:199], a[12:15], a[196:199], v[184:199]
    v_fma_f32 v233, v241, v68, -v233
    v_fma_f32 v234, v242, v68, -v234
    v_fma_f32 v235, v243, v68, -v235
    v_fma_f32 v236, v244, v68, -v236
    v_fma_f32 v237, v245, v68, -v237
    v_fma_f32 v238, v246, v68, -v238
    s_waitcnt vmcnt(11)
    v_mfma_f32_32x32x16_bf16 v[168:183], a[16:19], a[200:203], v[168:183]
    s_add_u32 m0, s47, 67584
    s_add_u32 s58, s45, 5514240
    buffer_load_dwordx4 v2, s[28:31], s58 offen sc1 lds
    v_fma_f32 v239, v247, v68, -v239
    v_cvt_pk_bf16_f32 v204, v240, v241
    v_mfma_f32_32x32x16_bf16 v[184:199], a[20:23], a[200:203], v[184:199]
    v_cvt_pk_bf16_f32 v205, v242, v243
    v_cvt_pk_bf16_f32 v206, v244, v245
    v_cvt_pk_bf16_f32 v207, v246, v247
    v_fma_f32 v240, v232, v68, -v240
    v_fma_f32 v241, v233, v68, -v241
    v_fma_f32 v242, v234, v68, -v242
    s_waitcnt vmcnt(11)
    v_mfma_f32_32x32x16_bf16 v[168:183], a[24:27], a[204:207], v[168:183]
    s_add_u32 m0, s47, 68608
    s_add_u32 s58, s45, 5518848
    buffer_load_dwordx4 v2, s[28:31], s58 offen sc1 lds
    v_fma_f32 v243, v235, v68, -v243
    v_fma_f32 v244, v236, v68, -v244
    v_mfma_f32_32x32x16_bf16 v[184:199], a[28:31], a[204:207], v[184:199]
    v_fma_f32 v245, v237, v68, -v245
    v_fma_f32 v246, v238, v68, -v246
    v_fma_f32 v247, v239, v68, -v247
    v_cvt_pk_bf16_f32 v208, v232, v233
    v_cvt_pk_bf16_f32 v209, v234, v235
    v_cvt_pk_bf16_f32 v210, v236, v237
    s_waitcnt vmcnt(11)
    v_mfma_f32_32x32x16_bf16 v[168:183], a[32:35], a[208:211], v[168:183]
    v_cvt_pk_bf16_f32 v211, v238, v239
    v_fma_f32 v232, v240, v68, -v232
    v_fma_f32 v233, v241, v68, -v233
    v_fma_f32 v234, v242, v68, -v234
    v_fma_f32 v235, v243, v68, -v235
    v_fma_f32 v236, v244, v68, -v236
    v_mfma_f32_32x32x16_bf16 v[184:199], a[36:39], a[208:211], v[184:199]
    v_fma_f32 v237, v245, v68, -v237
    v_fma_f32 v238, v246, v68, -v238
    v_fma_f32 v239, v247, v68, -v239
    v_cvt_pk_bf16_f32 v212, v240, v241
    v_cvt_pk_bf16_f32 v213, v242, v243
    v_cvt_pk_bf16_f32 v214, v244, v245
    s_waitcnt vmcnt(10)
    v_mfma_f32_32x32x16_bf16 v[168:183], a[40:43], a[212:215], v[168:183]
    v_cvt_pk_bf16_f32 v215, v246, v247
    v_fma_f32 v240, v232, v68, -v240
    v_fma_f32 v241, v233, v68, -v241
    v_fma_f32 v242, v234, v68, -v242
    v_fma_f32 v243, v235, v68, -v243
    v_fma_f32 v244, v236, v68, -v244
    v_mfma_f32_32x32x16_bf16 v[184:199], a[44:47], a[212:215], v[184:199]
    v_fma_f32 v245, v237, v68, -v245
    v_fma_f32 v246, v238, v68, -v246
    v_fma_f32 v247, v239, v68, -v247
    v_cvt_pk_bf16_f32 v216, v232, v233
    v_cvt_pk_bf16_f32 v217, v234, v235
    v_cvt_pk_bf16_f32 v218, v236, v237
    s_waitcnt vmcnt(9)
    v_mfma_f32_32x32x16_bf16 v[168:183], a[48:51], a[216:219], v[168:183]
    v_cvt_pk_bf16_f32 v219, v238, v239
    v_fma_f32 v232, v240, v68, -v232
    v_fma_f32 v233, v241, v68, -v233
    v_fma_f32 v234, v242, v68, -v234
    v_fma_f32 v235, v243, v68, -v235
    v_fma_f32 v236, v244, v68, -v236
    v_mfma_f32_32x32x16_bf16 v[184:199], a[52:55], a[216:219], v[184:199]
    v_fma_f32 v237, v245, v68, -v237
    v_fma_f32 v238, v246, v68, -v238
    v_fma_f32 v239, v247, v68, -v239
    v_cvt_pk_bf16_f32 v220, v240, v241
    v_cvt_pk_bf16_f32 v221, v242, v243
    v_cvt_pk_bf16_f32 v222, v244, v245
    s_waitcnt vmcnt(8)
    v_mfma_f32_32x32x16_bf16 v[168:183], a[56:59], a[220:223], v[168:183]
    v_cvt_pk_bf16_f32 v223, v246, v247
    v_fma_f32 v240, v232, v68, -v240
    v_fma_f32 v241, v233, v68, -v241
    v_fma_f32 v242, v234, v68, -v242
    v_fma_f32 v243, v235, v68, -v243
    v_fma_f32 v244, v236, v68, -v244
    v_mfma_f32_32x32x16_bf16 v[184:199], a[60:63], a[220:223], v[184:199]
    v_fma_f32 v245, v237, v68, -v245
    v_fma_f32 v246, v238, v68, -v246
    v_fma_f32 v247, v239, v68, -v247
    v_cvt_pk_bf16_f32 v224, v232, v233
    v_cvt_pk_bf16_f32 v225, v234, v235
    v_cvt_pk_bf16_f32 v226, v236, v237
    s_waitcnt vmcnt(7)
    v_mfma_f32_32x32x16_bf16 v[168:183], a[64:67], a[224:227], v[168:183]
    v_cvt_pk_bf16_f32 v227, v238, v239
    v_cvt_pk_bf16_f32 v228, v240, v241
    v_cvt_pk_bf16_f32 v229, v242, v243
    v_cvt_pk_bf16_f32 v230, v244, v245
    v_cvt_pk_bf16_f32 v231, v246, v247
    v_lshlrev_b32_e64 v1, 16, v45
    v_mfma_f32_32x32x16_bf16 v[184:199], a[68:71], a[224:227], v[184:199]
    v_lshl_add_u32 v1, v46, 4, v1
    s_lshl_b32 s54, s38, 19
    s_lshl_b32 s41, s36, 10
    s_add_u32 s54, s54, s41
    s_lshl_b32 s41, s37, 7
    s_add_u32 s54, s54, s41
    s_waitcnt vmcnt(6)
    v_mfma_f32_32x32x16_bf16 v[168:183], a[72:75], a[228:231], v[168:183]
    s_add_u32 s59, s54, 32768
    s_lshl_b32 s41, s3, 5
    v_add_u32 v41, s41, v48
    v_mul_i32_i24_e64 v41, s57, v41
    s_ashr_i32 s41, s57, 1
    s_and_b32 s41, s41, 63
    s_add_u32 s41, s41, 10240
    v_mfma_f32_32x32x16_bf16 v[184:199], a[76:79], a[228:231], v[184:199]
    v_add_lshl_u32 v41, v41, s41, 3
    v_lshl_add_u32 v41, v47, 10, v41
    s_lshl_b32 s41, s38, 13
    v_xor_b32 v42, v47, v46
    v_lshl_add_u32 v42, v42, 4, s41
    v_lshl_add_u32 v3, v48, 8, v42
    s_waitcnt vmcnt(5)
    v_mfma_f32_32x32x16_bf16 v[168:183], a[80:83], a[232:235], v[168:183]
    v_xor_b32 v36, 32, v3
    v_xor_b32_e64 v37, 64, v3
    v_xor_b32 v49, 96, v3
    s_lshl_b32 s42, s63, 13
    s_sub_u32 s42, s42, s41
    s_lshl_b32 s41, s3, 7
    v_mfma_f32_32x32x16_bf16 v[184:199], a[84:87], a[232:235], v[184:199]
    s_add_u32 s42, s42, s41
    s_add_u32 s62, s42, 32768
    s_sub_u32 s48, 65536, s62
    s_lshl_b32 s41, s38, 11
    v_lshlrev_b32 v43, 1, v46
    v_xor_b32_e64 v43, v43, v45
    v_lshl_add_u32 v43, v43, 4, s41
    s_waitcnt vmcnt(4)
    v_mfma_f32_32x32x16_bf16 v[168:183], a[88:91], a[236:239], v[168:183]
    v_lshl_add_u32 v50, v45, 8, v43
    v_xor_b32 v51, 16, v50
    v_mfma_f32_32x32x16_bf16 v[184:199], a[92:95], a[236:239], v[184:199]
    v_mfma_f32_32x32x16_bf16 v[168:183], a[96:99], a[128:131], v[168:183]
    v_mfma_f32_32x32x16_bf16 v[184:199], a[100:103], a[128:131], v[184:199]
    v_mfma_f32_32x32x16_bf16 v[168:183], a[104:107], a[132:135], v[168:183]
    v_mfma_f32_32x32x16_bf16 v[184:199], a[108:111], a[132:135], v[184:199]
    s_waitcnt vmcnt(0)
    s_barrier
    s_cmp_le_u32 s37, 0
    s_cselect_b32 s58, s44, s43
    s_add_u32 s58, s58, 114688
    buffer_load_dwordx4 a[144:147], v44, s[28:31], s58 offen offset:0 sc1
    buffer_load_dwordx4 a[148:151], v44, s[28:31], s58 offen offset:1024 sc1
    buffer_load_dwordx4 a[152:155], v44, s[28:31], s58 offen offset:2048 sc1
    v_mfma_f32_32x32x16_bf16 v[168:183], a[112:115], a[136:139], v[168:183]
    ds_read_b64 v[20:21], v41 offset:49152
    ds_read_b64 v[22:23], v41 offset:49664
    ds_read_b64 v[12:13], v41 offset:51200
    v_mfma_f32_32x32x16_bf16 v[184:199], a[116:119], a[136:139], v[184:199]
    buffer_load_dwordx4 a[156:159], v44, s[28:31], s58 offen offset:3072 sc1
    ds_read_b64 v[14:15], v41 offset:51712
    ds_read_b64 v[32:33], v41 offset:53248
    v_mfma_f32_32x32x16_bf16 v[168:183], a[120:123], a[140:143], v[168:183]
    ds_read_b64 v[34:35], v41 offset:53760
    v_mfma_f32_32x32x16_bf16 v[184:199], a[124:127], a[140:143], v[184:199]
    s_cmp_le_u32 s37, 1
    s_cselect_b32 s58, s44, s43
    s_add_u32 s58, s58, 126976
    buffer_load_dwordx4 a[160:163], v44, s[28:31], s58 offen offset:0 sc1
    s_waitcnt lgkmcnt(4)
    v_mfma_f32_32x32x16_bf16 v[232:247], v[20:23], v[200:203], 0
    ds_read_b64 v[16:17], v41 offset:55296
    ds_read_b64 v[18:19], v41 offset:55808
    buffer_load_dwordx4 a[164:167], v44, s[28:31], s58 offen offset:1024 sc1
    s_waitcnt lgkmcnt(4)
    v_mfma_f32_32x32x16_bf16 v[232:247], v[12:15], v[204:207], v[232:247]
    ds_read_b64 v[20:21], v41 offset:57344
    ds_read_b64 v[22:23], v41 offset:57856
    ds_write_b128 v3, v[168:171] offset:0
    s_waitcnt lgkmcnt(5)
    v_mfma_f32_32x32x16_bf16 v[232:247], v[32:35], v[208:211], v[232:247]
    ds_read_b64 v[12:13], v41 offset:59392
    ds_read_b64 v[14:15], v41 offset:59904
    buffer_load_dwordx4 a[168:171], v44, s[28:31], s58 offen offset:2048 sc1
    s_waitcnt lgkmcnt(5)
    v_mfma_f32_32x32x16_bf16 v[232:247], v[16:19], v[212:215], v[232:247]
    ds_read_b64 v[32:33], v41 offset:12288
    ds_read_b64 v[34:35], v41 offset:12800
    ds_write_b128 v36, v[172:175] offset:0
    s_waitcnt lgkmcnt(6)
    v_mfma_f32_32x32x16_bf16 v[232:247], v[20:23], v[216:219], v[232:247]
    ds_read_b64 v[16:17], v41 offset:14336
    ds_read_b64 v[18:19], v41 offset:14848
    buffer_load_dwordx4 a[172:175], v44, s[28:31], s58 offen offset:3072 sc1
    s_waitcnt lgkmcnt(5)
    v_mfma_f32_32x32x16_bf16 v[232:247], v[12:15], v[220:223], v[232:247]
    ds_write_b128 v37, v[176:179] offset:0
    s_waitcnt lgkmcnt(4)
    v_mfma_f32_32x32x16_bf16 v[232:247], v[32:35], v[224:227], v[232:247]
    s_cmp_le_u32 s37, 2
    s_cselect_b32 s58, s44, s43
    s_add_u32 s58, s58, 139264
    buffer_load_dwordx4 a[176:179], v44, s[28:31], s58 offen offset:0 sc1
    s_waitcnt lgkmcnt(1)
    v_mfma_f32_32x32x16_bf16 v[232:247], v[16:19], v[228:231], v[232:247]
    ds_write_b128 v49, v[180:183] offset:0
    buffer_load_dwordx4 a[180:183], v44, s[28:31], s58 offen offset:1024 sc1
    v_mfma_f32_32x32x16_bf16 v[200:215], a[96:99], a[240:243], 0
    s_mov_b32 s60, 0xbfb8aa3b
    v_mfma_f32_32x32x16_bf16 v[216:231], a[100:103], a[240:243], 0
    ds_write_b128 v3, v[184:187] offset:128
    v_add_u32_e64 v3, s62, v3
    v_mfma_f32_32x32x16_bf16 v[200:215], a[104:107], a[244:247], v[200:215]
    buffer_load_dwordx4 a[184:187], v44, s[28:31], s58 offen offset:2048 sc1
    v_mfma_f32_32x32x16_bf16 v[216:231], a[108:111], a[244:247], v[216:231]
    ds_write_b128 v36, v[188:191] offset:128
    v_add_u32_e64 v36, s62, v36
    v_mfma_f32_32x32x16_bf16 v[200:215], a[112:115], a[248:251], v[200:215]
    buffer_load_dwordx4 a[188:191], v44, s[28:31], s58 offen offset:3072 sc1
    v_mfma_f32_32x32x16_bf16 v[216:231], a[116:119], a[248:251], v[216:231]
    ds_write_b128 v37, v[192:195] offset:128
    v_add_u32_e64 v37, s62, v37
    v_mfma_f32_32x32x16_bf16 v[200:215], a[120:123], a[252:255], v[200:215]
    s_cmp_le_u32 s37, 3
    s_cselect_b32 s58, s44, s43
    s_add_u32 s58, s58, 151552
    buffer_load_dwordx4 a[192:195], v44, s[28:31], s58 offen offset:0 sc1
    v_mfma_f32_32x32x16_bf16 v[216:231], a[124:127], a[252:255], v[216:231]
    ds_write_b128 v49, v[196:199] offset:128
    v_add_u32 v49, s62, v49
    s_waitcnt vmcnt(12)
    v_mfma_f32_32x32x16_bf16 v[200:215], v[72:75], a[144:147], v[200:215]
    buffer_load_dwordx4 a[196:199], v44, s[28:31], s58 offen offset:1024 sc1
    v_mfma_f32_32x32x16_bf16 v[216:231], v[76:79], a[144:147], v[216:231]
    ds_write_b128 v3, v[232:235]
    v_add_u32 v3, s48, v3
    s_waitcnt vmcnt(12)
    v_mfma_f32_32x32x16_bf16 v[200:215], v[80:83], a[148:151], v[200:215]
    buffer_load_dwordx4 a[200:203], v44, s[28:31], s58 offen offset:2048 sc1
    v_mfma_f32_32x32x16_bf16 v[216:231], v[84:87], a[148:151], v[216:231]
    ds_write_b128 v36, v[236:239]
    v_add_u32 v36, s48, v36
    s_waitcnt vmcnt(12)
    v_mfma_f32_32x32x16_bf16 v[200:215], v[88:91], a[152:155], v[200:215]
    buffer_load_dwordx4 a[204:207], v44, s[28:31], s58 offen offset:3072 sc1
    v_mfma_f32_32x32x16_bf16 v[216:231], v[92:95], a[152:155], v[216:231]
    ds_write_b128 v37, v[240:243]
    v_add_u32 v37, s48, v37
    s_waitcnt vmcnt(12)
    v_mfma_f32_32x32x16_bf16 v[200:215], v[96:99], a[156:159], v[200:215]
    s_cmp_le_u32 s37, 4
    s_cselect_b32 s58, s44, s43
    s_add_u32 s58, s58, 163840
    buffer_load_dwordx4 a[208:211], v44, s[28:31], s58 offen offset:0 sc1
    v_mfma_f32_32x32x16_bf16 v[216:231], v[100:103], a[156:159], v[216:231]
    ds_write_b128 v49, v[244:247]
    v_add_u32 v49, s48, v49
    s_waitcnt vmcnt(12)
    v_mfma_f32_32x32x16_bf16 v[200:215], v[104:107], a[160:163], v[200:215]
    buffer_load_dwordx4 a[212:215], v44, s[28:31], s58 offen offset:1024 sc1
    v_mfma_f32_32x32x16_bf16 v[216:231], v[108:111], a[160:163], v[216:231]
    s_waitcnt vmcnt(12)
    v_mfma_f32_32x32x16_bf16 v[200:215], v[112:115], a[164:167], v[200:215]
    buffer_load_dwordx4 a[216:219], v44, s[28:31], s58 offen offset:2048 sc1
    v_mfma_f32_32x32x16_bf16 v[216:231], v[116:119], a[164:167], v[216:231]
    s_waitcnt vmcnt(12)
    v_mfma_f32_32x32x16_bf16 v[200:215], v[120:123], a[168:171], v[200:215]
    buffer_load_dwordx4 a[220:223], v44, s[28:31], s58 offen offset:3072 sc1
    v_mfma_f32_32x32x16_bf16 v[216:231], v[124:127], a[168:171], v[216:231]
    s_waitcnt lgkmcnt(0)
    s_barrier
    ds_read_b128 v[168:171], v50 offset:0
    ds_read_b128 v[172:175], v51 offset:0
    s_waitcnt vmcnt(12)
    v_mfma_f32_32x32x16_bf16 v[200:215], v[128:131], a[172:175], v[200:215]
    s_cmp_le_u32 s37, 5
    s_cselect_b32 s58, s44, s43
    s_add_u32 s58, s58, 176128
    buffer_load_dwordx4 a[224:227], v44, s[28:31], s58 offen offset:0 sc1
    v_mfma_f32_32x32x16_bf16 v[216:231], v[132:135], a[172:175], v[216:231]
    ds_read_b128 v[176:179], v50 offset:8192
    ds_read_b128 v[180:183], v51 offset:8192
    ds_read_b128 v[184:187], v50 offset:16384
    s_waitcnt vmcnt(12)
    v_mfma_f32_32x32x16_bf16 v[200:215], v[136:139], a[176:179], v[200:215]
    buffer_load_dwordx4 a[228:231], v44, s[28:31], s58 offen offset:1024 sc1
    ds_read_b128 v[188:191], v51 offset:16384
    ds_read_b128 v[192:195], v50 offset:24576
    v_mfma_f32_32x32x16_bf16 v[216:231], v[140:143], a[176:179], v[216:231]
    ds_read_b128 v[196:199], v51 offset:24576
    ds_read_b128 v[12:15], v50 offset:32768
    ds_read_b128 v[16:19], v51 offset:32768
    v_lshlrev_b32 v4, 16, v52
    s_waitcnt vmcnt(12)
    v_mfma_f32_32x32x16_bf16 v[200:215], v[144:147], a[180:183], v[200:215]
    buffer_load_dwordx4 a[232:235], v44, s[28:31], s58 offen offset:2048 sc1
    v_and_b32 v5, 0xffff0000, v52
    v_lshlrev_b32_e64 v6, 16, v53
    v_and_b32 v7, 0xffff0000, v53
    v_lshlrev_b32_e64 v8, 16, v54
    v_mfma_f32_32x32x16_bf16 v[216:231], v[148:151], a[180:183], v[216:231]
    v_and_b32 v9, 0xffff0000, v54
    v_lshlrev_b32_e64 v10, 16, v55
    v_and_b32 v11, 0xffff0000, v55
    v_lshlrev_b32_e64 v232, 16, v60
    v_and_b32 v233, 0xffff0000, v60
    v_lshlrev_b32 v234, 16, v61
    s_waitcnt vmcnt(12)
    v_mfma_f32_32x32x16_bf16 v[200:215], v[152:155], a[184:187], v[200:215]
    buffer_load_dwordx4 a[236:239], v44, s[28:31], s58 offen offset:3072 sc1
    v_and_b32 v235, 0xffff0000, v61
    v_lshlrev_b32_e64 v236, 16, v62
    v_and_b32 v237, 0xffff0000, v62
    v_lshlrev_b32_e64 v238, 16, v63
    v_mfma_f32_32x32x16_bf16 v[216:231], v[156:159], a[184:187], v[216:231]
    v_and_b32 v239, 0xffff0000, v63
    s_waitcnt vmcnt(12)
    v_mfma_f32_32x32x16_bf16 v[200:215], v[160:163], a[188:191], v[200:215]
    s_waitcnt lgkmcnt(9)
    v_add_f32 v4, v4, v168
    v_add_f32 v5, v5, v169
    v_add_f32 v6, v6, v170
    v_add_f32 v7, v7, v171
    s_waitcnt lgkmcnt(8)
    v_add_f32 v8, v8, v172
    v_add_f32_e64 v9, v9, v173
    v_mfma_f32_32x32x16_bf16 v[216:231], v[164:167], a[188:191], v[216:231]
    v_add_f32 v10, v10, v174
    v_add_f32 v11, v11, v175
    s_waitcnt lgkmcnt(7)
    v_add_f32 v4, v4, v176
    v_add_f32 v5, v5, v177
    v_add_f32 v6, v6, v178
    v_add_f32 v7, v7, v179
    s_waitcnt vmcnt(11)
    v_mfma_f32_32x32x16_bf16 v[200:215], a[0:3], a[192:195], v[200:215]
    s_waitcnt lgkmcnt(6)
    v_add_f32 v8, v8, v180
    v_add_f32 v9, v9, v181
    v_add_f32 v10, v10, v182
    v_add_f32 v11, v11, v183
    s_waitcnt lgkmcnt(5)
    v_add_f32 v4, v4, v184
    v_add_f32 v5, v5, v185
    v_mfma_f32_32x32x16_bf16 v[216:231], a[4:7], a[192:195], v[216:231]
    v_add_f32 v6, v6, v186
    v_add_f32 v7, v7, v187
    s_waitcnt lgkmcnt(4)
    v_add_f32 v8, v8, v188
    v_add_f32 v9, v9, v189
    v_add_f32 v10, v10, v190
    v_add_f32 v11, v11, v191
    s_waitcnt vmcnt(10)
    v_mfma_f32_32x32x16_bf16 v[200:215], a[8:11], a[196:199], v[200:215]
    s_waitcnt lgkmcnt(3)
    v_add_f32 v4, v4, v192
    v_add_f32 v5, v5, v193
    v_add_f32 v6, v6, v194
    v_add_f32 v7, v7, v195
    s_waitcnt lgkmcnt(2)
    v_add_f32 v8, v8, v196
    v_add_f32 v9, v9, v197
    v_mfma_f32_32x32x16_bf16 v[216:231], a[12:15], a[196:199], v[216:231]
    v_add_f32 v10, v10, v198
    v_add_f32 v11, v11, v199
    v_mul_f32 v168, s60, v4
    v_mul_f32 v169, s60, v5
    v_mul_f32_e64 v170, s60, v6
    v_mul_f32 v171, s60, v7
    s_waitcnt vmcnt(9)
    v_mfma_f32_32x32x16_bf16 v[200:215], a[16:19], a[200:203], v[200:215]
    v_mul_f32 v172, s60, v8
    v_mul_f32 v173, s60, v9
    v_mul_f32 v174, s60, v10
    v_mul_f32 v175, s60, v11
    v_exp_f32_e64 v168, v168
    v_mfma_f32_32x32x16_bf16 v[216:231], a[20:23], a[200:203], v[216:231]
    v_exp_f32 v169, v169
    v_exp_f32 v170, v170
    v_exp_f32 v171, v171
    s_waitcnt vmcnt(8)
    v_mfma_f32_32x32x16_bf16 v[200:215], a[24:27], a[204:207], v[200:215]
    v_exp_f32 v172, v172
    v_exp_f32 v173, v173
    v_exp_f32_e64 v174, v174
    v_mfma_f32_32x32x16_bf16 v[216:231], a[28:31], a[204:207], v[216:231]
    v_exp_f32 v175, v175
    s_waitcnt lgkmcnt(1)
    v_mul_f32 v4, v4, v12
    v_mul_f32 v5, v5, v13
    v_mul_f32_e64 v6, v6, v14
    v_mul_f32 v7, v7, v15
    s_waitcnt vmcnt(7)
    v_mfma_f32_32x32x16_bf16 v[200:215], a[32:35], a[208:211], v[200:215]
    s_waitcnt lgkmcnt(0)
    v_mul_f32 v8, v8, v16
    v_mul_f32 v9, v9, v17
    v_mul_f32 v10, v10, v18
    v_mul_f32 v11, v11, v19
    v_add_f32 v168, 1.0, v168
    v_add_f32_e64 v169, 1.0, v169
    v_mfma_f32_32x32x16_bf16 v[216:231], a[36:39], a[208:211], v[216:231]
    v_add_f32 v170, 1.0, v170
    v_add_f32 v171, 1.0, v171
    v_add_f32 v172, 1.0, v172
    v_add_f32 v173, 1.0, v173
    v_add_f32_e64 v174, 1.0, v174
    v_add_f32 v175, 1.0, v175
    s_waitcnt vmcnt(6)
    v_mfma_f32_32x32x16_bf16 v[200:215], a[40:43], a[212:215], v[200:215]
    v_rcp_f32 v168, v168
    v_rcp_f32 v169, v169
    v_rcp_f32 v170, v170
    s_waitcnt vmcnt(5)
    v_mfma_f32_32x32x16_bf16 v[200:215], a[48:51], a[216:219], v[200:215]
    v_rcp_f32 v171, v171
    v_rcp_f32 v172, v172
    v_rcp_f32 v173, v173
    s_waitcnt vmcnt(4)
    v_mfma_f32_32x32x16_bf16 v[200:215], a[56:59], a[220:223], v[200:215]
    v_rcp_f32 v174, v174
    v_rcp_f32 v175, v175
    v_fma_f32 v4, v4, v168, v232
    v_fma_f32 v5, v5, v169, v233
    s_waitcnt vmcnt(3)
    v_mfma_f32_32x32x16_bf16 v[200:215], a[64:67], a[224:227], v[200:215]
    v_fma_f32 v6, v6, v170, v234
    v_fma_f32 v7, v7, v171, v235
    v_fma_f32 v8, v8, v172, v236
    v_fma_f32 v9, v9, v173, v237
    v_fma_f32 v10, v10, v174, v238
    v_fma_f32 v11, v11, v175, v239
    s_waitcnt vmcnt(2)
    v_mfma_f32_32x32x16_bf16 v[200:215], a[72:75], a[228:231], v[200:215]
    v_cvt_pk_bf16_f32 v184, v4, v5
    v_cvt_pk_bf16_f32 v185, v6, v7
    v_cvt_pk_bf16_f32 v186, v8, v9
    v_cvt_pk_bf16_f32 v187, v10, v11
    s_waitcnt vmcnt(1)
    v_mfma_f32_32x32x16_bf16 v[200:215], a[80:83], a[232:235], v[200:215]
    buffer_store_dwordx4 v[184:187], v1, s[24:27], s54 offen sc1
    ds_read_b128 v[12:15], v50 offset:40960
    ds_read_b128 v[16:19], v51 offset:40960
    s_waitcnt vmcnt(1)
    v_mfma_f32_32x32x16_bf16 v[200:215], a[88:91], a[236:239], v[200:215]
    v_lshlrev_b32_e64 v4, 16, v56
    v_and_b32 v5, 0xffff0000, v56
    v_lshlrev_b32_e64 v6, 16, v57
    v_and_b32 v7, 0xffff0000, v57
    v_lshlrev_b32_e64 v8, 16, v58
    v_and_b32 v9, 0xffff0000, v58
    v_mfma_f32_32x32x16_bf16 v[216:231], a[44:47], a[212:215], v[216:231]
    v_lshlrev_b32_e64 v10, 16, v59
    v_and_b32 v11, 0xffff0000, v59
    v_lshlrev_b32_e64 v232, 16, v64
    v_and_b32 v233, 0xffff0000, v64
    v_lshlrev_b32_e64 v234, 16, v65
    v_and_b32 v235, 0xffff0000, v65
    v_mfma_f32_32x32x16_bf16 v[216:231], a[52:55], a[216:219], v[216:231]
    v_lshlrev_b32_e64 v236, 16, v66
    v_and_b32 v237, 0xffff0000, v66
    v_lshlrev_b32_e64 v238, 16, v67
    v_and_b32 v239, 0xffff0000, v67
    v_add_u32 v50, 65536, v50
    v_add_u32 v51, 65536, v51
    v_mfma_f32_32x32x16_bf16 v[216:231], a[60:63], a[220:223], v[216:231]
    ds_write_b128 v3, v[200:203] offset:0
    v_mfma_f32_32x32x16_bf16 v[216:231], a[68:71], a[224:227], v[216:231]
    ds_write_b128 v36, v[204:207] offset:0
    v_mfma_f32_32x32x16_bf16 v[216:231], a[76:79], a[228:231], v[216:231]
    ds_write_b128 v37, v[208:211] offset:0
    v_mfma_f32_32x32x16_bf16 v[216:231], a[84:87], a[232:235], v[216:231]
    ds_write_b128 v49, v[212:215] offset:0
    v_mfma_f32_32x32x16_bf16 v[216:231], a[92:95], a[236:239], v[216:231]
    s_nop 11
    ds_write_b128 v3, v[216:219] offset:128
    ds_write_b128 v36, v[220:223] offset:128
    ds_write_b128 v37, v[224:227] offset:128
    ds_write_b128 v49, v[228:231] offset:128
    s_waitcnt lgkmcnt(0)
    s_barrier
    ds_read_b128 v[200:203], v50 offset:0
    ds_read_b128 v[204:207], v51 offset:0
    ds_read_b128 v[208:211], v50 offset:8192
    ds_read_b128 v[212:215], v51 offset:8192
    ds_read_b128 v[216:219], v50 offset:16384
    ds_read_b128 v[220:223], v51 offset:16384
    ds_read_b128 v[224:227], v50 offset:24576
    ds_read_b128 v[228:231], v51 offset:24576
    s_waitcnt lgkmcnt(7)
    v_pk_add_f32 v[4:5], v[4:5], v[200:201]
    v_pk_add_f32 v[6:7], v[6:7], v[202:203]
    s_waitcnt lgkmcnt(6)
    v_pk_add_f32 v[8:9], v[8:9], v[204:205]
    v_pk_add_f32 v[10:11], v[10:11], v[206:207]
    s_waitcnt lgkmcnt(5)
    v_pk_add_f32 v[4:5], v[4:5], v[208:209]
    v_pk_add_f32 v[6:7], v[6:7], v[210:211]
    s_waitcnt lgkmcnt(4)
    v_pk_add_f32 v[8:9], v[8:9], v[212:213]
    v_pk_add_f32 v[10:11], v[10:11], v[214:215]
    s_waitcnt lgkmcnt(3)
    v_pk_add_f32 v[4:5], v[4:5], v[216:217]
    v_pk_add_f32 v[6:7], v[6:7], v[218:219]
    s_waitcnt lgkmcnt(2)
    v_pk_add_f32 v[8:9], v[8:9], v[220:221]
    v_pk_add_f32 v[10:11], v[10:11], v[222:223]
    s_waitcnt lgkmcnt(1)
    v_pk_add_f32 v[4:5], v[4:5], v[224:225]
    v_pk_add_f32 v[6:7], v[6:7], v[226:227]
    s_waitcnt lgkmcnt(0)
    v_pk_add_f32 v[8:9], v[8:9], v[228:229]
    v_pk_add_f32 v[10:11], v[10:11], v[230:231]
    v_pk_mul_f32 v[200:201], v[4:5], s[60:61] op_sel_hi:[1,0]
    v_pk_mul_f32 v[202:203], v[6:7], s[60:61] op_sel_hi:[1,0]
    v_pk_mul_f32 v[204:205], v[8:9], s[60:61] op_sel_hi:[1,0]
    v_pk_mul_f32 v[206:207], v[10:11], s[60:61] op_sel_hi:[1,0]
    v_exp_f32 v200, v200
    v_exp_f32 v201, v201
    v_exp_f32 v202, v202
    v_exp_f32 v203, v203
    v_exp_f32 v204, v204
    v_exp_f32 v205, v205
    v_exp_f32 v206, v206
    v_exp_f32_e64 v207, v207
    v_pk_mul_f32 v[4:5], v[4:5], v[12:13]
    v_pk_mul_f32 v[6:7], v[6:7], v[14:15]
    v_pk_mul_f32 v[8:9], v[8:9], v[16:17]
    v_pk_mul_f32 v[10:11], v[10:11], v[18:19]
    v_pk_add_f32 v[200:201], v[200:201], 1.0 op_sel_hi:[1,0]
    v_pk_add_f32 v[202:203], v[202:203], 1.0 op_sel_hi:[1,0]
    v_pk_add_f32 v[204:205], v[204:205], 1.0 op_sel_hi:[1,0]
    v_pk_add_f32 v[206:207], v[206:207], 1.0 op_sel_hi:[1,0]
    v_rcp_f32 v200, v200
    v_rcp_f32 v201, v201
    v_rcp_f32 v202, v202
    v_rcp_f32 v203, v203
    v_rcp_f32 v204, v204
    v_rcp_f32 v205, v205
    v_rcp_f32 v206, v206
    v_rcp_f32 v207, v207
    v_pk_fma_f32 v[4:5], v[4:5], v[200:201], v[232:233]
    v_pk_fma_f32 v[6:7], v[6:7], v[202:203], v[234:235]
    v_pk_fma_f32 v[8:9], v[8:9], v[204:205], v[236:237]
    v_pk_fma_f32 v[10:11], v[10:11], v[206:207], v[238:239]
    v_cvt_pk_bf16_f32 v216, v4, v5
    v_cvt_pk_bf16_f32 v217, v6, v7
    v_cvt_pk_bf16_f32 v218, v8, v9
    v_cvt_pk_bf16_f32 v219, v10, v11
    buffer_store_dwordx4 v[216:219], v1, s[24:27], s59 offen sc1
Lend:
    s_endpgm
LroleB:

    v_mfma_f32_16x16x32_bf16 v[60:63], v[52:55], v[240:243], v[60:63]
    ds_read_b64_tr_b16 v[236:237], v141 offset:53248
    v_mfma_f32_32x32x16_bf16 v[212:227], v[240:243], v[208:211], v[212:227]
    ds_read_b64_tr_b16 v[238:239], v141 offset:53760
    s_add_u32 m0, s52, 6144
    s_add_u32 s58, s59, 49152
    buffer_load_dwordx4 v28, s[12:15], s58 offen offset:0 lds
    v_lshrrev_b32 v64, 6, v51
    v_lshl_add_u32 v64, v64, 8, v45
    s_waitcnt lgkmcnt(6)
    v_mfma_f32_16x16x32_bf16 v[60:63], v[52:55], v[228:231], v[60:63]
    ds_read_b64_tr_b16 v[240:241], v141 offset:55296
    v_mfma_f32_32x32x16_bf16 v[212:227], v[228:231], a[240:243], v[212:227]
    ds_read_b64_tr_b16 v[242:243], v141 offset:55808
    buffer_load_dwordx4 v29, s[12:15], s58 offen offset:1024 lds
    s_waitcnt lgkmcnt(5)
    v_add_f32 v146, v146, v4
    v_add_f32 v147, v147, v5
    s_waitcnt lgkmcnt(4)
    v_add_f32 v56, v56, v6
    v_mul_f32 v70, 0xbb000000, v146
    v_mfma_f32_16x16x32_bf16 v[60:63], v[52:55], v[232:235], v[60:63]
    v_mfma_f32_32x32x16_bf16 v[212:227], v[232:235], a[244:247], v[212:227]
    s_add_u32 m0, s52, 14336
    s_add_u32 s58, s59, 114688
    buffer_load_dwordx4 v28, s[12:15], s58 offen offset:0 lds
    v_cmp_gt_u32 vcc, 32, v0
    v_cvt_pk_bf16_f32 v41, v70, v70
    v_and_b32 v42, 0xffff0000, v41
    v_sub_f32_e64 v42, v70, v42
    s_waitcnt lgkmcnt(2)
    v_mfma_f32_16x16x32_bf16 v[60:63], v[52:55], v[236:239], v[60:63]
    v_mfma_f32_32x32x16_bf16 v[212:227], v[236:239], a[248:251], v[212:227]
    buffer_load_dwordx4 v29, s[12:15], s58 offen offset:1024 lds
    v_cvt_pk_bf16_f32 v35, v42, v42
    v_cndmask_b32 v34, v35, v41, vcc
    v_and_b32 v35, 0xffff0000, v35
    v_sub_f32 v42, v42, v35
    v_cvt_pk_bf16_f32 v42, v70, v42
    v_cndmask_b32 v35, 0, v42, vcc
    s_waitcnt lgkmcnt(0)
    v_mfma_f32_16x16x32_bf16 v[60:63], v[52:55], v[240:243], v[60:63]
    v_mfma_f32_32x32x16_bf16 v[212:227], v[240:243], a[252:255], v[212:227]
    v_mul_f32_e64 v43, v70, v70
    v_fma_f32 v43, v147, s60, -v43
    v_max_f32_e64 v43, 0, v43
    v_add_f32 v4, 0x3727c5ac, v43
    v_rsq_f32 v71, v4
    s_lshl_b32 s41, s63, 7
    s_add_u32 s41, s41, 147456
    v_mul_f32_e64 v4, v71, v71
    v_fmaak_f32 v4, v4, v43, 0x3727c5ac
    v_rsq_f32_e64 v4, v4
    v_lshl_add_u32 v5, v48, 2, s41
    v_mul_f32 v4, v4, v71
    v_add_f32 v56, v56, v60
    v_cvt_pk_bf16_f32 v41, v56, v56
    v_and_b32 v41, 0xffff0000, v41
    v_sub_f32_e64 v42, v56, v41
    v_cvt_pk_bf16_f32 v20, v41, v42
    v_and_b32 v21, 0xffff0000, v20
    v_sub_f32_e64 v42, v42, v21
    v_cvt_pk_bf16_f32 v21, v42, v41
    s_nop 1
    v_mfma_f32_32x32x16_bf16 v[212:227], v[20:23], v[34:37], v[212:227]
    v_rcp_f32 v250, v4
    v_mul_f32 v246, 0xc0135761, v4
    v_mul_f32 v43, v4, v4
    v_mul_f32 v43, v43, v4
    v_mul_f32 v248, 0xbdd2d3e8, v43
    v_mul_f32_e64 v70, v70, v71
    ds_write_b32 v5, v71
    v_mul_u32_u24 v64, 3584, v64
    v_and_b32_e64 v51, 48, v51
    v_add_u32 v64, v51, v64
    s_add_u32 s42, s37, 3
    s_and_b32 s42, s42, 3
    s_lshr_b32 s101, s37, 2
    s_lshl1_add_u32 s101, s42, s101
    s_add_u32 s42, s101, 48
    s_lshl_b32 s48, s42, 6
    s_lshl_b32 s62, s42, 11
    v_add_u32 v65, 27648, v64
    v_add_u32 v66, 55296, v64
    v_add_u32 v67, 82944, v64
    s_mov_b32 s34, 256
    s_mov_b32 s35, 0x20000
    v_lshlrev_b32_e64 v146, 2, v46
    buffer_load_dword v147, v146, s[32:35], 0 offen sc1
    s_add_u32 m0, s47, 65536
    s_add_u32 s58, s48, 0
    buffer_load_dwordx4 v64, s[16:19], s58 offen offset:0 lds
    v_pk_mul_f32 v[4:5], v[212:213], v[212:213]
    v_pk_mul_f32 v[6:7], v[214:215], v[214:215]
    v_pk_mul_f32 v[8:9], v[216:217], v[216:217]
    v_pk_mul_f32 v[10:11], v[218:219], v[218:219]
    v_pk_fma_f32 v[4:5], v[4:5], v[248:249], v[246:247] op_sel_hi:[1,0,0]
    v_pk_fma_f32 v[6:7], v[6:7], v[248:249], v[246:247] op_sel_hi:[1,0,0]
    v_pk_fma_f32 v[8:9], v[8:9], v[248:249], v[246:247] op_sel_hi:[1,0,0]
    v_pk_fma_f32 v[10:11], v[10:11], v[248:249], v[246:247] op_sel_hi:[1,0,0]
    v_pk_mul_f32 v[4:5], v[4:5], v[212:213]
    v_pk_mul_f32 v[6:7], v[6:7], v[214:215]
    v_pk_mul_f32 v[8:9], v[8:9], v[216:217]
    v_pk_mul_f32 v[10:11], v[10:11], v[218:219]
    v_exp_f32 v4, v4
    v_exp_f32 v5, v5
    v_exp_f32 v6, v6
    v_exp_f32 v7, v7
    v_exp_f32 v8, v8
    v_exp_f32 v9, v9
    v_exp_f32 v10, v10
    v_exp_f32_e64 v11, v11
    v_pk_fma_f32 v[4:5], v[4:5], v[250:251], v[250:251] op_sel_hi:[1,0,0]
    v_pk_fma_f32 v[6:7], v[6:7], v[250:251], v[250:251] op_sel_hi:[1,0,0]
    v_pk_fma_f32 v[8:9], v[8:9], v[250:251], v[250:251] op_sel_hi:[1,0,0]
    v_pk_fma_f32 v[10:11], v[10:11], v[250:251], v[250:251] op_sel_hi:[1,0,0]
    v_rcp_f32 v4, v4
    v_rcp_f32 v5, v5
    v_rcp_f32 v6, v6
    v_rcp_f32 v7, v7
    buffer_load_dwordx4 v65, s[16:19], s58 offen offset:1024 lds
    v_rcp_f32 v8, v8
    v_rcp_f32 v9, v9
    v_rcp_f32 v10, v10
    v_rcp_f32 v11, v11
    v_pk_mul_f32 v[4:5], v[4:5], v[212:213]
    v_pk_mul_f32 v[6:7], v[6:7], v[214:215]
    v_pk_mul_f32 v[8:9], v[8:9], v[216:217]
    v_pk_mul_f32 v[10:11], v[10:11], v[218:219]
    v_cvt_pk_bf16_f32 v12, v4, v5
    v_cvt_pk_bf16_f32 v13, v6, v7
    v_cvt_pk_bf16_f32 v14, v8, v9
    v_cvt_pk_bf16_f32 v15, v10, v11
    v_and_b32 v12, v142, v12
    v_and_b32 v13, v142, v13
    v_and_b32 v14, v142, v14
    v_and_b32 v15, v142, v15
    buffer_store_dwordx4 v[12:15], v89, s[28:31], s51 offen offset:0 sc1
    v_pk_mul_f32 v[4:5], v[220:221], v[220:221]
    v_pk_mul_f32 v[6:7], v[222:223], v[222:223]
    v_pk_mul_f32 v[8:9], v[224:225], v[224:225]
    v_pk_mul_f32 v[10:11], v[226:227], v[226:227]
    v_pk_fma_f32 v[4:5], v[4:5], v[248:249], v[246:247] op_sel_hi:[1,0,0]
    v_pk_fma_f32 v[6:7], v[6:7], v[248:249], v[246:247] op_sel_hi:[1,0,0]
    v_pk_fma_f32 v[8:9], v[8:9], v[248:249], v[246:247] op_sel_hi:[1,0,0]
    v_pk_fma_f32 v[10:11], v[10:11], v[248:249], v[246:247] op_sel_hi:[1,0,0]
    v_pk_mul_f32 v[4:5], v[4:5], v[220:221]
    v_pk_mul_f32 v[6:7], v[6:7], v[222:223]
    v_pk_mul_f32 v[8:9], v[8:9], v[224:225]
    v_pk_mul_f32 v[10:11], v[10:11], v[226:227]
    v_exp_f32 v4, v4
    v_exp_f32 v5, v5
    v_exp_f32_e64 v6, v6
    buffer_load_dwordx4 v66, s[16:19], s58 offen offset:2048 lds
    v_exp_f32 v7, v7
    v_exp_f32 v8, v8
    v_exp_f32 v9, v9
    v_exp_f32 v10, v10
    v_exp_f32_e64 v11, v11
    v_pk_fma_f32 v[4:5], v[4:5], v[250:251], v[250:251] op_sel_hi:[1,0,0]
    v_pk_fma_f32 v[6:7], v[6:7], v[250:251], v[250:251] op_sel_hi:[1,0,0]
    v_pk_fma_f32 v[8:9], v[8:9], v[250:251], v[250:251] op_sel_hi:[1,0,0]
    v_pk_fma_f32 v[10:11], v[10:11], v[250:251], v[250:251] op_sel_hi:[1,0,0]
    v_rcp_f32 v4, v4
    v_rcp_f32 v5, v5
    v_rcp_f32 v6, v6
    v_rcp_f32 v7, v7
    v_rcp_f32 v8, v8
    v_rcp_f32 v9, v9
    v_rcp_f32 v10, v10
    v_rcp_f32 v11, v11
    v_pk_mul_f32 v[4:5], v[4:5], v[220:221]
    v_pk_mul_f32 v[6:7], v[6:7], v[222:223]
    v_pk_mul_f32 v[8:9], v[8:9], v[224:225]
    v_pk_mul_f32 v[10:11], v[10:11], v[226:227]
    v_cvt_pk_bf16_f32 v16, v4, v5
    v_cvt_pk_bf16_f32 v17, v6, v7
    v_cvt_pk_bf16_f32 v18, v8, v9
    v_cvt_pk_bf16_f32 v19, v10, v11
    v_and_b32 v16, v142, v16
    v_and_b32 v17, v142, v17
    v_and_b32_e64 v18, v142, v18
    buffer_load_dwordx4 v67, s[16:19], s58 offen offset:3072 lds
    v_and_b32_e64 v19, v142, v19
    s_mov_b32 s41, 17825792
    s_waitcnt vmcnt(14)
    buffer_store_dwordx4 v[72:75], v76, s[28:31], s41 offen sc1
    buffer_store_dwordx4 v[16:19], v89, s[28:31], s51 offen offset:1024 sc1
    v_add_u32 v24, s47, v24
    v_xor_b32_e64 v25, 64, v24
    v_add_u32 v26, 0x10000, v24
    v_add_u32 v27, 0x10000, v25
    v_lshlrev_b32 v44, 4, v0
    v_cmp_eq_u32 vcc, 0, v0
    v_mov_b32 v4, 1073741824
    v_mov_b32 v40, 1
    v_cndmask_b32 v38, v4, 0, vcc
    v_cmp_gt_u32 vcc, 8, v0
    s_add_u32 m0, s47, 0
    s_add_u32 s58, s48, 114688
    buffer_load_dwordx4 v64, s[16:19], s58 offen offset:0 lds
    v_lshlrev_b32 v39, 7, v0
    s_lshl_b32 s56, s36, 10
    v_cndmask_b32 v39, v4, v39, vcc
    s_add_u32 s41, s56, s50
    s_add_u32 s0, s28, s41
    s_addc_u32 s1, s29, 0
    v_mfma_f32_32x32x16_bf16 v[212:227], v[148:151], v[100:103], 0
    v_cvt_pk_bf16_f32 v108, v124, v125
    v_cvt_pk_bf16_f32 v109, v126, v127
    v_cvt_pk_bf16_f32 v110, v128, v129
    v_cvt_pk_bf16_f32 v111, v130, v131
    v_mfma_f32_32x32x16_bf16 v[228:243], a[192:195], v[100:103], 0
    v_fma_f32 v124, v116, v143, -v124
    v_fma_f32 v125, v117, v143, -v125
    v_fma_f32 v126, v118, v143, -v126
    v_fma_f32 v127, v119, v143, -v127
    v_mfma_f32_32x32x16_bf16 v[212:227], v[180:183], v[104:107], v[212:227]
    buffer_load_dwordx4 v65, s[16:19], s58 offen offset:1024 lds
    v_fma_f32 v128, v120, v143, -v128
    v_fma_f32 v129, v121, v143, -v129
    v_fma_f32 v130, v122, v143, -v130
    v_fma_f32 v131, v123, v143, -v131
    v_mfma_f32_32x32x16_bf16 v[228:243], a[224:227], v[104:107], v[228:243]
    v_xor_b32_dpp v112, v108, v144 quad_perm:[0,1,3,2] row_mask:0xf bank_mask:0xf
    v_xor_b32_dpp v113, v109, v144 quad_perm:[0,1,3,2] row_mask:0xf bank_mask:0xf
    v_xor_b32_dpp v114, v110, v144 quad_perm:[0,1,3,2] row_mask:0xf bank_mask:0xf
    v_xor_b32_dpp v115, v111, v144 quad_perm:[0,1,3,2] row_mask:0xf bank_mask:0xf
    v_mfma_f32_32x32x16_bf16 v[212:227], v[152:155], v[108:111], v[212:227]
    v_cvt_pk_bf16_f32 v100, v116, v117
    v_cvt_pk_bf16_f32 v101, v118, v119
    v_cvt_pk_bf16_f32 v102, v120, v121
    v_cvt_pk_bf16_f32 v103, v122, v123
    v_mfma_f32_32x32x16_bf16 v[228:243], a[196:199], v[108:111], v[228:243]
    buffer_load_dwordx4 v66, s[16:19], s58 offen offset:2048 lds
    v_fma_f32 v116, v124, v143, -v116
    v_fma_f32 v117, v125, v143, -v117
    v_fma_f32 v118, v126, v143, -v118
    v_fma_f32 v119, v127, v143, -v119
    v_mfma_f32_32x32x16_bf16 v[212:227], v[184:187], v[112:115], v[212:227]
    v_fma_f32 v120, v128, v143, -v120
    v_fma_f32 v121, v129, v143, -v121
    v_fma_f32 v122, v130, v143, -v122
    v_fma_f32 v123, v131, v143, -v123
    v_mfma_f32_32x32x16_bf16 v[228:243], a[228:231], v[112:115], v[228:243]
    v_xor_b32_dpp v104, v100, v144 quad_perm:[0,1,3,2] row_mask:0xf bank_mask:0xf
    v_xor_b32_dpp v105, v101, v144 quad_perm:[0,1,3,2] row_mask:0xf bank_mask:0xf
    v_xor_b32_dpp v106, v102, v144 quad_perm:[0,1,3,2] row_mask:0xf bank_mask:0xf
    v_xor_b32_dpp v107, v103, v144 quad_perm:[0,1,3,2] row_mask:0xf bank_mask:0xf
    v_mfma_f32_32x32x16_bf16 v[212:227], v[156:159], v[100:103], v[212:227]
    buffer_load_dwordx4 v67, s[16:19], s58 offen offset:3072 lds
    v_cvt_pk_bf16_f32 v108, v124, v125
    v_cvt_pk_bf16_f32 v109, v126, v127
    v_cvt_pk_bf16_f32 v110, v128, v129
    v_cvt_pk_bf16_f32 v111, v130, v131
    v_mfma_f32_32x32x16_bf16 v[228:243], a[200:203], v[100:103], v[228:243]
    v_fma_f32 v124, v116, v143, -v124
    v_fma_f32 v125, v117, v143, -v125
    v_fma_f32 v126, v118, v143, -v126
    v_fma_f32 v127, v119, v143, -v127
    s_waitcnt vmcnt(11)
    v_cmp_gt_u32 vcc, 1, v147
    s_cbranch_vccz Ld_1002
    s_mov_b32 s40, 0
Lp_1001:
    s_sleep 4
    buffer_load_dword v147, v146, s[32:35], 0 offen sc1
    s_add_u32 s40, s40, 1
    s_waitcnt vmcnt(0)
    s_cmp_gt_u32 s40, 100000
    s_cbranch_scc1 Ld_1002
    v_cmp_gt_u32 vcc, 1, v147
    s_cbranch_vccnz Lp_1001
Ld_1002:
    s_waitcnt vmcnt(4)
    s_barrier
    buffer_atomic_add v40, v39, s[28:31], s55 offen offset:0 sc1
    s_add_u32 s41, s50, 32768
    buffer_atomic_add v40, v38, s[28:31], s41 offen offset:4 sc1
    v_mfma_f32_32x32x16_bf16 v[212:227], v[188:191], v[104:107], v[212:227]
    ds_read_b64_tr_b16 a[64:65], v88 offset:0
    ds_read_b64_tr_b16 a[66:67], v88 offset:1024
    v_fma_f32 v128, v120, v143, -v128
    v_fma_f32 v129, v121, v143, -v129
    v_fma_f32 v130, v122, v143, -v130
    v_fma_f32 v131, v123, v143, -v131
    v_mfma_f32_32x32x16_bf16 v[228:243], a[232:235], v[104:107], v[228:243]
    ds_read_b64_tr_b16 a[68:69], v88 offset:2048
    ds_read_b64_tr_b16 a[70:71], v88 offset:3072
    v_xor_b32_dpp v112, v108, v144 quad_perm:[0,1,3,2] row_mask:0xf bank_mask:0xf
    s_add_u32 m0, s47, 16384
    s_add_u32 s58, s48, 229376
    buffer_load_dwordx4 v64, s[16:19], s58 offen offset:0 lds
    v_xor_b32_dpp v113, v109, v144 quad_perm:[0,1,3,2] row_mask:0xf bank_mask:0xf
    v_xor_b32_dpp v114, v110, v144 quad_perm:[0,1,3,2] row_mask:0xf bank_mask:0xf
    v_xor_b32_dpp v115, v111, v144 quad_perm:[0,1,3,2] row_mask:0xf bank_mask:0xf
    v_mfma_f32_32x32x16_bf16 v[212:227], v[160:163], v[108:111], v[212:227]
    ds_read_b64_tr_b16 a[72:73], v88 offset:4096
    ds_read_b64_tr_b16 a[74:75], v88 offset:5120
    v_cvt_pk_bf16_f32 v100, v116, v117
    v_cvt_pk_bf16_f32 v101, v118, v119
    v_cvt_pk_bf16_f32 v102, v120, v121
    v_cvt_pk_bf16_f32 v103, v122, v123
    v_mfma_f32_32x32x16_bf16 v[228:243], a[204:207], v[108:111], v[228:243]
    ds_read_b64_tr_b16 a[76:77], v88 offset:6144
    ds_read_b64_tr_b16 a[78:79], v88 offset:7168
    v_fma_f32 v116, v124, v143, -v116
    v_fma_f32 v117, v125, v143, -v117
    v_fma_f32 v118, v126, v143, -v118
    v_fma_f32 v119, v127, v143, -v119
    v_mfma_f32_32x32x16_bf16 v[212:227], v[192:195], v[112:115], v[212:227]
    ds_read_b64_tr_b16 a[80:81], v88 offset:8192
    ds_read_b64_tr_b16 a[82:83], v88 offset:9216
    v_fma_f32 v120, v128, v143, -v120
    v_fma_f32 v121, v129, v143, -v121
    v_fma_f32 v122, v130, v143, -v122
    v_fma_f32 v123, v131, v143, -v123
    v_mfma_f32_32x32x16_bf16 v[228:243], a[236:239], v[112:115], v[228:243]
    ds_read_b64_tr_b16 a[84:85], v88 offset:10240
    ds_read_b64_tr_b16 a[86:87], v88 offset:11264
    buffer_load_dwordx4 v65, s[16:19], s58 offen offset:1024 lds
    v_xor_b32_dpp v104, v100, v144 quad_perm:[0,1,3,2] row_mask:0xf bank_mask:0xf
    v_xor_b32_dpp v105, v101, v144 quad_perm:[0,1,3,2] row_mask:0xf bank_mask:0xf
    v_xor_b32_dpp v106, v102, v144 quad_perm:[0,1,3,2] row_mask:0xf bank_mask:0xf
    v_xor_b32_dpp v107, v103, v144 quad_perm:[0,1,3,2] row_mask:0xf bank_mask:0xf
    v_mfma_f32_32x32x16_bf16 v[212:227], v[164:167], v[100:103], v[212:227]
    ds_read_b64_tr_b16 a[88:89], v88 offset:12288
    ds_read_b64_tr_b16 a[90:91], v88 offset:13312
    v_cvt_pk_bf16_f32 v108, v124, v125
    v_cvt_pk_bf16_f32 v109, v126, v127
    v_cvt_pk_bf16_f32 v110, v128, v129
    v_cvt_pk_bf16_f32 v111, v130, v131
    v_mfma_f32_32x32x16_bf16 v[228:243], a[208:211], v[100:103], v[228:243]
    ds_read_b64_tr_b16 a[92:93], v88 offset:14336
    ds_read_b64_tr_b16 a[94:95], v88 offset:15360
    v_fma_f32 v124, v116, v143, -v124
    v_fma_f32 v125, v117, v143, -v125
    v_fma_f32 v126, v118, v143, -v126
    v_fma_f32 v127, v119, v143, -v127
    ds_read_b64_tr_b16 a[96:97], v88 offset:16384
    ds_read_b64_tr_b16 a[98:99], v88 offset:17408
    ds_read_b64_tr_b16 a[100:101], v88 offset:18432
    ds_read_b64_tr_b16 a[102:103], v88 offset:19456
    ds_read_b64_tr_b16 a[104:105], v88 offset:20480
    ds_read_b64_tr_b16 a[106:107], v88 offset:21504
    ds_read_b64_tr_b16 a[108:109], v88 offset:22528
    ds_read_b64_tr_b16 a[0:1], v26 offset:0
    ds_read_b64_tr_b16 a[2:3], v26 offset:1024
    buffer_load_dwordx4 v66, s[16:19], s58 offen offset:2048 lds
    ds_read_b64_tr_b16 a[110:111], v88 offset:23552
    ds_read_b64_tr_b16 a[112:113], v88 offset:24576
    ds_read_b64_tr_b16 a[114:115], v88 offset:25600
    ds_read_b64_tr_b16 a[116:117], v88 offset:26624
    ds_read_b64_tr_b16 a[118:119], v88 offset:27648
    ds_read_b64_tr_b16 a[120:121], v88 offset:28672
    ds_read_b64_tr_b16 a[122:123], v88 offset:29696
    ds_read_b64_tr_b16 a[124:125], v88 offset:30720
    ds_read_b64_tr_b16 a[126:127], v88 offset:31744
    ds_read_b64_tr_b16 a[128:129], v88 offset:32768
    ds_read_b64_tr_b16 a[130:131], v88 offset:33792
    ds_read_b64_tr_b16 a[132:133], v88 offset:34816
    ds_read_b64_tr_b16 a[134:135], v88 offset:35840
    ds_read_b64_tr_b16 a[136:137], v88 offset:36864
    ds_read_b64_tr_b16 a[138:139], v88 offset:37888
    ds_read_b64_tr_b16 a[140:141], v88 offset:38912
    ds_read_b64_tr_b16 a[4:5], v27 offset:0
    ds_read_b64_tr_b16 a[6:7], v27 offset:1024
    buffer_load_dwordx4 v67, s[16:19], s58 offen offset:3072 lds
    ds_read_b64_tr_b16 a[142:143], v88 offset:39936
    ds_read_b64_tr_b16 a[144:145], v88 offset:40960
    ds_read_b64_tr_b16 a[146:147], v88 offset:41984
    ds_read_b64_tr_b16 a[148:149], v88 offset:43008
    ds_read_b64_tr_b16 a[150:151], v88 offset:44032
    ds_read_b64_tr_b16 a[152:153], v88 offset:45056
    ds_read_b64_tr_b16 a[154:155], v88 offset:46080
    ds_read_b64_tr_b16 a[156:157], v88 offset:47104
    ds_read_b64_tr_b16 a[158:159], v88 offset:48128
    ds_read_b64_tr_b16 a[160:161], v88 offset:49152
    ds_read_b64_tr_b16 a[162:163], v88 offset:50176
    ds_read_b64_tr_b16 a[164:165], v88 offset:51200
    ds_read_b64_tr_b16 a[166:167], v88 offset:52224
    ds_read_b64_tr_b16 a[168:169], v88 offset:53248
    ds_read_b64_tr_b16 a[170:171], v88 offset:54272
    ds_read_b64_tr_b16 a[172:173], v88 offset:55296
    ds_read_b64_tr_b16 a[174:175], v88 offset:56320
    ds_read_b64_tr_b16 a[8:9], v26 offset:2048
    ds_read_b64_tr_b16 a[10:11], v26 offset:3072
    s_add_u32 m0, s47, 32768
    s_add_u32 s58, s48, 344064
    buffer_load_dwordx4 v64, s[16:19], s58 offen offset:0 lds
    ds_read_b64_tr_b16 a[176:177], v88 offset:57344
    ds_read_b64_tr_b16 a[178:179], v88 offset:58368
    ds_read_b64_tr_b16 a[180:181], v88 offset:59392
    ds_read_b64_tr_b16 a[182:183], v88 offset:60416
    s_load_dword s100, s[0:1], 0 glc
    ds_read_b64_tr_b16 a[184:185], v88 offset:61440
    ds_read_b64_tr_b16 a[186:187], v88 offset:62464
    ds_read_b64_tr_b16 a[188:189], v88 offset:63488
    ds_read_b64_tr_b16 a[190:191], v88 offset:64512
    s_lshl_b32 s52, s36, 16
    s_lshl_b32 s45, s63, 15
    s_lshl_b32 s41, s3, 12
    s_add_u32 s45, s45, s41
    s_add_u32 s46, s45, s52
    s_mov_b32 s40, 0
    s_branch Lc_1005
Lp_1003:
    s_load_dword s100, s[0:1], 0 glc
Lc_1005:
    s_waitcnt lgkmcnt(0)
    s_cmp_ge_u32 s100, 8
    s_cbranch_scc1 Ld_1004
    s_add_u32 s40, s40, 1
    s_cmp_lt_u32 s40, 200000
    s_cbranch_scc1 Lp_1003
Ld_1004:
    s_waitcnt lgkmcnt(0)
    s_barrier
    s_add_u32 m0, s45, 0
    s_add_u32 s58, s46, 1048576
    buffer_load_dwordx4 v44, s[28:31], s58 offen offset:0 sc1 lds
    buffer_load_dwordx4 v44, s[28:31], s58 offen offset:1024 sc1 lds
    buffer_load_dwordx4 v44, s[28:31], s58 offen offset:2048 sc1 lds
    buffer_load_dwordx4 v44, s[28:31], s58 offen offset:3072 sc1 lds
    v_mfma_f32_32x32x16_bf16 v[212:227], v[196:199], v[104:107], v[212:227]
    ds_read_b64_tr_b16 a[12:13], v27 offset:2048
    ds_read_b64_tr_b16 a[14:15], v27 offset:3072
    v_fma_f32 v128, v120, v143, -v128
    v_fma_f32 v129, v121, v143, -v129
    v_fma_f32 v130, v122, v143, -v130
    v_fma_f32 v131, v123, v143, -v131
    v_mfma_f32_32x32x16_bf16 v[228:243], a[240:243], v[104:107], v[228:243]
    s_add_u32 m0, s45, 8192
    s_add_u32 s58, s46, 1056768
    buffer_load_dwordx4 v44, s[28:31], s58 offen offset:0 sc1 lds
    v_xor_b32_dpp v112, v108, v144 quad_perm:[0,1,3,2] row_mask:0xf bank_mask:0xf
    v_xor_b32_dpp v113, v109, v144 quad_perm:[0,1,3,2] row_mask:0xf bank_mask:0xf
    v_xor_b32_dpp v114, v110, v144 quad_perm:[0,1,3,2] row_mask:0xf bank_mask:0xf
    v_xor_b32_dpp v115, v111, v144 quad_perm:[0,1,3,2] row_mask:0xf bank_mask:0xf
    s_lshl_b32 s41, s38, 11
    s_add_u32 s41, s41, 155648
    v_add_u32_e64 v42, s41, v44
    buffer_load_dwordx4 v44, s[28:31], s58 offen offset:1024 sc1 lds
    ds_write_b128 v42, v[92:95] offset:0
    v_lshlrev_b32_e64 v72, 16, v92
    v_and_b32 v73, 0xffff0000, v92
    v_lshlrev_b32_e64 v74, 16, v93
    v_and_b32 v75, 0xffff0000, v93
    buffer_load_dwordx4 v44, s[28:31], s58 offen offset:2048 sc1 lds
    v_lshlrev_b32_e64 v76, 16, v94
    v_and_b32 v77, 0xffff0000, v94
    v_lshlrev_b32_e64 v78, 16, v95
    v_and_b32 v79, 0xffff0000, v95
    ds_write_b128 v42, v[96:99] offset:1024
    buffer_load_dwordx4 v44, s[28:31], s58 offen offset:3072 sc1 lds
    v_lshlrev_b32_e64 v80, 16, v96
    v_and_b32 v81, 0xffff0000, v96
    v_lshlrev_b32_e64 v82, 16, v97
    v_and_b32 v83, 0xffff0000, v97
    v_lshlrev_b32_e64 v84, 16, v98
    v_and_b32 v85, 0xffff0000, v98
    v_lshlrev_b32_e64 v86, 16, v99
    v_and_b32 v87, 0xffff0000, v99
    v_mov_b32_e64 v132, v71
    s_add_u32 m0, s45, 16384
    s_add_u32 s58, s46, 1064960
    buffer_load_dwordx4 v44, s[28:31], s58 offen offset:0 sc1 lds
    v_mov_b32 v133, v70
    s_lshl_b32 s41, s63, 15
    v_add_u32_e64 v51, s41, v44
    v_pk_fma_f32 v[72:73], v[72:73], v[132:133], v[132:133] op_sel:[0,0,1] op_sel_hi:[1,0,1]
    v_pk_fma_f32 v[74:75], v[74:75], v[132:133], v[132:133] op_sel:[0,0,1] op_sel_hi:[1,0,1]
    v_pk_fma_f32 v[76:77], v[76:77], v[132:133], v[132:133] op_sel:[0,0,1] op_sel_hi:[1,0,1]
    v_pk_fma_f32 v[78:79], v[78:79], v[132:133], v[132:133] op_sel:[0,0,1] op_sel_hi:[1,0,1]
    buffer_load_dwordx4 v44, s[28:31], s58 offen offset:1024 sc1 lds
    v_pk_fma_f32 v[80:81], v[80:81], v[132:133], v[132:133] op_sel:[0,0,1] op_sel_hi:[1,0,1]
    v_pk_fma_f32 v[82:83], v[82:83], v[132:133], v[132:133] op_sel:[0,0,1] op_sel_hi:[1,0,1]
    v_pk_fma_f32 v[84:85], v[84:85], v[132:133], v[132:133] op_sel:[0,0,1] op_sel_hi:[1,0,1]
    v_pk_fma_f32 v[86:87], v[86:87], v[132:133], v[132:133] op_sel:[0,0,1] op_sel_hi:[1,0,1]
    v_mov_b32_e64 v68, 0
    v_mov_b32 v69, 0
    s_add_u32 s44, s54, s52
    s_add_u32 s44, s44, 3145728
    s_waitcnt vmcnt(17)
    v_mfma_f32_16x16x32_bf16 v[56:59], v[52:55], a[0:3], 0
    ds_read_b64_tr_b16 a[16:17], v24 offset:0
    ds_read_b64_tr_b16 a[18:19], v24 offset:1024
    buffer_load_dwordx4 v44, s[28:31], s58 offen offset:2048 sc1 lds
    v_lshlrev_b32 v43, 3, v0
    v_cmp_gt_u32 vcc, 32, v0
    v_mov_b32 v12, 1073741824
    v_mfma_f32_16x16x32_bf16 v[60:63], v[52:55], a[4:7], 0
    ds_read_b64_tr_b16 a[20:21], v25 offset:0
    ds_read_b64_tr_b16 a[22:23], v25 offset:1024
    buffer_load_dwordx4 v44, s[28:31], s58 offen offset:3072 sc1 lds
    s_lshl_b32 s43, s36, 13
    v_cndmask_b32 v43, v12, v43, vcc
    s_lshr_b32 s42, s54, 2
    s_add_u32 s43, s43, s42
    v_mfma_f32_16x16x32_bf16 v[56:59], v[52:55], a[8:11], v[56:59]
    ds_read_b64_tr_b16 a[24:25], v24 offset:2048
    ds_read_b64_tr_b16 a[26:27], v24 offset:3072
    s_add_u32 m0, s45, 24576
    s_add_u32 s58, s46, 1073152
    buffer_load_dwordx4 v44, s[28:31], s58 offen offset:0 sc1 lds
    s_lshl_b32 s42, s63, 8
    s_add_u32 s43, s43, s42
    s_waitcnt lgkmcnt(8)
    v_mfma_f32_16x16x32_bf16 v[60:63], v[52:55], a[12:15], v[60:63]
    ds_read_b64_tr_b16 a[28:29], v25 offset:2048
    ds_read_b64_tr_b16 a[30:31], v25 offset:3072
    buffer_load_dwordx4 v44, s[28:31], s58 offen offset:1024 sc1 lds
    s_add_u32 s43, s43, 5242880
    v_cvt_f32_u32 v41, v48
    v_mul_f32 v41, 0x3d000000, v41
    v_cvt_f32_u32_e64 v42, v47
    s_waitcnt vmcnt(10)
    s_barrier
    ds_read_b128 v[148:151], v51 offset:0
    ds_read_b128 v[152:155], v51 offset:1024
    ds_read_b128 v[156:159], v51 offset:2048
    s_waitcnt lgkmcnt(2)
    v_mfma_f32_32x32x16_bf16 v[72:87], a[64:67], v[148:151], v[72:87]
    ds_read_b128 v[160:163], v51 offset:3072
    buffer_load_dwordx4 v44, s[28:31], s58 offen offset:2048 sc1 lds
    v_mul_f32 v42, 4.0, v42
    v_mul_f32_e64 v42, v42, v41
    v_fmamk_f32 v132, v41, 0x00000000, v42
    v_fmamk_f32 v133, v41, 0x3f800000, v42
    s_waitcnt lgkmcnt(2)
    v_mfma_f32_32x32x16_bf16 v[72:87], a[68:71], v[152:155], v[72:87]
    ds_read_b128 v[148:151], v51 offset:4096
    buffer_load_dwordx4 v44, s[28:31], s58 offen offset:3072 sc1 lds
    v_fmamk_f32 v134, v41, 0x40000000, v42
    v_fmamk_f32 v135, v41, 0x40400000, v42
    v_fmamk_f32 v136, v41, 0x41000000, v42
    v_fmamk_f32 v137, v41, 0x41100000, v42
    s_waitcnt lgkmcnt(2)
    v_mfma_f32_32x32x16_bf16 v[72:87], a[72:75], v[156:159], v[72:87]
    ds_read_b128 v[152:155], v51 offset:5120
    v_fmamk_f32 v138, v41, 0x41200000, v42
    v_fmamk_f32 v139, v41, 0x41300000, v42
    v_cos_f32_e64 v4, v132
    v_cos_f32 v5, v133
    s_waitcnt lgkmcnt(2)
    v_mfma_f32_32x32x16_bf16 v[72:87], a[76:79], v[160:163], v[72:87]
    ds_read_b128 v[156:159], v51 offset:6144
    v_cos_f32 v6, v134
    v_cos_f32 v7, v135
    v_cos_f32 v8, v136
    s_waitcnt lgkmcnt(2)
    v_mfma_f32_32x32x16_bf16 v[72:87], a[80:83], v[148:151], v[72:87]
    ds_read_b128 v[160:163], v51 offset:7168
    s_add_u32 m0, s47, 32768
    s_add_u32 s58, s48, 344064
    buffer_load_dwordx4 v65, s[16:19], s58 offen offset:1024 lds
    v_cos_f32 v9, v137
    s_waitcnt lgkmcnt(2)
    v_mfma_f32_32x32x16_bf16 v[72:87], a[84:87], v[152:155], v[72:87]
    s_waitcnt vmcnt(9)
    s_barrier
    buffer_load_dword v1, v3, s[20:23], 0 offen
    ds_read_b128 v[148:151], v51 offset:8192
    v_cos_f32 v10, v138
    s_waitcnt lgkmcnt(2)
    v_mfma_f32_32x32x16_bf16 v[72:87], a[88:91], v[156:159], v[72:87]
    ds_read_b128 v[152:155], v51 offset:9216
    v_cos_f32_e64 v11, v139
    v_cvt_pk_bf16_f32 v180, v4, v5
    v_cvt_pk_bf16_f32 v181, v6, v7
    v_cvt_pk_bf16_f32 v182, v8, v9
    v_cvt_pk_bf16_f32 v183, v10, v11
    v_xor_b32 v184, v91, v180
    s_waitcnt lgkmcnt(2)
    v_mfma_f32_32x32x16_bf16 v[72:87], a[92:95], v[160:163], v[72:87]
    ds_read_b128 v[156:159], v51 offset:10240
    buffer_load_dwordx4 v66, s[16:19], s58 offen offset:2048 lds
    v_xor_b32 v185, v91, v181
    v_xor_b32 v186, v91, v182
    v_xor_b32 v187, v91, v183
    s_waitcnt lgkmcnt(2)
    v_mfma_f32_32x32x16_bf16 v[72:87], a[96:99], v[148:151], v[72:87]
    ds_read_b128 v[160:163], v51 offset:11264
    v_sin_f32 v4, v132
    v_sin_f32 v5, v133
    v_sin_f32 v6, v134
    s_waitcnt lgkmcnt(2)
    v_mfma_f32_32x32x16_bf16 v[72:87], a[100:103], v[152:155], v[72:87]
    ds_read_b128 v[148:151], v51 offset:12288
    v_sin_f32 v7, v135
    v_sin_f32 v8, v136
    v_sin_f32 v9, v137
    s_waitcnt lgkmcnt(2)
    v_mfma_f32_32x32x16_bf16 v[72:87], a[104:107], v[156:159], v[72:87]
    ds_read_b128 v[152:155], v51 offset:13312
    buffer_load_dwordx4 v67, s[16:19], s58 offen offset:3072 lds
    v_sin_f32_e64 v10, v138
    v_sin_f32 v11, v139
    s_waitcnt lgkmcnt(2)
    v_mfma_f32_32x32x16_bf16 v[72:87], a[108:111], v[160:163], v[72:87]
    ds_read_b128 v[156:159], v51 offset:14336
    v_cvt_pk_bf16_f32 v188, v4, v5
    v_cvt_pk_bf16_f32 v189, v6, v7
    v_cvt_pk_bf16_f32 v190, v8, v9
    v_cvt_pk_bf16_f32 v191, v10, v11
    v_xor_b32 v192, v91, v188
    v_xor_b32 v193, v91, v189
    v_xor_b32 v194, v91, v190
    s_waitcnt lgkmcnt(2)
    v_mfma_f32_32x32x16_bf16 v[72:87], a[112:115], v[148:151], v[72:87]
    ds_read_b128 v[160:163], v51 offset:15360
    v_xor_b32 v195, v91, v191
    s_waitcnt lgkmcnt(2)
    v_mfma_f32_32x32x16_bf16 v[72:87], a[116:119], v[152:155], v[72:87]
    s_waitcnt vmcnt(8)
    s_barrier
    ds_read_b128 v[148:151], v51 offset:16384
    s_add_u32 m0, s47, 49152
    s_add_u32 s58, s48, 458752
    buffer_load_dwordx4 v64, s[16:19], s58 offen offset:0 lds
    s_waitcnt lgkmcnt(2)
    v_mfma_f32_32x32x16_bf16 v[72:87], a[120:123], v[156:159], v[72:87]
    ds_read_b128 v[152:155], v51 offset:17408
    s_waitcnt lgkmcnt(2)
    v_mfma_f32_32x32x16_bf16 v[72:87], a[124:127], v[160:163], v[72:87]
    ds_read_b128 v[156:159], v51 offset:18432
    s_waitcnt lgkmcnt(2)
    v_mfma_f32_32x32x16_bf16 v[72:87], a[128:131], v[148:151], v[72:87]
    ds_read_b128 v[160:163], v51 offset:19456
    buffer_load_dwordx4 v65, s[16:19], s58 offen offset:1024 lds
    s_waitcnt lgkmcnt(2)
    v_mfma_f32_32x32x16_bf16 v[72:87], a[132:135], v[152:155], v[72:87]
    ds_read_b128 v[148:151], v51 offset:20480
    s_waitcnt lgkmcnt(2)
    v_mfma_f32_32x32x16_bf16 v[72:87], a[136:139], v[156:159], v[72:87]
    ds_read_b128 v[152:155], v51 offset:21504
    s_waitcnt lgkmcnt(2)
    v_mfma_f32_32x32x16_bf16 v[72:87], a[140:143], v[160:163], v[72:87]
    ds_read_b128 v[156:159], v51 offset:22528
    buffer_load_dwordx4 v66, s[16:19], s58 offen offset:2048 lds
    s_waitcnt lgkmcnt(2)
    v_mfma_f32_32x32x16_bf16 v[72:87], a[144:147], v[148:151], v[72:87]
    ds_read_b128 v[160:163], v51 offset:23552
    s_waitcnt lgkmcnt(2)
    v_mfma_f32_32x32x16_bf16 v[72:87], a[148:151], v[152:155], v[72:87]
    s_waitcnt vmcnt(7)
    s_barrier
    ds_read_b128 v[148:151], v51 offset:24576
    s_waitcnt lgkmcnt(2)
    v_mfma_f32_32x32x16_bf16 v[72:87], a[152:155], v[156:159], v[72:87]
    ds_read_b128 v[152:155], v51 offset:25600
    buffer_load_dwordx4 v67, s[16:19], s58 offen offset:3072 lds
    s_waitcnt lgkmcnt(2)
    v_mfma_f32_32x32x16_bf16 v[72:87], a[156:159], v[160:163], v[72:87]
    ds_read_b128 v[156:159], v51 offset:26624
    s_waitcnt lgkmcnt(2)
    v_mfma_f32_32x32x16_bf16 v[72:87], a[160:163], v[148:151], v[72:87]
    ds_read_b128 v[160:163], v51 offset:27648
    s_waitcnt lgkmcnt(2)
    v_mfma_f32_32x32x16_bf16 v[72:87], a[164:167], v[152:155], v[72:87]
    ds_read_b128 v[148:151], v51 offset:28672
    s_add_u32 m0, s47, 65536
    s_add_u32 s58, s48, 573440
    buffer_load_dwordx4 v64, s[16:19], s58 offen offset:0 lds
    s_waitcnt lgkmcnt(2)
    v_mfma_f32_32x32x16_bf16 v[72:87], a[168:171], v[156:159], v[72:87]
    ds_read_b128 v[152:155], v51 offset:29696
    s_waitcnt lgkmcnt(2)
    v_mfma_f32_32x32x16_bf16 v[72:87], a[172:175], v[160:163], v[72:87]
    ds_read_b128 v[156:159], v51 offset:30720
    s_waitcnt lgkmcnt(2)
    v_mfma_f32_32x32x16_bf16 v[72:87], a[176:179], v[148:151], v[72:87]
    ds_read_b128 v[160:163], v51 offset:31744
    buffer_load_dwordx4 v65, s[16:19], s58 offen offset:1024 lds
    s_waitcnt lgkmcnt(2)
    v_mfma_f32_32x32x16_bf16 v[72:87], a[180:183], v[152:155], v[72:87]
    s_waitcnt lgkmcnt(1)
    v_mfma_f32_32x32x16_bf16 v[72:87], a[184:187], v[156:159], v[72:87]
    s_waitcnt lgkmcnt(0)
    v_mfma_f32_32x32x16_bf16 v[72:87], a[188:191], v[160:163], v[72:87]
    s_nop 11
    v_cvt_pk_bf16_f32 v12, v72, v73
    v_cvt_pk_bf16_f32 v13, v74, v75
    v_cvt_pk_bf16_f32 v14, v76, v77
    v_cvt_pk_bf16_f32 v15, v78, v79
    v_cvt_pk_bf16_f32 v16, v80, v81
    v_cvt_pk_bf16_f32 v17, v82, v83
    v_cvt_pk_bf16_f32 v18, v84, v85
    v_cvt_pk_bf16_f32 v19, v86, v87
    buffer_store_dwordx4 v[12:15], v51, s[28:31], s44 offen offset:0 sc1
    buffer_store_dwordx4 v[16:19], v51, s[28:31], s44 offen offset:1024 sc1
    v_dot2c_f32_bf16 v68, s61, v12
    v_dot2c_f32_bf16 v69, v12, v12
    v_dot2c_f32_bf16 v68, s61, v13
    v_dot2c_f32_bf16 v69, v13, v13
    v_dot2c_f32_bf16 v68, s61, v14
    v_dot2c_f32_bf16 v69, v14, v14
    v_dot2c_f32_bf16 v68, s61, v15
    v_dot2c_f32_bf16 v69, v15, v15
    v_dot2c_f32_bf16 v68, s61, v16
    v_dot2c_f32_bf16 v69, v16, v16
    v_dot2c_f32_bf16 v68, s61, v17
    v_dot2c_f32_bf16 v69, v17, v17
    v_dot2c_f32_bf16 v68, s61, v18
    v_dot2c_f32_bf16 v69, v18, v18
    v_dot2c_f32_bf16 v68, s61, v19
    v_dot2c_f32_bf16 v69, v19, v19
    s_nop 1
    v_mov_b32_e64 v148, v68
    v_mov_b32 v149, v69
    s_nop 0
    v_permlane32_swap_b32 v68, v148
    v_permlane32_swap_b32 v69, v149
    v_pk_add_f32 v[68:69], v[68:69], v[148:149]
    buffer_store_dwordx2 v[68:69], v43, s[28:31], s43 offen sc1
    s_add_u32 s41, s28, 17825408
    s_addc_u32 s42, s29, 0
    s_cmp_eq_u32 s37, 3
    s_cselect_b32 s20, s41, s20
    s_cselect_b32 s21, s42, s21
    s_lshl_b32 s41, s63, 7
    s_add_u32 s41, s41, 147456
    v_lshl_add_u32 v68, v47, 4, s41
    ds_read_b128 v[148:151], v68 offset:0
    ds_read_b128 v[152:155], v68 offset:32
    ds_read_b128 v[156:159], v68 offset:64
    ds_read_b128 v[160:163], v68 offset:96
    v_mfma_f32_32x32x16_bf16 v[212:227], v[168:171], v[108:111], v[212:227]
    buffer_load_dwordx4 v66, s[16:19], s58 offen offset:2048 lds
    v_cvt_pk_bf16_f32 v100, v116, v117
    v_cvt_pk_bf16_f32 v101, v118, v119
    v_mfma_f32_32x32x16_bf16 v[228:243], a[212:215], v[108:111], v[228:243]
    ds_read_b64_tr_b16 a[32:33], v24 offset:16384
    ds_read_b64_tr_b16 a[34:35], v24 offset:17408
    v_cvt_pk_bf16_f32 v102, v120, v121
    v_cvt_pk_bf16_f32 v103, v122, v123
    v_mfma_f32_32x32x16_bf16 v[212:227], v[200:203], v[112:115], v[212:227]
    ds_read_b64_tr_b16 a[36:37], v25 offset:16384
    ds_read_b64_tr_b16 a[38:39], v25 offset:17408
    v_xor_b32_dpp v104, v100, v144 quad_perm:[0,1,3,2] row_mask:0xf bank_mask:0xf
    v_xor_b32_dpp v105, v101, v144 quad_perm:[0,1,3,2] row_mask:0xf bank_mask:0xf
    v_mfma_f32_32x32x16_bf16 v[228:243], a[244:247], v[112:115], v[228:243]
    ds_read_b64_tr_b16 a[40:41], v24 offset:18432
    ds_read_b64_tr_b16 a[42:43], v24 offset:19456
    v_xor_b32_dpp v106, v102, v144 quad_perm:[0,1,3,2] row_mask:0xf bank_mask:0xf
    v_xor_b32_dpp v107, v103, v144 quad_perm:[0,1,3,2] row_mask:0xf bank_mask:0xf
    v_mfma_f32_32x32x16_bf16 v[212:227], v[172:175], v[100:103], v[212:227]
    ds_read_b64_tr_b16 a[44:45], v25 offset:18432
    ds_read_b64_tr_b16 a[46:47], v25 offset:19456
    v_cvt_pk_bf16_f32 v108, v124, v125
    v_cvt_pk_bf16_f32 v109, v126, v127
    v_mfma_f32_32x32x16_bf16 v[228:243], a[216:219], v[100:103], v[228:243]
    s_waitcnt vmcnt(10)
    ds_read_b64_tr_b16 a[48:49], v24 offset:32768
    ds_read_b64_tr_b16 a[50:51], v24 offset:33792
    v_cvt_pk_bf16_f32 v110, v128, v129
    v_cvt_pk_bf16_f32 v111, v130, v131
    v_mfma_f32_32x32x16_bf16 v[212:227], v[204:207], v[104:107], v[212:227]
    ds_read_b64_tr_b16 a[52:53], v25 offset:32768
    ds_read_b64_tr_b16 a[54:55], v25 offset:33792
    v_xor_b32_dpp v112, v108, v144 quad_perm:[0,1,3,2] row_mask:0xf bank_mask:0xf
    v_xor_b32_dpp v113, v109, v144 quad_perm:[0,1,3,2] row_mask:0xf bank_mask:0xf
    v_mfma_f32_32x32x16_bf16 v[228:243], a[248:251], v[104:107], v[228:243]
    buffer_load_dwordx4 v67, s[16:19], s58 offen offset:3072 lds
    v_xor_b32_dpp v114, v110, v144 quad_perm:[0,1,3,2] row_mask:0xf bank_mask:0xf
    v_xor_b32_dpp v115, v111, v144 quad_perm:[0,1,3,2] row_mask:0xf bank_mask:0xf
    v_mfma_f32_32x32x16_bf16 v[212:227], v[176:179], v[108:111], v[212:227]
    ds_read_b64_tr_b16 a[56:57], v24 offset:34816
    ds_read_b64_tr_b16 a[58:59], v24 offset:35840
    v_mfma_f32_32x32x16_bf16 v[228:243], a[220:223], v[108:111], v[228:243]
    ds_read_b64_tr_b16 a[60:61], v25 offset:34816
    ds_read_b64_tr_b16 a[62:63], v25 offset:35840
    v_mfma_f32_32x32x16_bf16 v[212:227], v[208:211], v[112:115], v[212:227]
    s_waitcnt vmcnt(7)
    ds_read_b64_tr_b16 a[64:65], v24 offset:49152
    ds_read_b64_tr_b16 a[66:67], v24 offset:50176
    v_mfma_f32_32x32x16_bf16 v[228:243], a[252:255], v[112:115], v[228:243]
    ds_read_b64_tr_b16 a[68:69], v25 offset:49152
    ds_read_b64_tr_b16 a[70:71], v25 offset:50176
    v_mov_b32 v32, 0
    v_mov_b32_e64 v33, 0
    v_add_u32 v30, 14336, v28
    v_add_u32 v31, 21504, v28
    s_mov_b32 s26, 2097152
    s_mov_b32 s27, 0x20000
    s_bfe_i32 s57, s37, 0x10002
    s_or_b32 s57, s57, 1
    s_nop 1
    v_pk_fma_f32 v[212:213], v[228:229], v[90:91], v[212:213] op_sel_hi:[1,0,1]
    v_pk_fma_f32 v[214:215], v[230:231], v[90:91], v[214:215] op_sel_hi:[1,0,1]
    v_pk_fma_f32 v[216:217], v[232:233], v[90:91], v[216:217] op_sel_hi:[1,0,1]
    v_pk_fma_f32 v[218:219], v[234:235], v[90:91], v[218:219] op_sel_hi:[1,0,1]
    v_pk_fma_f32 v[220:221], v[236:237], v[90:91], v[220:221] op_sel_hi:[1,0,1]
    v_pk_fma_f32 v[222:223], v[238:239], v[90:91], v[222:223] op_sel_hi:[1,0,1]
    v_pk_fma_f32 v[224:225], v[240:241], v[90:91], v[224:225] op_sel_hi:[1,0,1]
    v_pk_fma_f32 v[226:227], v[242:243], v[90:91], v[226:227] op_sel_hi:[1,0,1]
    s_waitcnt lgkmcnt(15)
    v_pk_mul_f32 v[212:213], v[212:213], v[148:149]
    v_pk_mul_f32 v[214:215], v[214:215], v[150:151]
    s_waitcnt lgkmcnt(15)
    v_pk_mul_f32 v[216:217], v[216:217], v[152:153]
    ds_read_b64_tr_b16 a[72:73], v24 offset:51200
    ds_read_b64_tr_b16 a[74:75], v24 offset:52224
    s_add_u32 m0, s47, 0
    s_add_u32 s58, s48, 688128
    buffer_load_dwordx4 v64, s[16:19], s58 offen offset:0 lds
    v_pk_mul_f32 v[218:219], v[218:219], v[154:155]
    s_waitcnt lgkmcnt(15)
    v_pk_mul_f32 v[220:221], v[220:221], v[156:157]
    v_pk_mul_f32 v[222:223], v[222:223], v[158:159]
    s_waitcnt lgkmcnt(15)
    v_pk_mul_f32 v[224:225], v[224:225], v[160:161]
    v_pk_mul_f32 v[226:227], v[226:227], v[162:163]
    v_cvt_pk_bf16_f32 v100, v212, v213
    v_cvt_pk_bf16_f32 v101, v214, v215
    v_cvt_pk_bf16_f32 v102, v216, v217
    v_cvt_pk_bf16_f32 v103, v218, v219
    v_cvt_pk_bf16_f32 v104, v220, v221
    v_cvt_pk_bf16_f32 v105, v222, v223
    v_cvt_pk_bf16_f32 v106, v224, v225
    v_cvt_pk_bf16_f32 v107, v226, v227
    v_xor_b32_dpp v108, v100, v91 quad_perm:[1,0,3,2] row_mask:0xf bank_mask:0xf
    v_xor_b32_dpp v109, v101, v91 quad_perm:[1,0,3,2] row_mask:0xf bank_mask:0xf
    v_xor_b32_dpp v110, v102, v91 quad_perm:[1,0,3,2] row_mask:0xf bank_mask:0xf
    v_xor_b32_dpp v111, v103, v91 quad_perm:[1,0,3,2] row_mask:0xf bank_mask:0xf
    v_xor_b32_dpp v112, v104, v91 quad_perm:[1,0,3,2] row_mask:0xf bank_mask:0xf
    v_xor_b32_dpp v113, v105, v91 quad_perm:[1,0,3,2] row_mask:0xf bank_mask:0xf
    v_xor_b32_dpp v114, v106, v91 quad_perm:[1,0,3,2] row_mask:0xf bank_mask:0xf
    v_xor_b32_dpp v115, v107, v91 quad_perm:[1,0,3,2] row_mask:0xf bank_mask:0xf
    v_mfma_f32_32x32x16_bf16 v[148:163], v[100:103], v[180:183], 0
    s_lshl_b32 s41, s3, 7
    s_lshl2_add_u32 s41, s63, s41
    s_add_u32 s41, s41, 36864
    v_xor_b32 v41, v47, v46
    v_lshl_add_u32 v41, v41, 4, s41
    v_lshl_add_u32 v132, v48, 8, v41
    v_xor_b32_e64 v133, 32, v132
    v_mfma_f32_32x32x16_bf16 v[148:163], v[104:107], v[184:187], v[148:163]
    v_xor_b32_e64 v134, 64, v132
    v_xor_b32 v135, 96, v132
    s_lshl_b32 s41, s38, 11
    s_add_u32 s41, s41, 36864
    v_xor_b32 v41, v50, v0
    v_lshl_add_u32 v137, v41, 4, s41
    v_xor_b32_e64 v138, 64, v137
    v_mfma_f32_32x32x16_bf16 v[148:163], v[108:111], v[188:191], v[148:163]
    v_mul_u32_u24 v41, 73728, v50
    v_lshl_add_u32 v136, v49, 4, v41
    s_mul_i32 s41, s38, 589824
    s_mul_i32 s42, s36, 2304
    ds_read_b64_tr_b16 a[76:77], v25 offset:51200
    ds_read_b64_tr_b16 a[78:79], v25 offset:52224
    buffer_load_dwordx4 v65, s[16:19], s58 offen offset:1024 lds
    s_add_u32 s41, s41, s42
    s_lshl_b32 s42, s37, 8
    s_add_u32 s41, s41, s42
    v_mfma_f32_32x32x16_bf16 v[148:163], v[112:115], v[192:195], v[148:163]
    s_add_u32 s45, s41, 5505024
    s_add_u32 s46, s45, 294912
    s_mul_i32 s53, s36, 229376
    s_add_u32 s53, s53, 8388608
    s_add_u32 s62, s62, s53
    s_add_u32 s41, s37, 1
    s_lshr_b32 s41, s41, 3
    s_sub_u32 s41, 7, s41
    s_mul_i32 s41, s41, 196608
    s_add_u32 s55, s50, s41
    s_add_u32 s49, s50, 1572864
    s_add_u32 s50, s49, 32768
    s_lshl_b32 s41, s101, 15
    s_add_u32 s51, s49, s41
    v_mov_b32 v43, v136
    v_mov_b32 v68, v137
    v_mov_b32_e64 v69, v138
    v_cvt_pk_bf16_f32 v4, v148, v149
    v_cvt_pk_bf16_f32 v5, v150, v151
    v_cvt_pk_bf16_f32 v6, v152, v153
    v_cvt_pk_bf16_f32 v7, v154, v155
    v_cvt_pk_bf16_f32 v8, v156, v157
    v_cvt_pk_bf16_f32 v9, v158, v159
    v_cvt_pk_bf16_f32 v10, v160, v161
    v_cvt_pk_bf16_f32 v11, v162, v163
    buffer_load_dwordx4 v66, s[16:19], s58 offen offset:2048 lds
    buffer_load_dwordx4 v67, s[16:19], s58 offen offset:3072 lds
    s_waitcnt vmcnt(6)
    s_waitcnt lgkmcnt(0)
    s_barrier
    buffer_atomic_add v40, v39, s[28:31], s56 offen offset:32 sc1
    ds_write2_b32 v132, v4, v5 offset0:0 offset1:2
    ds_write2_b32 v133, v6, v7 offset0:0 offset1:2
    ds_write2_b32 v134, v8, v9 offset0:0 offset1:2
    ds_write2_b32 v135, v10, v11 offset0:0 offset1:2
    s_lshl_b32 s43, s36, 13
    s_lshl_b32 s54, s37, 7
    s_add_u32 s54, s54, 32768
    v_lshlrev_b32 v12, 7, v46
    v_add_u32 v12, 32772, v12
    buffer_load_dword v13, v12, s[28:31], 0 offen sc1
    s_add_u32 m0, s47, 16384
    s_add_u32 s58, s48, 802816
    buffer_load_dwordx4 v64, s[16:19], s58 offen offset:0 lds
    buffer_load_dwordx4 v65, s[16:19], s58 offen offset:1024 lds
    buffer_load_dwordx4 v66, s[16:19], s58 offen offset:2048 lds
    buffer_load_dwordx4 v67, s[16:19], s58 offen offset:3072 lds
    s_waitcnt vmcnt(10)
    v_mfma_f32_16x16x32_bf16 v[56:59], v[52:55], a[16:19], v[56:59]
    ds_read_b64_tr_b16 a[80:81], v26 offset:0
    v_mfma_f32_16x16x32_bf16 v[60:63], v[52:55], a[20:23], v[60:63]
    ds_read_b64_tr_b16 a[82:83], v26 offset:1024
    v_mfma_f32_16x16x32_bf16 v[56:59], v[52:55], a[24:27], v[56:59]
    ds_read_b64_tr_b16 a[84:85], v27 offset:0
    v_mfma_f32_16x16x32_bf16 v[60:63], v[52:55], a[28:31], v[60:63]
    ds_read_b64_tr_b16 a[86:87], v27 offset:1024
    v_mfma_f32_16x16x32_bf16 v[56:59], v[52:55], a[32:35], v[56:59]
    ds_read_b64_tr_b16 a[88:89], v26 offset:2048
    v_mfma_f32_16x16x32_bf16 v[60:63], v[52:55], a[36:39], v[60:63]
    ds_read_b64_tr_b16 a[90:91], v26 offset:3072
    v_mfma_f32_16x16x32_bf16 v[56:59], v[52:55], a[40:43], v[56:59]
    ds_read_b64_tr_b16 a[92:93], v27 offset:2048
    v_mfma_f32_16x16x32_bf16 v[60:63], v[52:55], a[44:47], v[60:63]
    ds_read_b64_tr_b16 a[94:95], v27 offset:3072
    s_waitcnt vmcnt(6)
    v_mfma_f32_16x16x32_bf16 v[56:59], v[52:55], a[48:51], v[56:59]
    ds_read_b64_tr_b16 a[96:97], v24 offset:0
    v_mfma_f32_16x16x32_bf16 v[60:63], v[52:55], a[52:55], v[60:63]
    ds_read_b64_tr_b16 a[98:99], v24 offset:1024
    v_mfma_f32_16x16x32_bf16 v[56:59], v[52:55], a[56:59], v[56:59]
    ds_read_b64_tr_b16 a[100:101], v25 offset:0
    v_mfma_f32_16x16x32_bf16 v[60:63], v[52:55], a[60:63], v[60:63]
    ds_read_b64_tr_b16 a[102:103], v25 offset:1024
    v_mfma_f32_16x16x32_bf16 v[56:59], v[52:55], a[64:67], v[56:59]
    ds_read_b64_tr_b16 a[104:105], v24 offset:2048
    v_mfma_f32_16x16x32_bf16 v[60:63], v[52:55], a[68:71], v[60:63]
    ds_read_b64_tr_b16 a[106:107], v24 offset:3072
    v_mfma_f32_16x16x32_bf16 v[56:59], v[52:55], a[72:75], v[56:59]
    ds_read_b64_tr_b16 a[108:109], v25 offset:2048
    v_mfma_f32_16x16x32_bf16 v[60:63], v[52:55], a[76:79], v[60:63]
    ds_read_b64_tr_b16 a[110:111], v25 offset:3072
    s_mov_b32 s40, 0
Lp_1007:
    s_load_dword s100, s[0:1], 32 glc
Lc_1009:
    s_waitcnt lgkmcnt(0)
    s_cmp_ge_u32 s100, 8
    s_cbranch_scc1 Ld_1008
    s_add_u32 s40, s40, 1
    s_cmp_lt_u32 s40, 200000
    s_cbranch_scc1 Lp_1007
Ld_1008:
    s_mov_b32 m0, 0
    s_add_u32 s58, s52, 3145728
    buffer_load_dwordx4 v44, s[28:31], s58 offen offset:0 sc1 lds
    buffer_load_dwordx4 v44, s[28:31], s58 offen offset:1024 sc1 lds
    buffer_load_dwordx4 v44, s[28:31], s58 offen offset:2048 sc1 lds
    buffer_load_dwordx4 v44, s[28:31], s58 offen offset:3072 sc1 lds
    s_mov_b32 m0, 4096
    s_add_u32 s58, s52, 3149824
    buffer_load_dwordx4 v44, s[28:31], s58 offen offset:0 sc1 lds
    buffer_load_dwordx4 v44, s[28:31], s58 offen offset:1024 sc1 lds
    buffer_load_dwordx4 v44, s[28:31], s58 offen offset:2048 sc1 lds
    buffer_load_dwordx4 v44, s[28:31], s58 offen offset:3072 sc1 lds
    s_mov_b32 m0, 8192
    s_add_u32 s58, s52, 3153920
    buffer_load_dwordx4 v44, s[28:31], s58 offen offset:0 sc1 lds
    buffer_load_dwordx4 v44, s[28:31], s58 offen offset:1024 sc1 lds
    buffer_load_dwordx4 v44, s[28:31], s58 offen offset:2048 sc1 lds
    buffer_load_dwordx4 v44, s[28:31], s58 offen offset:3072 sc1 lds
    s_mov_b32 m0, 12288
    s_add_u32 s58, s52, 3158016
    buffer_load_dwordx4 v44, s[28:31], s58 offen offset:0 sc1 lds
    buffer_load_dwordx4 v44, s[28:31], s58 offen offset:1024 sc1 lds
    buffer_load_dwordx4 v44, s[28:31], s58 offen offset:2048 sc1 lds
    buffer_load_dwordx4 v44, s[28:31], s58 offen offset:3072 sc1 lds
    s_mov_b32 m0, 147456
    s_add_u32 s58, s43, 5242880
    buffer_load_dwordx4 v44, s[28:31], s58 offen offset:0 sc1 lds
    buffer_load_dwordx4 v44, s[28:31], s58 offen offset:1024 sc1 lds
    buffer_load_dwordx4 v44, s[28:31], s58 offen offset:2048 sc1 lds
    buffer_load_dwordx4 v44, s[28:31], s58 offen offset:3072 sc1 lds
    s_mov_b32 m0, 151552
    s_add_u32 s58, s43, 5246976
    buffer_load_dwordx4 v44, s[28:31], s58 offen offset:0 sc1 lds
    buffer_load_dwordx4 v44, s[28:31], s58 offen offset:1024 sc1 lds
    buffer_load_dwordx4 v44, s[28:31], s58 offen offset:2048 sc1 lds
    buffer_load_dwordx4 v44, s[28:31], s58 offen offset:3072 sc1 lds
    s_mov_b32 m0, 16384
    s_add_u32 s58, s52, 3162112
    buffer_load_dwordx4 v44, s[28:31], s58 offen offset:0 sc1 lds
    buffer_load_dwordx4 v44, s[28:31], s58 offen offset:1024 sc1 lds
    buffer_load_dwordx4 v44, s[28:31], s58 offen offset:2048 sc1 lds
    buffer_load_dwordx4 v44, s[28:31], s58 offen offset:3072 sc1 lds
    s_mov_b32 m0, 20480
    s_add_u32 s58, s52, 3166208
    buffer_load_dwordx4 v44, s[28:31], s58 offen offset:0 sc1 lds
    buffer_load_dwordx4 v44, s[28:31], s58 offen offset:1024 sc1 lds
    buffer_load_dwordx4 v44, s[28:31], s58 offen offset:2048 sc1 lds
    buffer_load_dwordx4 v44, s[28:31], s58 offen offset:3072 sc1 lds
    s_mov_b32 m0, 24576
    s_add_u32 s58, s52, 3170304
    buffer_load_dwordx4 v44, s[28:31], s58 offen offset:0 sc1 lds
    buffer_load_dwordx4 v44, s[28:31], s58 offen offset:1024 sc1 lds
    buffer_load_dwordx4 v44, s[28:31], s58 offen offset:2048 sc1 lds
    buffer_load_dwordx4 v44, s[28:31], s58 offen offset:3072 sc1 lds
    s_mov_b32 m0, 28672
    s_add_u32 s58, s52, 3174400
    buffer_load_dwordx4 v44, s[28:31], s58 offen offset:0 sc1 lds
    buffer_load_dwordx4 v44, s[28:31], s58 offen offset:1024 sc1 lds
    buffer_load_dwordx4 v44, s[28:31], s58 offen offset:2048 sc1 lds
    buffer_load_dwordx4 v44, s[28:31], s58 offen offset:3072 sc1 lds
    s_waitcnt vmcnt(40)
    v_mfma_f32_16x16x32_bf16 v[56:59], v[52:55], a[80:83], v[56:59]
    ds_read_b64_tr_b16 a[112:113], v24 offset:16384
    v_mfma_f32_16x16x32_bf16 v[60:63], v[52:55], a[84:87], v[60:63]
    ds_read_b64_tr_b16 a[114:115], v24 offset:17408
    v_mfma_f32_16x16x32_bf16 v[56:59], v[52:55], a[88:91], v[56:59]
    ds_read_b64_tr_b16 a[116:117], v25 offset:16384
    v_mfma_f32_16x16x32_bf16 v[60:63], v[52:55], a[92:95], v[60:63]
    ds_read_b64_tr_b16 a[118:119], v25 offset:17408
    v_mfma_f32_16x16x32_bf16 v[56:59], v[52:55], a[96:99], v[56:59]
    ds_read_b64_tr_b16 a[120:121], v24 offset:18432
    v_mfma_f32_16x16x32_bf16 v[60:63], v[52:55], a[100:103], v[60:63]
    ds_read_b64_tr_b16 a[122:123], v24 offset:19456
    v_mfma_f32_16x16x32_bf16 v[56:59], v[52:55], a[104:107], v[56:59]
    ds_read_b64_tr_b16 a[124:125], v25 offset:18432
    v_mfma_f32_16x16x32_bf16 v[60:63], v[52:55], a[108:111], v[60:63]
    ds_read_b64_tr_b16 a[126:127], v25 offset:19456
    s_waitcnt lgkmcnt(6)
    v_mfma_f32_16x16x32_bf16 v[56:59], v[52:55], a[112:115], v[56:59]
    s_waitcnt lgkmcnt(4)
    v_mfma_f32_16x16x32_bf16 v[60:63], v[52:55], a[116:119], v[60:63]
    s_waitcnt lgkmcnt(2)
    v_mfma_f32_16x16x32_bf16 v[56:59], v[52:55], a[120:123], v[56:59]
    s_waitcnt lgkmcnt(0)
    v_mfma_f32_16x16x32_bf16 v[60:63], v[52:55], a[124:127], v[60:63]
    s_nop 7
    v_add_f32 v56, v56, v60
    v_cvt_pk_bf16_f32 v41, v56, v56
    v_and_b32 v41, 0xffff0000, v41
    v_sub_f32_e64 v42, v56, v41
    v_cvt_pk_bf16_f32 v20, v41, v42
    v_and_b32 v21, 0xffff0000, v20
    v_sub_f32_e64 v42, v42, v21
    v_cvt_pk_bf16_f32 v21, v42, v41
    v_cmp_gt_u32 vcc, 32, v13
    s_cbranch_vccz Ld_1011
    s_mov_b32 s40, 0
Lp_1010:
    s_sleep 4
    buffer_load_dword v13, v12, s[28:31], 0 offen sc1
    s_add_u32 s40, s40, 1
    s_waitcnt vmcnt(0)
    s_cmp_gt_u32 s40, 100000
    s_cbranch_scc1 Ld_1011
    v_cmp_gt_u32 vcc, 32, v13
    s_cbranch_vccnz Lp_1010
Ld_1011:
    s_waitcnt vmcnt(24)
    s_barrier
    ds_read_b128 v[232:235], v44 offset:0
    ds_read_b128 v[236:239], v44 offset:1024
    ds_read_b128 v[240:243], v44 offset:2048
    ds_read_b128 v[12:15], v68 offset:0
    ds_read_b128 v[16:19], v69 offset:1024
    s_waitcnt lgkmcnt(4)
    v_mfma_f32_32x32x16_bf16 v[168:183], a[0:3], v[232:235], 0
    ds_read_b128 v[244:247], v44 offset:3072
    s_mov_b32 m0, 45056
    s_add_u32 s58, s52, 3190784
    buffer_load_dwordx4 v44, s[28:31], s58 offen offset:0 sc1 lds
    buffer_load_dwordx4 v44, s[28:31], s58 offen offset:1024 sc1 lds
    buffer_load_dwordx4 v44, s[28:31], s58 offen offset:2048 sc1 lds
    s_waitcnt lgkmcnt(4)
    v_mfma_f32_32x32x16_bf16 v[168:183], a[8:11], v[236:239], v[168:183]
    ds_read_b128 v[232:235], v44 offset:4096
    s_waitcnt lgkmcnt(2)
    s_cmp_lg_u32 s37, 0
    s_cbranch_scc1 Lj0_1006
    v_mov_b32_e64 v68, 1073741824
    v_cmp_gt_u32 vcc, 8, v49
    s_nop 1
    v_cndmask_b32 v68, v68, v43, vcc
    v_cmp_eq_u32 vcc, 0, v49
    buffer_store_dwordx4 v[12:15], v68, s[28:31], s45 offen offset:2048 sc1
    buffer_store_dwordx4 v[16:19], v68, s[28:31], s46 offen offset:2048 sc1
    s_nop 0
    v_cndmask_b32 v12, v12, 0, vcc
    v_cndmask_b32 v13, v13, 0, vcc
    v_cndmask_b32 v16, v16, 0, vcc
    v_cndmask_b32 v17, v17, 0, vcc
Lj0_1006:
    buffer_store_dwordx4 v[12:15], v43, s[28:31], s45 offen sc1
    buffer_store_dwordx4 v[16:19], v43, s[28:31], s46 offen sc1
    buffer_load_dwordx4 v44, s[28:31], s58 offen offset:3072 sc1 lds
    s_mov_b32 m0, 49152
    s_add_u32 s58, s52, 3194880
    buffer_load_dwordx4 v44, s[28:31], s58 offen offset:0 sc1 lds
    buffer_load_dwordx4 v44, s[28:31], s58 offen offset:1024 sc1 lds
    v_mfma_f32_32x32x16_bf16 v[168:183], a[16:19], v[240:243], v[168:183]
    ds_read_b128 v[236:239], v44 offset:5120
    buffer_load_dwordx4 v44, s[28:31], s58 offen offset:2048 sc1 lds
    buffer_load_dwordx4 v44, s[28:31], s58 offen offset:3072 sc1 lds
    s_mov_b32 m0, 53248
    s_add_u32 s58, s52, 3198976
    buffer_load_dwordx4 v44, s[28:31], s58 offen offset:0 sc1 lds
    s_waitcnt lgkmcnt(2)
    v_mfma_f32_32x32x16_bf16 v[168:183], a[24:27], v[244:247], v[168:183]
    ds_read_b128 v[240:243], v44 offset:6144
    buffer_load_dwordx4 v44, s[28:31], s58 offen offset:1024 sc1 lds
    buffer_load_dwordx4 v44, s[28:31], s58 offen offset:2048 sc1 lds
    buffer_load_dwordx4 v44, s[28:31], s58 offen offset:3072 sc1 lds
    s_waitcnt lgkmcnt(2)
    v_mfma_f32_32x32x16_bf16 v[168:183], a[32:35], v[232:235], v[168:183]
    ds_read_b128 v[244:247], v44 offset:7168
    s_mov_b32 m0, 57344
    s_add_u32 s58, s52, 3203072
    buffer_load_dwordx4 v44, s[28:31], s58 offen offset:0 sc1 lds
    buffer_load_dwordx4 v44, s[28:31], s58 offen offset:1024 sc1 lds
    buffer_load_dwordx4 v44, s[28:31], s58 offen offset:2048 sc1 lds
    s_waitcnt lgkmcnt(2)
    v_mfma_f32_32x32x16_bf16 v[168:183], a[40:43], v[236:239], v[168:183]
    ds_read_b128 v[232:235], v44 offset:8192
    buffer_load_dwordx4 v44, s[28:31], s58 offen offset:3072 sc1 lds
    s_mov_b32 m0, 61440
    s_add_u32 s58, s52, 3207168
    buffer_load_dwordx4 v44, s[28:31], s58 offen offset:0 sc1 lds
    buffer_load_dwordx4 v44, s[28:31], s58 offen offset:1024 sc1 lds
    s_waitcnt lgkmcnt(2)
    v_mfma_f32_32x32x16_bf16 v[168:183], a[48:51], v[240:243], v[168:183]
    ds_read_b128 v[236:239], v44 offset:9216
    buffer_load_dwordx4 v44, s[28:31], s58 offen offset:2048 sc1 lds
    buffer_load_dwordx4 v44, s[28:31], s58 offen offset:3072 sc1 lds
    s_mov_b32 m0, 32768
    s_add_u32 s58, s52, 3178496
    buffer_load_dwordx4 v44, s[28:31], s58 offen offset:0 sc1 lds
    s_waitcnt lgkmcnt(2)
    v_mfma_f32_32x32x16_bf16 v[168:183], a[56:59], v[244:247], v[168:183]
    ds_read_b128 v[240:243], v44 offset:10240
    buffer_load_dwordx4 v44, s[28:31], s58 offen offset:1024 sc1 lds
    buffer_load_dwordx4 v44, s[28:31], s58 offen offset:2048 sc1 lds
    buffer_load_dwordx4 v44, s[28:31], s58 offen offset:3072 sc1 lds
    s_waitcnt lgkmcnt(2)
    v_mfma_f32_32x32x16_bf16 v[168:183], a[64:67], v[232:235], v[168:183]
    ds_read_b128 v[244:247], v44 offset:11264
    s_waitcnt lgkmcnt(2)
    v_mfma_f32_32x32x16_bf16 v[168:183], a[72:75], v[236:239], v[168:183]
    s_waitcnt vmcnt(26)
    s_barrier
    ds_read_b128 v[232:235], v44 offset:12288
    s_mov_b32 m0, 36864
    s_add_u32 s58, s52, 3182592
    buffer_load_dwordx4 v44, s[28:31], s58 offen offset:0 sc1 lds
    buffer_load_dwordx4 v44, s[28:31], s58 offen offset:1024 sc1 lds
    buffer_load_dwordx4 v44, s[28:31], s58 offen offset:2048 sc1 lds
    buffer_load_dwordx4 v44, s[28:31], s58 offen offset:3072 sc1 lds
    s_mov_b32 m0, 40960
    s_add_u32 s58, s52, 3186688
    buffer_load_dwordx4 v44, s[28:31], s58 offen offset:0 sc1 lds
    buffer_load_dwordx4 v44, s[28:31], s58 offen offset:1024 sc1 lds
    buffer_load_dwordx4 v44, s[28:31], s58 offen offset:2048 sc1 lds
    buffer_load_dwordx4 v44, s[28:31], s58 offen offset:3072 sc1 lds
    s_add_u32 m0, s47, 32768
    s_cmp_le_u32 s101, 0
    s_cselect_b32 s58, s50, s49
    s_add_u32 s58, s58, 0
    buffer_load_dwordx4 v28, s[20:23], s58 offen offset:0 sc1 lds
    buffer_load_dwordx4 v29, s[20:23], s58 offen offset:1024 sc1 lds
    buffer_load_dwordx4 v30, s[20:23], s58 offen offset:2048 sc1 lds
    buffer_load_dwordx4 v31, s[20:23], s58 offen offset:3072 sc1 lds
    s_add_u32 m0, s47, 49152
    s_cmp_le_u32 s101, 1
    s_cselect_b32 s58, s50, s49
    s_add_u32 s58, s58, 32768
    buffer_load_dwordx4 v28, s[20:23], s58 offen offset:0 sc1 lds
    buffer_load_dwordx4 v29, s[20:23], s58 offen offset:1024 sc1 lds
    buffer_load_dwordx4 v30, s[20:23], s58 offen offset:2048 sc1 lds
    buffer_load_dwordx4 v31, s[20:23], s58 offen offset:3072 sc1 lds
    s_waitcnt lgkmcnt(2)
    v_mfma_f32_32x32x16_bf16 v[168:183], a[80:83], v[240:243], v[168:183]
    ds_read_b128 v[236:239], v44 offset:13312
    s_add_u32 m0, s47, 65536
    s_cmp_le_u32 s101, 2
    s_cselect_b32 s58, s50, s49
    s_add_u32 s58, s58, 65536
    buffer_load_dwordx4 v28, s[20:23], s58 offen offset:0 sc1 lds
    v_lshlrev_b32_e64 v41, 3, v0
    v_add_u32 v41, 147456, v41
    s_waitcnt lgkmcnt(2)
    v_mfma_f32_32x32x16_bf16 v[168:183], a[88:91], v[244:247], v[168:183]
    ds_read_b128 v[240:243], v44 offset:14336
    buffer_load_dwordx4 v29, s[20:23], s58 offen offset:1024 sc1 lds
    ds_read_b64 v[200:201], v41 offset:0
    ds_read_b64 v[216:217], v41 offset:4096
    ds_read_b64 v[202:203], v41 offset:512
    ds_read_b64 v[218:219], v41 offset:4608
    s_waitcnt lgkmcnt(6)
    v_mfma_f32_32x32x16_bf16 v[168:183], a[96:99], v[232:235], v[168:183]
    ds_read_b128 v[244:247], v44 offset:15360
    buffer_load_dwordx4 v30, s[20:23], s58 offen offset:2048 sc1 lds
    ds_read_b64 v[204:205], v41 offset:1024
    ds_read_b64 v[220:221], v41 offset:5120
    ds_read_b64 v[206:207], v41 offset:1536
    ds_read_b64 v[222:223], v41 offset:5632
    s_waitcnt lgkmcnt(10)
    v_mfma_f32_32x32x16_bf16 v[168:183], a[104:107], v[236:239], v[168:183]
    ds_read_b128 v[232:235], v44 offset:16384
    buffer_load_dwordx4 v31, s[20:23], s58 offen offset:3072 sc1 lds
    ds_read_b64 v[208:209], v41 offset:2048
    ds_read_b64 v[224:225], v41 offset:6144
    ds_read_b64 v[210:211], v41 offset:2560
    ds_read_b64 v[226:227], v41 offset:6656
    s_waitcnt lgkmcnt(14)
    v_mfma_f32_32x32x16_bf16 v[168:183], a[112:115], v[240:243], v[168:183]
    ds_read_b128 v[236:239], v44 offset:17408
    s_add_u32 m0, s47, 0
    s_cmp_le_u32 s101, 3
    s_cselect_b32 s58, s50, s49
    s_add_u32 s58, s58, 98304
    buffer_load_dwordx4 v28, s[20:23], s58 offen offset:0 sc1 lds
    ds_read_b64 v[212:213], v41 offset:3072
    s_waitcnt lgkmcnt(11)
    v_mfma_f32_32x32x16_bf16 v[168:183], a[120:123], v[244:247], v[168:183]
    s_waitcnt vmcnt(13)
    s_barrier
    buffer_atomic_add v40, v38, s[28:31], s54 offen offset:0 sc1
    ds_read_b128 v[240:243], v44 offset:18432
    buffer_load_dwordx4 v29, s[20:23], s58 offen offset:1024 sc1 lds
    ds_read_b64 v[228:229], v41 offset:7168
    s_waitcnt lgkmcnt(8)
    v_mfma_f32_32x32x16_bf16 v[168:183], a[4:7], v[232:235], v[168:183]
    ds_read_b128 v[244:247], v44 offset:19456
    buffer_load_dwordx4 v30, s[20:23], s58 offen offset:2048 sc1 lds
    ds_read_b64 v[214:215], v41 offset:3584
    ds_read_b64 v[230:231], v41 offset:7680
    s_waitcnt lgkmcnt(6)
    v_mfma_f32_32x32x16_bf16 v[168:183], a[12:15], v[236:239], v[168:183]
    ds_read_b128 v[232:235], v44 offset:20480
    buffer_load_dwordx4 v31, s[20:23], s58 offen offset:3072 sc1 lds
    s_waitcnt lgkmcnt(5)
    v_mfma_f32_32x32x16_bf16 v[168:183], a[20:23], v[240:243], v[168:183]
    ds_read_b128 v[236:239], v44 offset:21504
    s_add_u32 m0, s47, 16384
    s_cmp_le_u32 s101, 4
    s_cselect_b32 s58, s50, s49
    s_add_u32 s58, s58, 131072
    buffer_load_dwordx4 v28, s[20:23], s58 offen offset:0 sc1 lds
    s_waitcnt lgkmcnt(4)
    v_mfma_f32_32x32x16_bf16 v[168:183], a[28:31], v[244:247], v[168:183]
    ds_read_b128 v[240:243], v44 offset:22528
    buffer_load_dwordx4 v29, s[20:23], s58 offen offset:1024 sc1 lds
    s_waitcnt vmcnt(15)
    ds_read_b64_tr_b16 v[72:73], v24 offset:32768
    ds_read_b64_tr_b16 v[74:75], v24 offset:33792
    s_waitcnt lgkmcnt(4)
    v_mfma_f32_32x32x16_bf16 v[168:183], a[36:39], v[232:235], v[168:183]
    ds_read_b128 v[244:247], v44 offset:23552
    buffer_load_dwordx4 v30, s[20:23], s58 offen offset:2048 sc1 lds
    ds_read_b64_tr_b16 v[76:77], v25 offset:32768
    ds_read_b64_tr_b16 v[78:79], v25 offset:33792
    ds_read_b64_tr_b16 v[80:81], v24 offset:34816
    ds_read_b64_tr_b16 v[82:83], v24 offset:35840
    s_waitcnt lgkmcnt(8)
    v_mfma_f32_32x32x16_bf16 v[168:183], a[44:47], v[236:239], v[168:183]
    ds_read_b128 v[232:235], v44 offset:24576
    buffer_load_dwordx4 v31, s[20:23], s58 offen offset:3072 sc1 lds
    ds_read_b64_tr_b16 v[84:85], v25 offset:34816
    ds_read_b64_tr_b16 v[86:87], v25 offset:35840
    v_add_f32 v200, v200, v216
    v_add_f32 v201, v201, v217
    v_add_f32 v202, v202, v218
    v_add_f32 v203, v203, v219
    s_waitcnt lgkmcnt(10)
    v_mfma_f32_32x32x16_bf16 v[168:183], a[52:55], v[240:243], v[168:183]
    ds_read_b128 v[236:239], v44 offset:25600
    s_add_u32 m0, s47, 32768
    s_cmp_le_u32 s101, 5
    s_cselect_b32 s58, s50, s49
    s_add_u32 s58, s58, 163840
    s_waitcnt lgkmcnt(1)
    buffer_load_dwordx4 v28, s[20:23], s58 offen offset:0 sc1 lds
    v_add_f32 v204, v204, v220
    v_add_f32 v205, v205, v221
    v_add_f32 v206, v206, v222
    v_mfma_f32_32x32x16_bf16 v[168:183], a[60:63], v[244:247], v[168:183]
    ds_read_b128 v[240:243], v44 offset:26624
    buffer_load_dwordx4 v29, s[20:23], s58 offen offset:1024 sc1 lds
    s_waitcnt vmcnt(15)
    ds_read_b64_tr_b16 v[88:89], v24 offset:49152
    ds_read_b64_tr_b16 v[90:91], v24 offset:50176
    v_add_f32 v207, v207, v223
    v_add_f32 v208, v208, v224
    v_add_f32 v209, v209, v225
    v_mfma_f32_32x32x16_bf16 v[168:183], a[68:71], v[232:235], v[168:183]
    ds_read_b128 v[244:247], v44 offset:27648
    buffer_load_dwordx4 v30, s[20:23], s58 offen offset:2048 sc1 lds
    ds_read_b64_tr_b16 v[92:93], v25 offset:49152
    ds_read_b64_tr_b16 v[94:95], v25 offset:50176
    ds_read_b64_tr_b16 v[96:97], v24 offset:51200
    ds_read_b64_tr_b16 v[98:99], v24 offset:52224
    s_waitcnt lgkmcnt(8)
    v_mfma_f32_32x32x16_bf16 v[168:183], a[76:79], v[236:239], v[168:183]
    ds_read_b128 v[232:235], v44 offset:28672
    buffer_load_dwordx4 v31, s[20:23], s58 offen offset:3072 sc1 lds
    ds_read_b64_tr_b16 v[100:101], v25 offset:51200
    ds_read_b64_tr_b16 v[102:103], v25 offset:52224
    v_add_f32 v210, v210, v226
    v_add_f32 v211, v211, v227
    v_add_f32 v212, v212, v228
    v_add_f32 v213, v213, v229
    s_waitcnt lgkmcnt(10)
    v_mfma_f32_32x32x16_bf16 v[168:183], a[84:87], v[240:243], v[168:183]
    ds_read_b128 v[236:239], v44 offset:29696
    s_add_u32 m0, s47, 49152
    s_cmp_le_u32 s101, 6
    s_cselect_b32 s58, s50, s49
    s_add_u32 s58, s58, 196608
    s_waitcnt lgkmcnt(1)
    buffer_load_dwordx4 v28, s[20:23], s58 offen offset:0 sc1 lds
    v_add_f32 v214, v214, v230
    v_add_f32 v215, v215, v231
    v_add_f32 v200, v200, v208
    v_mfma_f32_32x32x16_bf16 v[168:183], a[92:95], v[244:247], v[168:183]
    ds_read_b128 v[240:243], v44 offset:30720
    buffer_load_dwordx4 v29, s[20:23], s58 offen offset:1024 sc1 lds
    s_waitcnt vmcnt(15)
    ds_read_b64_tr_b16 v[104:105], v26 offset:0
    ds_read_b64_tr_b16 v[106:107], v26 offset:1024
    v_add_f32 v201, v201, v209
    v_add_f32 v202, v202, v210
    v_add_f32 v203, v203, v211
    v_mfma_f32_32x32x16_bf16 v[168:183], a[100:103], v[232:235], v[168:183]
    ds_read_b128 v[244:247], v44 offset:31744
    buffer_load_dwordx4 v30, s[20:23], s58 offen offset:2048 sc1 lds
    ds_read_b64_tr_b16 v[108:109], v27 offset:0
    ds_read_b64_tr_b16 v[110:111], v27 offset:1024
    ds_read_b64_tr_b16 v[112:113], v26 offset:2048
    ds_read_b64_tr_b16 v[114:115], v26 offset:3072
    s_waitcnt lgkmcnt(8)
    v_mfma_f32_32x32x16_bf16 v[168:183], a[108:111], v[236:239], v[168:183]
    ds_read_b128 v[232:235], v44 offset:32768
    buffer_load_dwordx4 v31, s[20:23], s58 offen offset:3072 sc1 lds
    ds_read_b64_tr_b16 v[116:117], v27 offset:2048
    ds_read_b64_tr_b16 v[118:119], v27 offset:3072
    v_add_f32 v204, v204, v212
    v_add_f32 v205, v205, v213
    v_add_f32 v206, v206, v214
    v_add_f32 v207, v207, v215
    s_waitcnt lgkmcnt(10)
    v_mfma_f32_32x32x16_bf16 v[168:183], a[116:119], v[240:243], v[168:183]
    ds_read_b128 v[236:239], v44 offset:33792
    s_add_u32 m0, s47, 65536
    s_add_u32 s58, s55, 0
    s_waitcnt lgkmcnt(1)
    buffer_load_dwordx4 v28, s[20:23], s58 offen offset:0 sc1 lds
    v_add_f32 v200, v200, v204
    v_add_f32 v201, v201, v205
    v_add_f32 v202, v202, v206
    v_add_f32 v203, v203, v207
    v_add_f32_e64 v4, v200, v202
    v_mfma_f32_32x32x16_bf16 v[168:183], a[124:127], v[244:247], v[168:183]
    ds_read_b128 v[240:243], v44 offset:34816
    buffer_load_dwordx4 v29, s[20:23], s58 offen offset:1024 sc1 lds
    v_add_f32_e64 v5, v201, v203
    v_mul_f32 v50, 0xbb000000, v4
    v_mul_f32_e64 v41, v50, v50
    v_fma_f32 v41, v5, s60, -v41
    v_max_f32_e64 v41, 0, v41
    v_add_f32 v41, 0x3727c5ac, v41
    v_rsq_f32 v70, v41
    v_mov_b32 v51, v50
    v_mov_b32_e64 v71, v70
    s_nop 0
    v_permlane32_swap_b32 v50, v51
    v_permlane32_swap_b32 v70, v71
    v_cmp_gt_u32 vcc, 32, v0
    v_cvt_pk_bf16_f32 v41, v50, v50
    v_and_b32 v42, 0xffff0000, v41
    v_sub_f32_e64 v42, v50, v42
    v_cvt_pk_bf16_f32 v35, v42, v42
    v_cndmask_b32 v34, v35, v41, vcc
    v_and_b32 v35, 0xffff0000, v35
    v_sub_f32 v42, v42, v35
    v_cvt_pk_bf16_f32 v42, v50, v42
    v_cndmask_b32 v35, 0, v42, vcc
    v_rcp_f32 v252, v70
    v_mul_f32 v248, 0xc0135761, v70
    v_mul_f32 v6, v70, v70
    v_mul_f32 v6, v6, v70
    v_mul_f32 v250, 0xbdd2d3e8, v6
    v_mfma_f32_32x32x16_bf16 v[168:183], v[20:23], v[34:37], v[168:183]
    buffer_load_dwordx4 v30, s[20:23], s58 offen offset:2048 sc1 lds
    buffer_load_dwordx4 v31, s[20:23], s58 offen offset:3072 sc1 lds
    s_nop 9
    v_pk_mul_f32 v[4:5], v[168:169], v[168:169]
    v_pk_mul_f32 v[6:7], v[170:171], v[170:171]
    v_pk_mul_f32 v[8:9], v[172:173], v[172:173]
    v_pk_mul_f32 v[10:11], v[174:175], v[174:175]
    v_pk_fma_f32 v[4:5], v[4:5], v[250:251], v[248:249] op_sel_hi:[1,0,0]
    v_pk_fma_f32 v[6:7], v[6:7], v[250:251], v[248:249] op_sel_hi:[1,0,0]
    v_pk_fma_f32 v[8:9], v[8:9], v[250:251], v[248:249] op_sel_hi:[1,0,0]
    v_pk_fma_f32 v[10:11], v[10:11], v[250:251], v[248:249] op_sel_hi:[1,0,0]
    v_pk_mul_f32 v[4:5], v[4:5], v[168:169]
    v_pk_mul_f32 v[6:7], v[6:7], v[170:171]
    v_pk_mul_f32 v[8:9], v[8:9], v[172:173]
    v_pk_mul_f32 v[10:11], v[10:11], v[174:175]
    v_exp_f32 v4, v4
    v_exp_f32 v5, v5
    v_exp_f32 v6, v6
    v_exp_f32 v7, v7
    v_exp_f32 v8, v8
    v_exp_f32 v9, v9
    v_exp_f32 v10, v10
    v_exp_f32_e64 v11, v11
    v_pk_fma_f32 v[4:5], v[4:5], v[252:253], v[252:253] op_sel_hi:[1,0,0]
    v_pk_fma_f32 v[6:7], v[6:7], v[252:253], v[252:253] op_sel_hi:[1,0,0]
    v_pk_fma_f32 v[8:9], v[8:9], v[252:253], v[252:253] op_sel_hi:[1,0,0]
    v_pk_fma_f32 v[10:11], v[10:11], v[252:253], v[252:253] op_sel_hi:[1,0,0]
    s_waitcnt vmcnt(16)
    ds_read_b64_tr_b16 v[120:121], v24 offset:0
    ds_read_b64_tr_b16 v[122:123], v24 offset:1024
    v_rcp_f32 v4, v4
    v_rcp_f32 v5, v5
    v_rcp_f32 v6, v6
    v_rcp_f32 v7, v7
    v_rcp_f32 v8, v8
    v_rcp_f32 v9, v9
    v_rcp_f32 v10, v10
    v_rcp_f32_e64 v11, v11
    v_pk_mul_f32 v[4:5], v[4:5], v[168:169]
    v_pk_mul_f32 v[6:7], v[6:7], v[170:171]
    v_pk_mul_f32 v[8:9], v[8:9], v[172:173]
    v_pk_mul_f32 v[10:11], v[10:11], v[174:175]
    v_cvt_pk_bf16_f32 v168, v4, v5
    v_cvt_pk_bf16_f32 v169, v6, v7
    v_cvt_pk_bf16_f32 v170, v8, v9
    v_cvt_pk_bf16_f32 v171, v10, v11
    buffer_store_dwordx4 v[168:171], v44, s[28:31], s62 offen offset:0 sc1
    v_pk_mul_f32 v[4:5], v[176:177], v[176:177]
    v_pk_mul_f32 v[6:7], v[178:179], v[178:179]
    v_pk_mul_f32 v[8:9], v[180:181], v[180:181]
    v_pk_mul_f32 v[10:11], v[182:183], v[182:183]
    v_pk_fma_f32 v[4:5], v[4:5], v[250:251], v[248:249] op_sel_hi:[1,0,0]
    v_pk_fma_f32 v[6:7], v[6:7], v[250:251], v[248:249] op_sel_hi:[1,0,0]
    ds_read_b64_tr_b16 v[124:125], v25 offset:0
    ds_read_b64_tr_b16 v[126:127], v25 offset:1024
    v_pk_fma_f32 v[8:9], v[8:9], v[250:251], v[248:249] op_sel_hi:[1,0,0]
    v_pk_fma_f32 v[10:11], v[10:11], v[250:251], v[248:249] op_sel_hi:[1,0,0]
    v_pk_mul_f32 v[4:5], v[4:5], v[176:177]
    v_pk_mul_f32 v[6:7], v[6:7], v[178:179]
    v_pk_mul_f32 v[8:9], v[8:9], v[180:181]
    v_pk_mul_f32 v[10:11], v[10:11], v[182:183]
    v_exp_f32 v4, v4
    v_exp_f32 v5, v5
    v_exp_f32 v6, v6
    v_exp_f32 v7, v7
    v_exp_f32 v8, v8
    v_exp_f32 v9, v9
    v_exp_f32 v10, v10
    v_exp_f32 v11, v11
    v_pk_fma_f32 v[4:5], v[4:5], v[252:253], v[252:253] op_sel_hi:[1,0,0]
    v_pk_fma_f32 v[6:7], v[6:7], v[252:253], v[252:253] op_sel_hi:[1,0,0]
    v_pk_fma_f32 v[8:9], v[8:9], v[252:253], v[252:253] op_sel_hi:[1,0,0]
    v_pk_fma_f32 v[10:11], v[10:11], v[252:253], v[252:253] op_sel_hi:[1,0,0]
    v_rcp_f32 v4, v4
    v_rcp_f32 v5, v5
    v_rcp_f32 v6, v6
    v_rcp_f32 v7, v7
    ds_read_b64_tr_b16 v[128:129], v24 offset:2048
    ds_read_b64_tr_b16 v[130:131], v24 offset:3072
    v_rcp_f32 v8, v8
    v_rcp_f32 v9, v9
    v_rcp_f32 v10, v10
    v_rcp_f32 v11, v11
    v_pk_mul_f32 v[4:5], v[4:5], v[176:177]
    v_pk_mul_f32 v[6:7], v[6:7], v[178:179]
    v_pk_mul_f32 v[8:9], v[8:9], v[180:181]
    v_pk_mul_f32 v[10:11], v[10:11], v[182:183]
    v_cvt_pk_bf16_f32 v176, v4, v5
    v_cvt_pk_bf16_f32 v177, v6, v7
    v_cvt_pk_bf16_f32 v178, v8, v9
    v_cvt_pk_bf16_f32 v179, v10, v11
    buffer_store_dwordx4 v[176:179], v44, s[28:31], s62 offen offset:1024 sc1
    v_mfma_f32_32x32x16_bf16 v[200:215], a[0:3], v[232:235], 0
    ds_read_b128 v[244:247], v44 offset:35840
    ds_read_b64_tr_b16 v[132:133], v25 offset:2048
    ds_read_b64_tr_b16 v[134:135], v25 offset:3072
    v_cmp_gt_u32 vcc, 32, v0
    v_cvt_pk_bf16_f32 v41, v51, v51
    v_and_b32 v42, 0xffff0000, v41
    s_waitcnt lgkmcnt(10)
    v_mfma_f32_32x32x16_bf16 v[200:215], a[8:11], v[236:239], v[200:215]
    ds_read_b128 v[232:235], v44 offset:36864
    s_add_u32 m0, s47, 0
    s_add_u32 s58, s55, 32768
    s_waitcnt lgkmcnt(1)
    buffer_load_dwordx4 v28, s[20:23], s58 offen offset:0 sc1 lds
    v_sub_f32_e64 v42, v51, v42
    v_mfma_f32_32x32x16_bf16 v[200:215], a[16:19], v[240:243], v[200:215]
    ds_read_b128 v[236:239], v44 offset:37888
    s_waitcnt vmcnt(15)
    ds_read_b64_tr_b16 v[136:137], v24 offset:16384
    ds_read_b64_tr_b16 v[138:139], v24 offset:17408
    v_cvt_pk_bf16_f32 v35, v42, v42
    v_cndmask_b32 v34, v35, v41, vcc
    v_mfma_f32_32x32x16_bf16 v[200:215], a[24:27], v[244:247], v[200:215]
    ds_read_b128 v[240:243], v44 offset:38912
    buffer_load_dwordx4 v29, s[20:23], s58 offen offset:1024 sc1 lds
    ds_read_b64_tr_b16 v[140:141], v25 offset:16384
    ds_read_b64_tr_b16 v[142:143], v25 offset:17408
    s_waitcnt lgkmcnt(6)
    v_mfma_f32_32x32x16_bf16 v[200:215], a[32:35], v[232:235], v[200:215]
    ds_read_b128 v[244:247], v44 offset:39936
    ds_read_b64_tr_b16 v[144:145], v24 offset:18432
    ds_read_b64_tr_b16 v[146:147], v24 offset:19456
    v_and_b32 v35, 0xffff0000, v35
    v_sub_f32 v42, v42, v35
    v_cvt_pk_bf16_f32 v42, v51, v42
    s_waitcnt lgkmcnt(8)
    v_mfma_f32_32x32x16_bf16 v[200:215], a[40:43], v[236:239], v[200:215]
    ds_read_b128 v[232:235], v44 offset:40960
    buffer_load_dwordx4 v30, s[20:23], s58 offen offset:2048 sc1 lds
    ds_read_b64_tr_b16 v[148:149], v25 offset:18432
    ds_read_b64_tr_b16 v[150:151], v25 offset:19456
    s_waitcnt lgkmcnt(8)
    v_mfma_f32_32x32x16_bf16 v[200:215], a[48:51], v[240:243], v[200:215]
    ds_read_b128 v[236:239], v44 offset:41984
    s_waitcnt vmcnt(13)
    ds_read_b64_tr_b16 v[152:153], v24 offset:32768
    ds_read_b64_tr_b16 v[154:155], v24 offset:33792
    v_cndmask_b32 v35, 0, v42, vcc
    s_waitcnt lgkmcnt(8)
    v_mfma_f32_32x32x16_bf16 v[200:215], a[56:59], v[244:247], v[200:215]
    ds_read_b128 v[240:243], v44 offset:43008
    buffer_load_dwordx4 v31, s[20:23], s58 offen offset:3072 sc1 lds
    ds_read_b64_tr_b16 v[156:157], v25 offset:32768
    ds_read_b64_tr_b16 v[158:159], v25 offset:33792
    s_waitcnt lgkmcnt(8)
    v_mfma_f32_32x32x16_bf16 v[200:215], a[64:67], v[232:235], v[200:215]
    ds_read_b128 v[244:247], v44 offset:44032
    ds_read_b64_tr_b16 v[160:161], v24 offset:34816
    ds_read_b64_tr_b16 v[162:163], v24 offset:35840
    v_rcp_f32_e64 v252, v71
    v_mul_f32 v248, 0xc0135761, v71
    s_waitcnt lgkmcnt(8)
    v_mfma_f32_32x32x16_bf16 v[200:215], a[72:75], v[236:239], v[200:215]
    ds_read_b128 v[232:235], v44 offset:45056
    s_add_u32 m0, s47, 16384
    s_add_u32 s58, s55, 65536
    buffer_load_dwordx4 v28, s[20:23], s58 offen offset:0 sc1 lds
    v_mul_f32_e64 v43, v71, v71
    s_waitcnt lgkmcnt(6)
    v_mfma_f32_32x32x16_bf16 v[200:215], a[80:83], v[240:243], v[200:215]
    ds_read_b128 v[236:239], v44 offset:46080
    ds_read_b64_tr_b16 v[164:165], v25 offset:34816
    ds_read_b64_tr_b16 v[166:167], v25 offset:35840
    v_mul_f32_e64 v43, v43, v71
    v_mul_f32 v250, 0xbdd2d3e8, v43
    s_add_u32 s62, s62, 114688
    s_waitcnt lgkmcnt(6)
    v_mfma_f32_32x32x16_bf16 v[200:215], a[88:91], v[244:247], v[200:215]
    ds_read_b128 v[240:243], v44 offset:47104
    buffer_load_dwordx4 v29, s[20:23], s58 offen offset:1024 sc1 lds
    v_mul_u32_u24 v2, 2304, v47
    v_lshl_add_u32 v2, v48, 4, v2
    s_mul_i32 s41, s36, s57
    s_and_b32 s41, s41, 31
    s_waitcnt lgkmcnt(4)
    v_mfma_f32_32x32x16_bf16 v[200:215], a[96:99], v[232:235], v[200:215]
    ds_read_b128 v[244:247], v44 offset:48128
    s_waitcnt vmcnt(12)
    ds_read_b64_tr_b16 a[128:129], v24 offset:49152
    ds_read_b64_tr_b16 a[130:131], v24 offset:50176
    s_mul_i32 s41, s41, 73728
    s_mul_i32 s42, s38, 18432
    s_waitcnt lgkmcnt(6)
    v_mfma_f32_32x32x16_bf16 v[200:215], a[104:107], v[236:239], v[200:215]
    ds_read_b128 v[232:235], v44 offset:49152
    buffer_load_dwordx4 v30, s[20:23], s58 offen offset:2048 sc1 lds
    ds_read_b64_tr_b16 a[132:133], v25 offset:49152
    ds_read_b64_tr_b16 a[134:135], v25 offset:50176
    s_waitcnt lgkmcnt(6)
    v_mfma_f32_32x32x16_bf16 v[200:215], a[112:115], v[240:243], v[200:215]
    ds_read_b128 v[236:239], v44 offset:50176
    ds_read_b64_tr_b16 a[136:137], v24 offset:51200
    ds_read_b64_tr_b16 a[138:139], v24 offset:52224
    s_add_u32 s41, s41, s42
    s_lshl_b32 s42, s37, 9
    s_mul_i32 s42, s42, s57
    s_waitcnt lgkmcnt(8)
    v_mfma_f32_32x32x16_bf16 v[200:215], a[120:123], v[244:247], v[200:215]
    ds_read_b128 v[240:243], v44 offset:51200
    buffer_load_dwordx4 v31, s[20:23], s58 offen offset:3072 sc1 lds
    ds_read_b64_tr_b16 a[140:141], v25 offset:51200
    ds_read_b64_tr_b16 a[142:143], v25 offset:52224
    s_waitcnt lgkmcnt(8)
    v_mfma_f32_32x32x16_bf16 v[200:215], a[4:7], v[232:235], v[200:215]
    ds_read_b128 v[244:247], v44 offset:52224
    s_waitcnt vmcnt(10)
    ds_read_b64_tr_b16 a[144:145], v26 offset:0
    ds_read_b64_tr_b16 a[146:147], v26 offset:1024
    s_add_u32 s41, s41, s42
    s_and_b32 s42, s57, 3592
    s_waitcnt lgkmcnt(8)
    v_mfma_f32_32x32x16_bf16 v[200:215], a[12:15], v[236:239], v[200:215]
    ds_read_b128 v[232:235], v44 offset:53248
    s_add_u32 m0, s47, 32768
    s_add_u32 s58, s55, 98304
    buffer_load_dwordx4 v28, s[20:23], s58 offen offset:0 sc1 lds
    s_add_u32 s45, s41, s42
    s_waitcnt vmcnt(9)
    s_barrier
    buffer_atomic_add v40, v39, s[28:31], s56 offen offset:64 sc1
    v_lshlrev_b32_e64 v12, 7, v46
    v_add_u32 v12, 32768, v12
    buffer_load_dword v13, v12, s[28:31], 0 offen sc1
    s_waitcnt lgkmcnt(6)
    v_mfma_f32_32x32x16_bf16 v[200:215], a[20:23], v[240:243], v[200:215]
    ds_read_b128 v[236:239], v44 offset:54272
    buffer_load_dwordx4 v29, s[20:23], s58 offen offset:1024 sc1 lds
    ds_read_b64_tr_b16 a[148:149], v27 offset:0
    ds_read_b64_tr_b16 a[150:151], v27 offset:1024
    s_waitcnt lgkmcnt(6)
    v_mfma_f32_32x32x16_bf16 v[200:215], a[28:31], v[244:247], v[200:215]
    ds_read_b128 v[240:243], v44 offset:55296
    ds_read_b64_tr_b16 a[152:153], v26 offset:2048
    ds_read_b64_tr_b16 a[154:155], v26 offset:3072
    s_add_u32 s41, s37, 1
    s_lshr_b32 s41, s41, 3
    s_sub_u32 s41, 7, s41
    s_waitcnt lgkmcnt(6)
    v_mfma_f32_32x32x16_bf16 v[200:215], a[36:39], v[232:235], v[200:215]
    ds_read_b128 v[244:247], v44 offset:56320
    buffer_load_dwordx4 v30, s[20:23], s58 offen offset:2048 sc1 lds
    ds_read_b64_tr_b16 a[156:157], v27 offset:2048
    ds_read_b64_tr_b16 a[158:159], v27 offset:3072
    s_waitcnt lgkmcnt(8)
    v_mfma_f32_32x32x16_bf16 v[200:215], a[44:47], v[236:239], v[200:215]
    ds_read_b128 v[232:235], v44 offset:57344
    s_mul_i32 s41, s41, 12288
    s_add_u32 s46, s53, s41
    s_add_u32 s43, s53, 98304
    s_add_u32 s44, s43, 2048
    v_lshrrev_b32 v41, 1, v46
    v_lshlrev_b32 v41, 10, v41
    v_and_b32 v42, 1, v0
    s_waitcnt lgkmcnt(6)
    v_mfma_f32_32x32x16_bf16 v[200:215], a[52:55], v[240:243], v[200:215]
    ds_read_b128 v[236:239], v44 offset:58368
    buffer_load_dwordx4 v31, s[20:23], s58 offen offset:3072 sc1 lds
    v_lshl_add_u32 v41, v42, 3, v41
    v_lshl_add_u32 v42, v45, 4, v41
    s_lshl_b32 s41, s38, 7
    s_lshl_b32 s42, s37, 12
    s_waitcnt lgkmcnt(4)
    v_mfma_f32_32x32x16_bf16 v[200:215], a[60:63], v[244:247], v[200:215]
    ds_read_b128 v[240:243], v44 offset:59392
    s_add_u32 s42, s42, s41
    s_add_u32 s41, s41, 155648
    v_add_u32 v41, s42, v42
    v_add_u32 v42, s41, v42
    ds_read_b64 v[52:53], v41 offset:0
    s_waitcnt lgkmcnt(3)
    v_mfma_f32_32x32x16_bf16 v[200:215], a[68:71], v[232:235], v[200:215]
    ds_read_b128 v[244:247], v44 offset:60416
    s_add_u32 m0, s47, 49152
    s_add_u32 s58, s55, 131072
    buffer_load_dwordx4 v28, s[20:23], s58 offen offset:0 sc1 lds
    s_waitcnt lgkmcnt(3)
    v_mfma_f32_32x32x16_bf16 v[200:215], a[76:79], v[236:239], v[200:215]
    ds_read_b128 v[232:235], v44 offset:61440
    ds_read_b64 v[60:61], v42 offset:0
    ds_read_b64 v[54:55], v41 offset:512
    ds_read_b64 v[62:63], v42 offset:512
    s_waitcnt lgkmcnt(6)
    v_mfma_f32_32x32x16_bf16 v[200:215], a[84:87], v[240:243], v[200:215]
    ds_read_b128 v[236:239], v44 offset:62464
    buffer_load_dwordx4 v29, s[20:23], s58 offen offset:1024 sc1 lds
    ds_read_b64 v[56:57], v41 offset:32768
    ds_read_b64 v[64:65], v42 offset:4096
    s_waitcnt lgkmcnt(7)
    v_mfma_f32_32x32x16_bf16 v[200:215], a[92:95], v[244:247], v[200:215]
    ds_read_b128 v[240:243], v44 offset:63488
    s_waitcnt vmcnt(12)
    ds_read_b64_tr_b16 a[160:161], v24 offset:0
    ds_read_b64_tr_b16 a[162:163], v24 offset:1024
    ds_read_b64 v[58:59], v41 offset:33280
    s_waitcnt lgkmcnt(10)
    v_mfma_f32_32x32x16_bf16 v[200:215], a[100:103], v[232:235], v[200:215]
    ds_read_b128 v[244:247], v44 offset:64512
    buffer_load_dwordx4 v30, s[20:23], s58 offen offset:2048 sc1 lds
    ds_read_b64_tr_b16 a[164:165], v25 offset:0
    ds_read_b64_tr_b16 a[166:167], v25 offset:1024
    s_waitcnt lgkmcnt(9)
    v_mfma_f32_32x32x16_bf16 v[200:215], a[108:111], v[236:239], v[200:215]
    ds_read_b64_tr_b16 a[168:169], v24 offset:2048
    ds_read_b64_tr_b16 a[170:171], v24 offset:3072
    ds_read_b64_tr_b16 a[172:173], v25 offset:2048
    ds_read_b64_tr_b16 a[174:175], v25 offset:3072
    s_waitcnt lgkmcnt(10)
    v_mfma_f32_32x32x16_bf16 v[200:215], a[116:119], v[240:243], v[200:215]
    buffer_load_dwordx4 v31, s[20:23], s58 offen offset:3072 sc1 lds
    ds_read_b64 v[66:67], v42 offset:4608
    s_waitcnt lgkmcnt(7)
    v_mfma_f32_32x32x16_bf16 v[200:215], a[124:127], v[244:247], v[200:215]
    v_mfma_f32_32x32x16_bf16 v[200:215], v[20:23], v[34:37], v[200:215]
    s_add_u32 m0, s47, 65536
    s_add_u32 s58, s55, 163840
    buffer_load_dwordx4 v28, s[20:23], s58 offen offset:0 sc1 lds
    buffer_load_dwordx4 v29, s[20:23], s58 offen offset:1024 sc1 lds
    buffer_load_dwordx4 v30, s[20:23], s58 offen offset:2048 sc1 lds
    buffer_load_dwordx4 v31, s[20:23], s58 offen offset:3072 sc1 lds
    s_add_u32 m0, s47, 0
    s_add_u32 s58, s51, 0
    s_waitcnt lgkmcnt(1)
    buffer_load_dwordx4 v28, s[20:23], s58 offen offset:0 sc1 lds
    s_waitcnt vmcnt(15)
    ds_read_b64_tr_b16 a[176:177], v24 offset:16384
    ds_read_b64_tr_b16 a[178:179], v24 offset:17408
    buffer_load_dwordx4 v29, s[20:23], s58 offen offset:1024 sc1 lds
    s_load_dword s100, s[0:1], 64 glc
    v_accvgpr_write_b32 a0, v168
    v_accvgpr_write_b32 a1, v169
    v_accvgpr_write_b32 a2, v170
    v_accvgpr_write_b32 a3, v171
    v_accvgpr_write_b32 a4, v176
    v_accvgpr_write_b32 a5, v177
    v_accvgpr_write_b32 a6, v178
    v_accvgpr_write_b32 a7, v179
    v_pk_mul_f32 v[4:5], v[200:201], v[200:201]
    v_pk_mul_f32 v[6:7], v[202:203], v[202:203]
    v_pk_mul_f32 v[8:9], v[204:205], v[204:205]
    v_pk_mul_f32 v[10:11], v[206:207], v[206:207]
    v_pk_fma_f32 v[4:5], v[4:5], v[250:251], v[248:249] op_sel_hi:[1,0,0]
    v_pk_fma_f32 v[6:7], v[6:7], v[250:251], v[248:249] op_sel_hi:[1,0,0]
    v_pk_fma_f32 v[8:9], v[8:9], v[250:251], v[248:249] op_sel_hi:[1,0,0]
    v_pk_fma_f32 v[10:11], v[10:11], v[250:251], v[248:249] op_sel_hi:[1,0,0]
    v_pk_mul_f32 v[4:5], v[4:5], v[200:201]
    v_pk_mul_f32 v[6:7], v[6:7], v[202:203]
    v_pk_mul_f32 v[8:9], v[8:9], v[204:205]
    v_pk_mul_f32 v[10:11], v[10:11], v[206:207]
    v_exp_f32 v4, v4
    v_exp_f32 v5, v5
    v_exp_f32 v6, v6
    v_exp_f32 v7, v7
    v_exp_f32 v8, v8
    v_exp_f32 v9, v9
    v_exp_f32 v10, v10
    v_exp_f32_e64 v11, v11
    v_pk_fma_f32 v[4:5], v[4:5], v[252:253], v[252:253] op_sel_hi:[1,0,0]
    v_pk_fma_f32 v[6:7], v[6:7], v[252:253], v[252:253] op_sel_hi:[1,0,0]
    v_pk_fma_f32 v[8:9], v[8:9], v[252:253], v[252:253] op_sel_hi:[1,0,0]
    v_pk_fma_f32 v[10:11], v[10:11], v[252:253], v[252:253] op_sel_hi:[1,0,0]
    v_rcp_f32 v4, v4
    v_rcp_f32 v5, v5
    buffer_load_dwordx4 v30, s[20:23], s58 offen offset:2048 sc1 lds
    v_rcp_f32 v6, v6
    v_rcp_f32 v7, v7
    v_rcp_f32 v8, v8
    v_rcp_f32 v9, v9
    v_rcp_f32 v10, v10
    v_rcp_f32 v11, v11
    v_pk_mul_f32 v[4:5], v[4:5], v[200:201]
    v_pk_mul_f32 v[6:7], v[6:7], v[202:203]
    v_pk_mul_f32 v[8:9], v[8:9], v[204:205]
    v_pk_mul_f32 v[10:11], v[10:11], v[206:207]
    v_cvt_pk_bf16_f32 v200, v4, v5
    v_cvt_pk_bf16_f32 v201, v6, v7
    v_cvt_pk_bf16_f32 v202, v8, v9
    v_cvt_pk_bf16_f32 v203, v10, v11
    buffer_store_dwordx4 v[200:203], v44, s[28:31], s62 offen offset:0 sc1
    v_pk_mul_f32 v[4:5], v[208:209], v[208:209]
    v_pk_mul_f32 v[6:7], v[210:211], v[210:211]
    v_pk_mul_f32 v[8:9], v[212:213], v[212:213]
    v_pk_mul_f32 v[10:11], v[214:215], v[214:215]
    v_pk_fma_f32 v[4:5], v[4:5], v[250:251], v[248:249] op_sel_hi:[1,0,0]
    v_pk_fma_f32 v[6:7], v[6:7], v[250:251], v[248:249] op_sel_hi:[1,0,0]
    v_pk_fma_f32 v[8:9], v[8:9], v[250:251], v[248:249] op_sel_hi:[1,0,0]
    v_pk_fma_f32 v[10:11], v[10:11], v[250:251], v[248:249] op_sel_hi:[1,0,0]
    v_pk_mul_f32 v[4:5], v[4:5], v[208:209]
    v_pk_mul_f32 v[6:7], v[6:7], v[210:211]
    v_pk_mul_f32 v[8:9], v[8:9], v[212:213]
    v_pk_mul_f32 v[10:11], v[10:11], v[214:215]
    v_exp_f32_e64 v4, v4
    v_exp_f32 v5, v5
    s_waitcnt vmcnt(15)
    v_cmp_gt_u32 vcc, 32, v13
    s_cbranch_vccz Ld_1013
    s_mov_b32 s40, 0
Lp_1012:
    s_sleep 4
    buffer_load_dword v13, v12, s[28:31], 0 offen sc1
    s_add_u32 s40, s40, 1
    s_waitcnt vmcnt(0)
    s_cmp_gt_u32 s40, 100000
    s_cbranch_scc1 Ld_1013
    v_cmp_gt_u32 vcc, 32, v13
    s_cbranch_vccnz Lp_1012
Ld_1013:
    s_mov_b32 s40, 0
    s_branch Lc_1016
Lp_1014:
    s_load_dword s100, s[0:1], 64 glc
Lc_1016:
    s_waitcnt lgkmcnt(0)
    s_cmp_ge_u32 s100, 8
    s_cbranch_scc1 Ld_1015
    s_add_u32 s40, s40, 1
    s_cmp_lt_u32 s40, 200000
    s_cbranch_scc1 Lp_1014
Ld_1015:
    s_barrier
    ds_read_b64_tr_b16 a[180:181], v25 offset:16384
    ds_read_b64_tr_b16 a[182:183], v25 offset:17408
    buffer_load_dwordx4 v31, s[20:23], s58 offen offset:3072 sc1 lds
    v_exp_f32 v6, v6
    v_exp_f32 v7, v7
    v_exp_f32 v8, v8
    v_exp_f32 v9, v9
    v_exp_f32 v10, v10
    ds_read_b64_tr_b16 a[184:185], v24 offset:18432
    ds_read_b64_tr_b16 a[186:187], v24 offset:19456
    s_cmp_le_u32 s101, 0
    s_cselect_b32 s58, s44, s43
    s_add_u32 s58, s58, 0
    buffer_load_dwordx4 a[8:11], v44, s[28:31], s58 offen offset:0 sc1
    v_exp_f32 v11, v11
    v_pk_fma_f32 v[4:5], v[4:5], v[252:253], v[252:253] op_sel_hi:[1,0,0]
    v_pk_fma_f32 v[6:7], v[6:7], v[252:253], v[252:253] op_sel_hi:[1,0,0]
    v_pk_fma_f32 v[8:9], v[8:9], v[252:253], v[252:253] op_sel_hi:[1,0,0]
    ds_read_b64_tr_b16 a[188:189], v25 offset:18432
    ds_read_b64_tr_b16 a[190:191], v25 offset:19456
    buffer_load_dwordx4 a[12:15], v44, s[28:31], s58 offen offset:1024 sc1
    v_pk_fma_f32 v[10:11], v[10:11], v[252:253], v[252:253] op_sel_hi:[1,0,0]
    v_rcp_f32 v4, v4
    v_rcp_f32 v5, v5
    v_rcp_f32_e64 v6, v6
    v_rcp_f32 v7, v7
    s_waitcnt vmcnt(15)
    ds_read_b64_tr_b16 a[192:193], v24 offset:32768
    ds_read_b64_tr_b16 a[194:195], v24 offset:33792
    s_cmp_le_u32 s101, 1
    s_cselect_b32 s58, s44, s43
    s_add_u32 s58, s58, 2048
    buffer_load_dwordx4 a[16:19], v44, s[28:31], s58 offen offset:0 sc1
    v_rcp_f32 v8, v8
    v_rcp_f32 v9, v9
    v_rcp_f32_e64 v10, v10
    ds_read_b64_tr_b16 a[196:197], v25 offset:32768
    ds_read_b64_tr_b16 a[198:199], v25 offset:33792
    buffer_load_dwordx4 a[20:23], v44, s[28:31], s58 offen offset:1024 sc1
    v_rcp_f32_e64 v11, v11
    v_pk_mul_f32 v[4:5], v[4:5], v[208:209]
    v_pk_mul_f32 v[6:7], v[6:7], v[210:211]
    v_pk_mul_f32 v[8:9], v[8:9], v[212:213]
    v_pk_mul_f32 v[10:11], v[10:11], v[214:215]
    v_cvt_pk_bf16_f32 v208, v4, v5
    v_cvt_pk_bf16_f32 v209, v6, v7
    ds_read_b64_tr_b16 a[200:201], v24 offset:34816
    ds_read_b64_tr_b16 a[202:203], v24 offset:35840
    s_cmp_le_u32 s101, 2
    s_cselect_b32 s58, s44, s43
    s_add_u32 s58, s58, 4096
    buffer_load_dwordx4 a[24:27], v44, s[28:31], s58 offen offset:0 sc1
    v_cvt_pk_bf16_f32 v210, v8, v9
    v_cvt_pk_bf16_f32 v211, v10, v11
    buffer_store_dwordx4 v[208:211], v44, s[28:31], s62 offen offset:1024 sc1
    ds_read_b64_tr_b16 a[204:205], v25 offset:34816
    ds_read_b64_tr_b16 a[206:207], v25 offset:35840
    buffer_load_dwordx4 a[28:31], v44, s[28:31], s58 offen offset:1024 sc1
    s_waitcnt vmcnt(16)
    ds_read_b64_tr_b16 a[208:209], v24 offset:49152
    ds_read_b64_tr_b16 a[210:211], v24 offset:50176
    s_cmp_le_u32 s101, 3
    s_cselect_b32 s58, s44, s43
    s_add_u32 s58, s58, 6144
    buffer_load_dwordx4 a[32:35], v44, s[28:31], s58 offen offset:0 sc1
    v_accvgpr_write_b32 a112, v200
    v_accvgpr_write_b32 a113, v201
    v_accvgpr_write_b32 a114, v202
    v_accvgpr_write_b32 a115, v203
    v_accvgpr_write_b32 a116, v208
    v_accvgpr_write_b32 a117, v209
    v_accvgpr_write_b32 a118, v210
    v_accvgpr_write_b32 a119, v211
    s_lshl_b32 s41, s63, 5
    s_add_u32 s41, s41, s36
    ds_read_b64_tr_b16 a[212:213], v25 offset:49152
    ds_read_b64_tr_b16 a[214:215], v25 offset:50176
    buffer_load_dwordx4 a[36:39], v44, s[28:31], s58 offen offset:1024 sc1
    v_lshl_add_u32 v41, v48, 6, s41
    v_mul_i32_i24 v41, s57, v41
    v_cvt_f32_i32_e64 v41, v41
    v_mul_f32 v41, 0x3a000000, v41
    v_cvt_f32_u32 v43, v47
    v_mul_f32 v43, 2.0, v43
    v_mul_f32 v43, v43, v41
    v_mul_f32 v68, 4.0, v41
    v_cos_f32_e64 v68, v68
    ds_read_b64_tr_b16 a[216:217], v24 offset:51200
    ds_read_b64_tr_b16 a[218:219], v24 offset:52224
    s_cmp_le_u32 s101, 4
    s_cselect_b32 s58, s44, s43
    s_add_u32 s58, s58, 8192
    buffer_load_dwordx4 a[40:43], v44, s[28:31], s58 offen offset:0 sc1
    v_fmamk_f32 v20, v41, 0x00000000, v43
    v_fmamk_f32 v21, v41, 0x42000000, v43
    v_fmamk_f32 v22, v41, 0x3f800000, v43
    v_fmamk_f32 v23, v41, 0x42040000, v43
    v_cos_f32_e64 v232, v20
    ds_read_b64_tr_b16 a[220:221], v25 offset:51200
    ds_read_b64_tr_b16 a[222:223], v25 offset:52224
    buffer_load_dwordx4 a[44:47], v44, s[28:31], s58 offen offset:1024 sc1
    v_sin_f32 v233, v20
    v_cos_f32 v234, v21
    v_sin_f32_e64 v235, v21
    v_cos_f32 v236, v22
    s_waitcnt vmcnt(16)
    ds_read_b64_tr_b16 a[224:225], v26 offset:0
    ds_read_b64_tr_b16 a[226:227], v26 offset:1024
    s_cmp_le_u32 s101, 5
    s_cselect_b32 s58, s44, s43
    s_add_u32 s58, s58, 10240
    buffer_load_dwordx4 a[48:51], v44, s[28:31], s58 offen offset:0 sc1
    v_sin_f32 v237, v22
    v_cos_f32 v238, v23
    v_sin_f32_e64 v239, v23
    ds_read_b64_tr_b16 a[228:229], v27 offset:0
    ds_read_b64_tr_b16 a[230:231], v27 offset:1024
    buffer_load_dwordx4 a[52:55], v44, s[28:31], s58 offen offset:1024 sc1
    v_fmamk_f32 v20, v41, 0x40800000, v43
    v_fmamk_f32 v21, v41, 0x42100000, v43
    v_fmamk_f32 v22, v41, 0x40a00000, v43
    v_fmamk_f32 v23, v41, 0x42140000, v43
    v_cos_f32 v240, v20
    v_sin_f32 v241, v20
    ds_read_b64_tr_b16 a[232:233], v26 offset:2048
    ds_read_b64_tr_b16 a[234:235], v26 offset:3072
    s_cmp_le_u32 s101, 6
    s_cselect_b32 s58, s44, s43
    s_add_u32 s58, s58, 12288
    buffer_load_dwordx4 a[56:59], v44, s[28:31], s58 offen offset:0 sc1
    v_cos_f32 v242, v21
    v_sin_f32 v243, v21
    v_cos_f32_e64 v244, v22
    ds_read_b64_tr_b16 a[236:237], v27 offset:2048
    ds_read_b64_tr_b16 a[238:239], v27 offset:3072
    buffer_load_dwordx4 a[60:63], v44, s[28:31], s58 offen offset:1024 sc1
    v_sin_f32 v245, v22
    v_cos_f32 v246, v23
    v_sin_f32 v247, v23
    v_add_f32 v68, v68, v68
    v_cvt_pk_bf16_f32 v200, v232, v233
    s_waitcnt vmcnt(15)
    ds_read_b64_tr_b16 a[240:241], v24 offset:0
    ds_read_b64_tr_b16 a[242:243], v24 offset:1024
    s_add_u32 s58, s46, 0
    buffer_load_dwordx4 a[64:67], v44, s[28:31], s58 offen offset:0 sc1
    v_cvt_pk_bf16_f32 v201, v234, v235
    v_cvt_pk_bf16_f32 v202, v236, v237
    v_cvt_pk_bf16_f32 v203, v238, v239
    v_fma_f32 v232, v240, v68, -v232
    v_fma_f32 v233, v241, v68, -v233
    v_fma_f32 v234, v242, v68, -v234
    v_fma_f32 v235, v243, v68, -v235
    ds_read_b64_tr_b16 a[244:245], v25 offset:0
    ds_read_b64_tr_b16 a[246:247], v25 offset:1024
    buffer_load_dwordx4 a[68:71], v44, s[28:31], s58 offen offset:1024 sc1
    v_fma_f32 v236, v244, v68, -v236
    v_fma_f32 v237, v245, v68, -v237
    v_fma_f32 v238, v246, v68, -v238
    v_fma_f32 v239, v247, v68, -v239
    v_cvt_pk_bf16_f32 v204, v240, v241
    v_cvt_pk_bf16_f32 v205, v242, v243
    v_cvt_pk_bf16_f32 v206, v244, v245
    v_cvt_pk_bf16_f32 v207, v246, v247
    ds_read_b64_tr_b16 a[248:249], v24 offset:2048
    ds_read_b64_tr_b16 a[250:251], v24 offset:3072
    buffer_load_dwordx4 a[72:75], v44, s[28:31], s58 offen offset:2048 sc1
    v_fma_f32 v240, v232, v68, -v240
    v_fma_f32 v241, v233, v68, -v241
    v_fma_f32 v242, v234, v68, -v242
    v_fma_f32 v243, v235, v68, -v243
    v_fma_f32 v244, v236, v68, -v244
    v_fma_f32 v245, v237, v68, -v245
    v_fma_f32 v246, v238, v68, -v246
    v_fma_f32 v247, v239, v68, -v247
    ds_read_b64_tr_b16 a[252:253], v25 offset:2048
    ds_read_b64_tr_b16 a[254:255], v25 offset:3072
    buffer_load_dwordx4 a[76:79], v44, s[28:31], s58 offen offset:3072 sc1
    v_cvt_pk_bf16_f32 v208, v232, v233
    v_cvt_pk_bf16_f32 v209, v234, v235
    v_cvt_pk_bf16_f32 v210, v236, v237
    v_cvt_pk_bf16_f32 v211, v238, v239
    v_fma_f32 v232, v240, v68, -v232
    v_fma_f32 v233, v241, v68, -v233
    v_fma_f32 v234, v242, v68, -v234
    v_fma_f32 v235, v243, v68, -v235
    s_add_u32 s58, s46, 4096
    buffer_load_dwordx4 a[80:83], v44, s[28:31], s58 offen offset:0 sc1
    v_fma_f32 v236, v244, v68, -v236
    v_fma_f32 v237, v245, v68, -v237
    v_fma_f32 v238, v246, v68, -v238
    v_fma_f32 v239, v247, v68, -v239
    v_cvt_pk_bf16_f32 v212, v240, v241
    v_cvt_pk_bf16_f32 v213, v242, v243
    v_cvt_pk_bf16_f32 v214, v244, v245
    v_cvt_pk_bf16_f32 v215, v246, v247
    v_fma_f32 v240, v232, v68, -v240
    v_fma_f32 v241, v233, v68, -v241
    v_fma_f32 v242, v234, v68, -v242
    v_fma_f32 v243, v235, v68, -v243
    buffer_load_dwordx4 a[84:87], v44, s[28:31], s58 offen offset:1024 sc1
    v_fma_f32 v244, v236, v68, -v244
    v_fma_f32 v245, v237, v68, -v245
    v_fma_f32 v246, v238, v68, -v246
    v_fma_f32 v247, v239, v68, -v247
    v_cvt_pk_bf16_f32 v216, v232, v233
    v_cvt_pk_bf16_f32 v217, v234, v235
    v_cvt_pk_bf16_f32 v218, v236, v237
    v_cvt_pk_bf16_f32 v219, v238, v239
    v_fma_f32 v232, v240, v68, -v232
    v_fma_f32 v233, v241, v68, -v233
    v_fma_f32 v234, v242, v68, -v234
    v_fma_f32 v235, v243, v68, -v235
    buffer_load_dwordx4 a[88:91], v44, s[28:31], s58 offen offset:2048 sc1
    v_fma_f32 v236, v244, v68, -v236
    v_fma_f32 v237, v245, v68, -v237
    v_fma_f32 v238, v246, v68, -v238
    v_fma_f32 v239, v247, v68, -v239
    v_cvt_pk_bf16_f32 v220, v240, v241
    v_cvt_pk_bf16_f32 v221, v242, v243
    v_cvt_pk_bf16_f32 v222, v244, v245
    v_cvt_pk_bf16_f32 v223, v246, v247
    v_fma_f32 v240, v232, v68, -v240
    v_fma_f32 v241, v233, v68, -v241
    v_fma_f32 v242, v234, v68, -v242
    v_fma_f32 v243, v235, v68, -v243
    buffer_load_dwordx4 a[92:95], v44, s[28:31], s58 offen offset:3072 sc1
    v_fma_f32 v244, v236, v68, -v244
    v_fma_f32 v245, v237, v68, -v245
    v_fma_f32 v246, v238, v68, -v246
    v_fma_f32 v247, v239, v68, -v247
    v_cvt_pk_bf16_f32 v224, v232, v233
    v_cvt_pk_bf16_f32 v225, v234, v235
    v_cvt_pk_bf16_f32 v226, v236, v237
    v_cvt_pk_bf16_f32 v227, v238, v239
    v_cvt_pk_bf16_f32 v228, v240, v241
    v_cvt_pk_bf16_f32 v229, v242, v243
    v_cvt_pk_bf16_f32 v230, v244, v245
    v_cvt_pk_bf16_f32 v231, v246, v247
    s_add_u32 s58, s46, 8192
    buffer_load_dwordx4 a[96:99], v44, s[28:31], s58 offen offset:0 sc1
    v_lshlrev_b32_e64 v1, 16, v45
    v_lshl_add_u32 v1, v46, 4, v1
    s_lshl_b32 s54, s38, 19
    s_lshl_b32 s41, s36, 10
    s_add_u32 s54, s54, s41
    s_lshl_b32 s41, s37, 7
    s_add_u32 s54, s54, s41
    s_add_u32 s59, s54, 32768
    s_lshl_b32 s41, s3, 5
    v_add_u32_e64 v41, s41, v48
    v_mul_i32_i24 v41, s57, v41
    s_ashr_i32 s41, s57, 1
    buffer_load_dwordx4 a[100:103], v44, s[28:31], s58 offen offset:1024 sc1
    s_and_b32 s41, s41, 63
    s_add_u32 s41, s41, 10240
    v_add_lshl_u32 v41, v41, s41, 3
    v_lshl_add_u32 v41, v47, 10, v41
    s_lshl_b32 s41, s38, 13
    v_xor_b32_e64 v42, v47, v46
    v_lshl_add_u32 v42, v42, 4, s41
    v_lshl_add_u32 v3, v48, 8, v42
    v_xor_b32 v36, 32, v3
    v_xor_b32 v37, 64, v3
    v_xor_b32 v49, 96, v3
    s_lshl_b32 s42, s63, 13
    s_sub_u32 s42, s42, s41
    buffer_load_dwordx4 a[104:107], v44, s[28:31], s58 offen offset:2048 sc1
    s_lshl_b32 s41, s3, 7
    s_add_u32 s42, s42, s41
    s_add_u32 s62, s42, 32768
    s_sub_u32 s48, 65536, s62
    s_lshl_b32 s41, s38, 11
    v_lshlrev_b32 v43, 1, v46
    v_xor_b32_e64 v43, v43, v45
    v_lshl_add_u32 v43, v43, 4, s41
    v_lshl_add_u32 v50, v45, 8, v43
    v_xor_b32 v51, 16, v50
    s_waitcnt vmcnt(25)
    v_mfma_f32_32x32x16_bf16 v[168:183], v[72:75], a[8:11], 0
    buffer_load_dwordx4 a[108:111], v44, s[28:31], s58 offen offset:3072 sc1
    v_mfma_f32_32x32x16_bf16 v[184:199], v[76:79], a[8:11], 0
    s_waitcnt vmcnt(25)
    v_mfma_f32_32x32x16_bf16 v[168:183], v[80:83], a[12:15], v[168:183]
    s_add_u32 m0, s47, 16384
    s_add_u32 s58, s45, 5505024
    s_waitcnt lgkmcnt(15)
    buffer_load_dwordx4 v2, s[28:31], s58 offen sc1 lds
    v_mfma_f32_32x32x16_bf16 v[184:199], v[84:87], a[12:15], v[184:199]
    s_waitcnt vmcnt(25)
    v_mfma_f32_32x32x16_bf16 v[168:183], v[88:91], a[16:19], v[168:183]
    s_add_u32 m0, s47, 17408
    s_add_u32 s58, s45, 5509632
    buffer_load_dwordx4 v2, s[28:31], s58 offen sc1 lds
    v_mfma_f32_32x32x16_bf16 v[184:199], v[92:95], a[16:19], v[184:199]
    s_waitcnt vmcnt(25)
    v_mfma_f32_32x32x16_bf16 v[168:183], v[96:99], a[20:23], v[168:183]
    s_add_u32 m0, s47, 18432
    s_add_u32 s58, s45, 5514240
    buffer_load_dwordx4 v2, s[28:31], s58 offen sc1 lds
    v_mfma_f32_32x32x16_bf16 v[184:199], v[100:103], a[20:23], v[184:199]
    s_waitcnt vmcnt(25)
    v_mfma_f32_32x32x16_bf16 v[168:183], v[104:107], a[24:27], v[168:183]
    s_add_u32 m0, s47, 19456
    s_add_u32 s58, s45, 5518848
    buffer_load_dwordx4 v2, s[28:31], s58 offen sc1 lds
    v_mfma_f32_32x32x16_bf16 v[184:199], v[108:111], a[24:27], v[184:199]
    s_waitcnt vmcnt(24)
    v_mfma_f32_32x32x16_bf16 v[168:183], v[112:115], a[28:31], v[168:183]
    v_mfma_f32_32x32x16_bf16 v[184:199], v[116:119], a[28:31], v[184:199]
    s_waitcnt vmcnt(23)
    v_mfma_f32_32x32x16_bf16 v[168:183], v[120:123], a[32:35], v[168:183]
    v_mfma_f32_32x32x16_bf16 v[184:199], v[124:127], a[32:35], v[184:199]
    s_waitcnt vmcnt(22)
    v_mfma_f32_32x32x16_bf16 v[168:183], v[128:131], a[36:39], v[168:183]
    v_mfma_f32_32x32x16_bf16 v[184:199], v[132:135], a[36:39], v[184:199]
    s_waitcnt vmcnt(21)
    v_mfma_f32_32x32x16_bf16 v[168:183], v[136:139], a[40:43], v[168:183]
    v_mfma_f32_32x32x16_bf16 v[184:199], v[140:143], a[40:43], v[184:199]
    s_waitcnt vmcnt(20)
    v_mfma_f32_32x32x16_bf16 v[168:183], v[144:147], a[44:47], v[168:183]
    v_mfma_f32_32x32x16_bf16 v[184:199], v[148:151], a[44:47], v[184:199]
    s_waitcnt vmcnt(19)
    v_mfma_f32_32x32x16_bf16 v[168:183], v[152:155], a[48:51], v[168:183]
    v_mfma_f32_32x32x16_bf16 v[184:199], v[156:159], a[48:51], v[184:199]
    s_waitcnt vmcnt(18)
    v_mfma_f32_32x32x16_bf16 v[168:183], v[160:163], a[52:55], v[168:183]
    v_mfma_f32_32x32x16_bf16 v[184:199], v[164:167], a[52:55], v[184:199]
    s_waitcnt lgkmcnt(0)
    s_barrier
    buffer_atomic_add v40, v39, s[28:31], s56 offen offset:112 sc1
    s_waitcnt vmcnt(18)
    v_mfma_f32_32x32x16_bf16 v[168:183], a[128:131], a[56:59], v[168:183]
    v_mfma_f32_32x32x16_bf16 v[184:199], a[132:135], a[56:59], v[184:199]
    s_waitcnt vmcnt(17)
    v_mfma_f32_32x32x16_bf16 v[168:183], a[136:139], a[60:63], v[168:183]
    v_mfma_f32_32x32x16_bf16 v[184:199], a[140:143], a[60:63], v[184:199]
    s_waitcnt vmcnt(16)
    v_mfma_f32_32x32x16_bf16 v[168:183], a[144:147], a[64:67], v[168:183]
    v_mfma_f32_32x32x16_bf16 v[184:199], a[148:151], a[64:67], v[184:199]
    s_waitcnt vmcnt(15)
    v_mfma_f32_32x32x16_bf16 v[168:183], a[152:155], a[68:71], v[168:183]
    v_mfma_f32_32x32x16_bf16 v[184:199], a[156:159], a[68:71], v[184:199]
    s_waitcnt vmcnt(14)
    v_mfma_f32_32x32x16_bf16 v[168:183], a[160:163], a[72:75], v[168:183]
    v_mfma_f32_32x32x16_bf16 v[184:199], a[164:167], a[72:75], v[184:199]
    s_waitcnt vmcnt(13)
    v_mfma_f32_32x32x16_bf16 v[168:183], a[168:171], a[76:79], v[168:183]
    v_mfma_f32_32x32x16_bf16 v[184:199], a[172:175], a[76:79], v[184:199]
    s_waitcnt vmcnt(12)
    v_mfma_f32_32x32x16_bf16 v[168:183], a[176:179], a[80:83], v[168:183]
    v_mfma_f32_32x32x16_bf16 v[184:199], a[180:183], a[80:83], v[184:199]
    s_waitcnt vmcnt(11)
    v_mfma_f32_32x32x16_bf16 v[168:183], a[184:187], a[84:87], v[168:183]
    v_mfma_f32_32x32x16_bf16 v[184:199], a[188:191], a[84:87], v[184:199]
    s_waitcnt vmcnt(10)
    v_mfma_f32_32x32x16_bf16 v[168:183], a[192:195], a[88:91], v[168:183]
    v_mfma_f32_32x32x16_bf16 v[184:199], a[196:199], a[88:91], v[184:199]
    s_waitcnt vmcnt(9)
    v_mfma_f32_32x32x16_bf16 v[168:183], a[200:203], a[92:95], v[168:183]
    v_mfma_f32_32x32x16_bf16 v[184:199], a[204:207], a[92:95], v[184:199]
    s_waitcnt vmcnt(8)
    v_mfma_f32_32x32x16_bf16 v[168:183], a[208:211], a[96:99], v[168:183]
    v_mfma_f32_32x32x16_bf16 v[184:199], a[212:215], a[96:99], v[184:199]
    s_waitcnt vmcnt(7)
    v_mfma_f32_32x32x16_bf16 v[168:183], a[216:219], a[100:103], v[168:183]
    s_load_dword s100, s[0:1], 112 glc
    v_mfma_f32_32x32x16_bf16 v[184:199], a[220:223], a[100:103], v[184:199]
    s_waitcnt vmcnt(6)
    v_mfma_f32_32x32x16_bf16 v[168:183], a[224:227], a[104:107], v[168:183]
    v_mfma_f32_32x32x16_bf16 v[184:199], a[228:231], a[104:107], v[184:199]
    s_waitcnt vmcnt(5)
    v_mfma_f32_32x32x16_bf16 v[168:183], a[232:235], a[108:111], v[168:183]
    v_mfma_f32_32x32x16_bf16 v[184:199], a[236:239], a[108:111], v[184:199]
    s_mov_b32 s40, 0
    s_branch Lc_1019
Lp_1017:
    s_load_dword s100, s[0:1], 112 glc
Lc_1019:
    s_waitcnt lgkmcnt(0)
    s_cmp_ge_u32 s100, 8
    s_cbranch_scc1 Ld_1018
    s_add_u32 s40, s40, 1
    s_cmp_lt_u32 s40, 200000
    s_cbranch_scc1 Lp_1017
Ld_1018:
    s_waitcnt vmcnt(1)
    s_barrier
    s_cmp_le_u32 s101, 0
    s_cselect_b32 s58, s44, s43
    s_add_u32 s58, s58, 114688
    buffer_load_dwordx4 a[8:11], v44, s[28:31], s58 offen offset:0 sc1
    buffer_load_dwordx4 a[12:15], v44, s[28:31], s58 offen offset:1024 sc1
    s_cmp_le_u32 s101, 1
    s_cselect_b32 s58, s44, s43
    s_add_u32 s58, s58, 116736
    buffer_load_dwordx4 a[16:19], v44, s[28:31], s58 offen offset:0 sc1
    v_mfma_f32_32x32x16_bf16 v[168:183], a[240:243], a[0:3], v[168:183]
    ds_read_b64 v[20:21], v41 offset:49152
    ds_read_b64 v[22:23], v41 offset:49664
    ds_read_b64 v[12:13], v41 offset:51200
    v_mfma_f32_32x32x16_bf16 v[184:199], a[244:247], a[0:3], v[184:199]
    buffer_load_dwordx4 a[20:23], v44, s[28:31], s58 offen offset:1024 sc1
    ds_read_b64 v[14:15], v41 offset:51712
    ds_read_b64 v[32:33], v41 offset:53248
    v_mfma_f32_32x32x16_bf16 v[168:183], a[248:251], a[4:7], v[168:183]
    ds_read_b64 v[34:35], v41 offset:53760
    v_mfma_f32_32x32x16_bf16 v[184:199], a[252:255], a[4:7], v[184:199]
    s_cmp_le_u32 s101, 2
    s_cselect_b32 s58, s44, s43
    s_add_u32 s58, s58, 118784
    buffer_load_dwordx4 a[24:27], v44, s[28:31], s58 offen offset:0 sc1
    s_waitcnt lgkmcnt(4)
    v_mfma_f32_32x32x16_bf16 v[232:247], v[20:23], v[200:203], 0
    ds_read_b64 v[16:17], v41 offset:55296
    ds_read_b64 v[18:19], v41 offset:55808
    buffer_load_dwordx4 a[28:31], v44, s[28:31], s58 offen offset:1024 sc1
    s_waitcnt lgkmcnt(4)
    v_mfma_f32_32x32x16_bf16 v[232:247], v[12:15], v[204:207], v[232:247]
    ds_read_b64 v[20:21], v41 offset:57344
    ds_read_b64 v[22:23], v41 offset:57856
    ds_write_b128 v3, v[168:171] offset:0
    s_waitcnt lgkmcnt(5)
    v_mfma_f32_32x32x16_bf16 v[232:247], v[32:35], v[208:211], v[232:247]
    ds_read_b64 v[12:13], v41 offset:59392
    ds_read_b64 v[14:15], v41 offset:59904
    s_waitcnt lgkmcnt(5)
    v_mfma_f32_32x32x16_bf16 v[232:247], v[16:19], v[212:215], v[232:247]
    ds_read_b64 v[32:33], v41 offset:12288
    ds_read_b64 v[34:35], v41 offset:12800
    ds_write_b128 v36, v[172:175] offset:0
    s_cmp_le_u32 s101, 3
    s_cselect_b32 s58, s44, s43
    s_add_u32 s58, s58, 120832
    buffer_load_dwordx4 a[32:35], v44, s[28:31], s58 offen offset:0 sc1
    s_waitcnt lgkmcnt(6)
    v_mfma_f32_32x32x16_bf16 v[232:247], v[20:23], v[216:219], v[232:247]
    ds_read_b64 v[16:17], v41 offset:14336
    ds_read_b64 v[18:19], v41 offset:14848
    buffer_load_dwordx4 a[36:39], v44, s[28:31], s58 offen offset:1024 sc1
    s_waitcnt lgkmcnt(5)
    v_mfma_f32_32x32x16_bf16 v[232:247], v[12:15], v[220:223], v[232:247]
    ds_write_b128 v37, v[176:179] offset:0
    s_waitcnt lgkmcnt(4)
    v_mfma_f32_32x32x16_bf16 v[232:247], v[32:35], v[224:227], v[232:247]
    s_cmp_le_u32 s101, 4
    s_cselect_b32 s58, s44, s43
    s_add_u32 s58, s58, 122880
    buffer_load_dwordx4 a[40:43], v44, s[28:31], s58 offen offset:0 sc1
    s_waitcnt lgkmcnt(1)
    v_mfma_f32_32x32x16_bf16 v[232:247], v[16:19], v[228:231], v[232:247]
    ds_write_b128 v49, v[180:183] offset:0
    buffer_load_dwordx4 a[44:47], v44, s[28:31], s58 offen offset:1024 sc1
    v_mfma_f32_32x32x16_bf16 v[200:215], a[240:243], a[112:115], 0
    s_mov_b32 s60, 0xbfb8aa3b
    v_mfma_f32_32x32x16_bf16 v[216:231], a[244:247], a[112:115], 0
    ds_write_b128 v3, v[184:187] offset:128
    v_add_u32 v3, s62, v3
    v_mfma_f32_32x32x16_bf16 v[200:215], a[248:251], a[116:119], v[200:215]
    s_cmp_le_u32 s101, 5
    s_cselect_b32 s58, s44, s43
    s_add_u32 s58, s58, 124928
    buffer_load_dwordx4 a[48:51], v44, s[28:31], s58 offen offset:0 sc1
    v_mfma_f32_32x32x16_bf16 v[216:231], a[252:255], a[116:119], v[216:231]
    ds_write_b128 v36, v[188:191] offset:128
    v_add_u32 v36, s62, v36
    s_waitcnt vmcnt(10)
    v_mfma_f32_32x32x16_bf16 v[200:215], v[72:75], a[8:11], v[200:215]
    buffer_load_dwordx4 a[52:55], v44, s[28:31], s58 offen offset:1024 sc1
    v_mfma_f32_32x32x16_bf16 v[216:231], v[76:79], a[8:11], v[216:231]
    ds_write_b128 v37, v[192:195] offset:128
    v_add_u32 v37, s62, v37
    s_waitcnt vmcnt(10)
    v_mfma_f32_32x32x16_bf16 v[200:215], v[80:83], a[12:15], v[200:215]
    s_cmp_le_u32 s101, 6
    s_cselect_b32 s58, s44, s43
    s_add_u32 s58, s58, 126976
    buffer_load_dwordx4 a[56:59], v44, s[28:31], s58 offen offset:0 sc1
    v_mfma_f32_32x32x16_bf16 v[216:231], v[84:87], a[12:15], v[216:231]
    ds_write_b128 v49, v[196:199] offset:128
    v_add_u32 v49, s62, v49
    s_waitcnt vmcnt(10)
    v_mfma_f32_32x32x16_bf16 v[200:215], v[88:91], a[16:19], v[200:215]
    buffer_load_dwordx4 a[60:63], v44, s[28:31], s58 offen offset:1024 sc1
    v_mfma_f32_32x32x16_bf16 v[216:231], v[92:95], a[16:19], v[216:231]
    ds_write_b128 v3, v[232:235]
    v_add_u32 v3, s48, v3
    s_waitcnt vmcnt(10)
    v_mfma_f32_32x32x16_bf16 v[200:215], v[96:99], a[20:23], v[200:215]
    s_add_u32 s58, s46, 114688
    buffer_load_dwordx4 a[64:67], v44, s[28:31], s58 offen offset:0 sc1
    v_mfma_f32_32x32x16_bf16 v[216:231], v[100:103], a[20:23], v[216:231]
    ds_write_b128 v36, v[236:239]
    v_add_u32 v36, s48, v36
    s_waitcnt vmcnt(10)
    v_mfma_f32_32x32x16_bf16 v[200:215], v[104:107], a[24:27], v[200:215]
    buffer_load_dwordx4 a[68:71], v44, s[28:31], s58 offen offset:1024 sc1
    v_mfma_f32_32x32x16_bf16 v[216:231], v[108:111], a[24:27], v[216:231]
    ds_write_b128 v37, v[240:243]
    v_add_u32 v37, s48, v37
    s_waitcnt vmcnt(10)
    v_mfma_f32_32x32x16_bf16 v[200:215], v[112:115], a[28:31], v[200:215]
    buffer_load_dwordx4 a[72:75], v44, s[28:31], s58 offen offset:2048 sc1
    v_mfma_f32_32x32x16_bf16 v[216:231], v[116:119], a[28:31], v[216:231]
    ds_write_b128 v49, v[244:247]
    v_add_u32 v49, s48, v49
    s_waitcnt vmcnt(10)
    v_mfma_f32_32x32x16_bf16 v[200:215], v[120:123], a[32:35], v[200:215]
    buffer_load_dwordx4 a[76:79], v44, s[28:31], s58 offen offset:3072 sc1
    v_mfma_f32_32x32x16_bf16 v[216:231], v[124:127], a[32:35], v[216:231]
    s_waitcnt vmcnt(10)
    v_mfma_f32_32x32x16_bf16 v[200:215], v[128:131], a[36:39], v[200:215]
    s_add_u32 s58, s46, 118784
    buffer_load_dwordx4 a[80:83], v44, s[28:31], s58 offen offset:0 sc1
    v_mfma_f32_32x32x16_bf16 v[216:231], v[132:135], a[36:39], v[216:231]
    s_waitcnt vmcnt(10)
    v_mfma_f32_32x32x16_bf16 v[200:215], v[136:139], a[40:43], v[200:215]
    buffer_load_dwordx4 a[84:87], v44, s[28:31], s58 offen offset:1024 sc1
    v_mfma_f32_32x32x16_bf16 v[216:231], v[140:143], a[40:43], v[216:231]
    s_waitcnt lgkmcnt(0)
    s_barrier
    buffer_load_dwordx4 a[88:91], v44, s[28:31], s58 offen offset:2048 sc1
    ds_read_b128 v[168:171], v50 offset:0
    s_waitcnt vmcnt(11)
    v_mfma_f32_32x32x16_bf16 v[200:215], v[144:147], a[44:47], v[200:215]
    ds_read_b128 v[172:175], v51 offset:0
    ds_read_b128 v[176:179], v50 offset:8192
    ds_read_b128 v[180:183], v51 offset:8192
    v_mfma_f32_32x32x16_bf16 v[216:231], v[148:151], a[44:47], v[216:231]
    buffer_load_dwordx4 a[92:95], v44, s[28:31], s58 offen offset:3072 sc1
    ds_read_b128 v[184:187], v50 offset:16384
    ds_read_b128 v[188:191], v51 offset:16384
    s_waitcnt vmcnt(11)
    v_mfma_f32_32x32x16_bf16 v[200:215], v[152:155], a[48:51], v[200:215]
    ds_read_b128 v[192:195], v50 offset:24576
    ds_read_b128 v[196:199], v51 offset:24576
    ds_read_b128 v[12:15], v50 offset:32768
    v_mfma_f32_32x32x16_bf16 v[216:231], v[156:159], a[48:51], v[216:231]
    s_add_u32 s58, s46, 122880
    buffer_load_dwordx4 a[96:99], v44, s[28:31], s58 offen offset:0 sc1
    ds_read_b128 v[16:19], v51 offset:32768
    v_lshlrev_b32 v4, 16, v52
    s_waitcnt vmcnt(11)
    v_mfma_f32_32x32x16_bf16 v[200:215], v[160:163], a[52:55], v[200:215]
    v_and_b32 v5, 0xffff0000, v52
    v_lshlrev_b32_e64 v6, 16, v53
    v_and_b32 v7, 0xffff0000, v53
    v_lshlrev_b32_e64 v8, 16, v54
    v_and_b32 v9, 0xffff0000, v54
    v_lshlrev_b32_e64 v10, 16, v55
    v_mfma_f32_32x32x16_bf16 v[216:231], v[164:167], a[52:55], v[216:231]
    buffer_load_dwordx4 a[100:103], v44, s[28:31], s58 offen offset:1024 sc1
    v_and_b32 v11, 0xffff0000, v55
    v_lshlrev_b32_e64 v232, 16, v60
    v_and_b32 v233, 0xffff0000, v60
    v_lshlrev_b32 v234, 16, v61
    s_waitcnt vmcnt(11)
    v_mfma_f32_32x32x16_bf16 v[200:215], a[128:131], a[56:59], v[200:215]
    v_and_b32 v235, 0xffff0000, v61
    v_lshlrev_b32_e64 v236, 16, v62
    v_and_b32 v237, 0xffff0000, v62
    v_lshlrev_b32_e64 v238, 16, v63
    v_and_b32 v239, 0xffff0000, v63
    v_mfma_f32_32x32x16_bf16 v[216:231], a[132:135], a[56:59], v[216:231]
    buffer_load_dwordx4 a[104:107], v44, s[28:31], s58 offen offset:2048 sc1
    s_waitcnt lgkmcnt(9)
    v_add_f32 v4, v4, v168
    v_add_f32 v5, v5, v169
    v_add_f32 v6, v6, v170
    v_add_f32 v7, v7, v171
    s_waitcnt vmcnt(11)
    v_mfma_f32_32x32x16_bf16 v[200:215], a[136:139], a[60:63], v[200:215]
    s_waitcnt lgkmcnt(8)
    v_add_f32 v8, v8, v172
    v_add_f32 v9, v9, v173
    v_add_f32 v10, v10, v174
    v_add_f32 v11, v11, v175
    s_waitcnt lgkmcnt(7)
    v_add_f32 v4, v4, v176
    v_add_f32 v5, v5, v177
    v_mfma_f32_32x32x16_bf16 v[216:231], a[140:143], a[60:63], v[216:231]
    buffer_load_dwordx4 a[108:111], v44, s[28:31], s58 offen offset:3072 sc1
    v_add_f32 v6, v6, v178
    v_add_f32 v7, v7, v179
    s_waitcnt lgkmcnt(6)
    v_add_f32 v8, v8, v180
    v_add_f32 v9, v9, v181
    s_waitcnt vmcnt(11)
    v_mfma_f32_32x32x16_bf16 v[200:215], a[144:147], a[64:67], v[200:215]
    v_add_f32 v10, v10, v182
    v_add_f32 v11, v11, v183
    s_waitcnt lgkmcnt(5)
    v_add_f32 v4, v4, v184
    v_add_f32 v5, v5, v185
    v_add_f32 v6, v6, v186
    v_add_f32_e64 v7, v7, v187
    v_mfma_f32_32x32x16_bf16 v[216:231], a[148:151], a[64:67], v[216:231]
    s_waitcnt lgkmcnt(4)
    v_add_f32 v8, v8, v188
    v_add_f32 v9, v9, v189
    v_add_f32 v10, v10, v190
    v_add_f32 v11, v11, v191
    s_waitcnt lgkmcnt(3)
    v_add_f32_e64 v4, v4, v192
    v_add_f32 v5, v5, v193
    s_waitcnt vmcnt(10)
    v_mfma_f32_32x32x16_bf16 v[200:215], a[152:155], a[68:71], v[200:215]
    v_add_f32 v6, v6, v194
    v_add_f32 v7, v7, v195
    s_waitcnt lgkmcnt(2)
    v_add_f32 v8, v8, v196
    v_add_f32 v9, v9, v197
    v_add_f32 v10, v10, v198
    v_add_f32_e64 v11, v11, v199
    v_mfma_f32_32x32x16_bf16 v[216:231], a[156:159], a[68:71], v[216:231]
    v_mul_f32 v168, s60, v4
    v_mul_f32 v169, s60, v5
    v_mul_f32 v170, s60, v6
    v_mul_f32 v171, s60, v7
    v_mul_f32_e64 v172, s60, v8
    v_mul_f32 v173, s60, v9
    s_waitcnt vmcnt(9)
    v_mfma_f32_32x32x16_bf16 v[200:215], a[160:163], a[72:75], v[200:215]
    v_mul_f32 v174, s60, v10
    v_mul_f32 v175, s60, v11
    v_exp_f32 v168, v168
    v_exp_f32 v169, v169
    v_mfma_f32_32x32x16_bf16 v[216:231], a[164:167], a[72:75], v[216:231]
    v_exp_f32 v170, v170
    v_exp_f32 v171, v171
    v_exp_f32 v172, v172
    s_waitcnt vmcnt(8)
    v_mfma_f32_32x32x16_bf16 v[200:215], a[168:171], a[76:79], v[200:215]
    v_exp_f32 v173, v173
    v_exp_f32 v174, v174
    v_exp_f32_e64 v175, v175
    v_mfma_f32_32x32x16_bf16 v[216:231], a[172:175], a[76:79], v[216:231]
    s_waitcnt lgkmcnt(1)
    v_mul_f32 v4, v4, v12
    v_mul_f32 v5, v5, v13
    v_mul_f32 v6, v6, v14
    v_mul_f32 v7, v7, v15
    s_waitcnt lgkmcnt(0)
    v_mul_f32_e64 v8, v8, v16
    v_mul_f32 v9, v9, v17
    s_waitcnt vmcnt(7)
    v_mfma_f32_32x32x16_bf16 v[200:215], a[176:179], a[80:83], v[200:215]
    v_mul_f32 v10, v10, v18
    v_mul_f32 v11, v11, v19
    v_add_f32 v168, 1.0, v168
    v_add_f32 v169, 1.0, v169
    v_add_f32 v170, 1.0, v170
    v_add_f32 v171, 1.0, v171
    v_mfma_f32_32x32x16_bf16 v[216:231], a[180:183], a[80:83], v[216:231]
    v_add_f32 v172, 1.0, v172
    v_add_f32 v173, 1.0, v173
    v_add_f32 v174, 1.0, v174
    v_add_f32 v175, 1.0, v175
    v_rcp_f32 v168, v168
    s_waitcnt vmcnt(6)
    v_mfma_f32_32x32x16_bf16 v[200:215], a[184:187], a[84:87], v[200:215]
    v_rcp_f32 v169, v169
    v_rcp_f32 v170, v170
    v_rcp_f32 v171, v171
    s_waitcnt vmcnt(5)
    v_mfma_f32_32x32x16_bf16 v[200:215], a[192:195], a[88:91], v[200:215]
    v_rcp_f32 v172, v172
    v_rcp_f32 v173, v173
    v_rcp_f32 v174, v174
    s_waitcnt vmcnt(4)
    v_mfma_f32_32x32x16_bf16 v[200:215], a[200:203], a[92:95], v[200:215]
    v_rcp_f32_e64 v175, v175
    v_fma_f32 v4, v4, v168, v232
    v_fma_f32 v5, v5, v169, v233
    v_fma_f32 v6, v6, v170, v234
    v_fma_f32 v7, v7, v171, v235
    s_waitcnt vmcnt(3)
    v_mfma_f32_32x32x16_bf16 v[200:215], a[208:211], a[96:99], v[200:215]
    v_fma_f32 v8, v8, v172, v236
    v_fma_f32 v9, v9, v173, v237
    v_fma_f32 v10, v10, v174, v238
    v_fma_f32 v11, v11, v175, v239
    v_cvt_pk_bf16_f32 v184, v4, v5
    v_cvt_pk_bf16_f32 v185, v6, v7
    s_waitcnt vmcnt(2)
    v_mfma_f32_32x32x16_bf16 v[200:215], a[216:219], a[100:103], v[200:215]
    v_cvt_pk_bf16_f32 v186, v8, v9
    v_cvt_pk_bf16_f32 v187, v10, v11
    buffer_store_dwordx4 v[184:187], v1, s[24:27], s54 offen sc1
    s_waitcnt vmcnt(2)
    v_mfma_f32_32x32x16_bf16 v[200:215], a[224:227], a[104:107], v[200:215]
    ds_read_b128 v[12:15], v50 offset:40960
    ds_read_b128 v[16:19], v51 offset:40960
    v_lshlrev_b32 v4, 16, v56
    v_and_b32 v5, 0xffff0000, v56
    v_lshlrev_b32 v6, 16, v57
    s_waitcnt vmcnt(1)
    v_mfma_f32_32x32x16_bf16 v[200:215], a[232:235], a[108:111], v[200:215]
    v_and_b32 v7, 0xffff0000, v57
    v_lshlrev_b32_e64 v8, 16, v58
    v_and_b32 v9, 0xffff0000, v58
    v_lshlrev_b32_e64 v10, 16, v59
    v_and_b32 v11, 0xffff0000, v59
    v_lshlrev_b32_e64 v232, 16, v64
    v_mfma_f32_32x32x16_bf16 v[216:231], a[188:191], a[84:87], v[216:231]
    v_and_b32 v233, 0xffff0000, v64
    v_lshlrev_b32_e64 v234, 16, v65
    v_and_b32 v235, 0xffff0000, v65
    v_lshlrev_b32_e64 v236, 16, v66
    v_and_b32 v237, 0xffff0000, v66
    v_lshlrev_b32_e64 v238, 16, v67
    v_mfma_f32_32x32x16_bf16 v[216:231], a[196:199], a[88:91], v[216:231]
    v_and_b32 v239, 0xffff0000, v67
    v_add_u32 v50, 65536, v50
    v_add_u32 v51, 65536, v51
    v_mfma_f32_32x32x16_bf16 v[216:231], a[204:207], a[92:95], v[216:231]
    ds_write_b128 v3, v[200:203] offset:0
    v_mfma_f32_32x32x16_bf16 v[216:231], a[212:215], a[96:99], v[216:231]
    ds_write_b128 v36, v[204:207] offset:0
    v_mfma_f32_32x32x16_bf16 v[216:231], a[220:223], a[100:103], v[216:231]
    ds_write_b128 v37, v[208:211] offset:0
    v_mfma_f32_32x32x16_bf16 v[216:231], a[228:231], a[104:107], v[216:231]
    ds_write_b128 v49, v[212:215] offset:0
    v_mfma_f32_32x32x16_bf16 v[216:231], a[236:239], a[108:111], v[216:231]
    s_nop 11
    ds_write_b128 v3, v[216:219] offset:128
    ds_write_b128 v36, v[220:223] offset:128
    ds_write_b128 v37, v[224:227] offset:128
    ds_write_b128 v49, v[228:231] offset:128
    s_waitcnt lgkmcnt(0)
    s_barrier
    ds_read_b128 v[200:203], v50 offset:0
    ds_read_b128 v[204:207], v51 offset:0
    ds_read_b128 v[208:211], v50 offset:8192
    ds_read_b128 v[212:215], v51 offset:8192
    ds_read_b128 v[216:219], v50 offset:16384
    ds_read_b128 v[220:223], v51 offset:16384
    ds_read_b128 v[224:227], v50 offset:24576
    ds_read_b128 v[228:231], v51 offset:24576
    s_waitcnt lgkmcnt(7)
    v_pk_add_f32 v[4:5], v[4:5], v[200:201]
    v_pk_add_f32 v[6:7], v[6:7], v[202:203]
    s_waitcnt lgkmcnt(6)
    v_pk_add_f32 v[8:9], v[8:9], v[204:205]
    v_pk_add_f32 v[10:11], v[10:11], v[206:207]
    s_waitcnt lgkmcnt(5)
    v_pk_add_f32 v[4:5], v[4:5], v[208:209]
    v_pk_add_f32 v[6:7], v[6:7], v[210:211]
    s_waitcnt lgkmcnt(4)
    v_pk_add_f32 v[8:9], v[8:9], v[212:213]
    v_pk_add_f32 v[10:11], v[10:11], v[214:215]
    s_waitcnt lgkmcnt(3)
    v_pk_add_f32 v[4:5], v[4:5], v[216:217]
    v_pk_add_f32 v[6:7], v[6:7], v[218:219]
    s_waitcnt lgkmcnt(2)
    v_pk_add_f32 v[8:9], v[8:9], v[220:221]
    v_pk_add_f32 v[10:11], v[10:11], v[222:223]
    s_waitcnt lgkmcnt(1)
    v_pk_add_f32 v[4:5], v[4:5], v[224:225]
    v_pk_add_f32 v[6:7], v[6:7], v[226:227]
    s_waitcnt lgkmcnt(0)
    v_pk_add_f32 v[8:9], v[8:9], v[228:229]
    v_pk_add_f32 v[10:11], v[10:11], v[230:231]
    v_pk_mul_f32 v[200:201], v[4:5], s[60:61] op_sel_hi:[1,0]
    v_pk_mul_f32 v[202:203], v[6:7], s[60:61] op_sel_hi:[1,0]
    v_pk_mul_f32 v[204:205], v[8:9], s[60:61] op_sel_hi:[1,0]
    v_pk_mul_f32 v[206:207], v[10:11], s[60:61] op_sel_hi:[1,0]
    v_exp_f32 v200, v200
    v_exp_f32 v201, v201
    v_exp_f32 v202, v202
    v_exp_f32 v203, v203
    v_exp_f32 v204, v204
    v_exp_f32 v205, v205
    v_exp_f32 v206, v206
    v_exp_f32_e64 v207, v207
    v_pk_mul_f32 v[4:5], v[4:5], v[12:13]
    v_pk_mul_f32 v[6:7], v[6:7], v[14:15]
    v_pk_mul_f32 v[8:9], v[8:9], v[16:17]
    v_pk_mul_f32 v[10:11], v[10:11], v[18:19]
    v_pk_add_f32 v[200:201], v[200:201], 1.0 op_sel_hi:[1,0]
    v_pk_add_f32 v[202:203], v[202:203], 1.0 op_sel_hi:[1,0]
    v_pk_add_f32 v[204:205], v[204:205], 1.0 op_sel_hi:[1,0]
    v_pk_add_f32 v[206:207], v[206:207], 1.0 op_sel_hi:[1,0]
    v_rcp_f32 v200, v200
    v_rcp_f32 v201, v201
    v_rcp_f32 v202, v202
    v_rcp_f32 v203, v203
    v_rcp_f32 v204, v204
    v_rcp_f32 v205, v205
    v_rcp_f32 v206, v206
    v_rcp_f32 v207, v207
    v_pk_fma_f32 v[4:5], v[4:5], v[200:201], v[232:233]
    v_pk_fma_f32 v[6:7], v[6:7], v[202:203], v[234:235]
    v_pk_fma_f32 v[8:9], v[8:9], v[204:205], v[236:237]
    v_pk_fma_f32 v[10:11], v[10:11], v[206:207], v[238:239]
    v_cvt_pk_bf16_f32 v216, v4, v5
    v_cvt_pk_bf16_f32 v217, v6, v7
    v_cvt_pk_bf16_f32 v218, v8, v9
    v_cvt_pk_bf16_f32 v219, v10, v11
    buffer_store_dwordx4 v[216:219], v1, s[24:27], s59 offen sc1
    s_endpgm
Linit1:
v_mov_b32 v12, 0
v_mov_b32 v13, 0
v_mov_b32 v14, 0
    v_mov_b32_e64 v15, 0
s_mov_b32 s30, 33554432
s_mov_b32 s31, 0x20000
v_lshlrev_b32 v41, 4, v0
v_lshlrev_b32 v42, 4, v46
s_lshl_b32 s41, s2, 12
s_lshl_b32 s42, s2, 7
s_add_u32 s42, s42, 32768
buffer_store_dwordx4 v[12:15], v41, s[28:31], s41 offen offset:0 sc1
buffer_store_dwordx4 v[12:15], v41, s[28:31], s41 offen offset:1024 sc1
buffer_store_dwordx4 v[12:15], v41, s[28:31], s41 offen offset:2048 sc1
buffer_store_dwordx4 v[12:15], v41, s[28:31], s41 offen offset:3072 sc1
buffer_store_dwordx4 v[12:15], v42, s[28:31], s42 offen sc1
s_branch Lnoinit
Linit2:
s_mov_b32 s34, 256
s_mov_b32 s35, 0x20000
v_lshlrev_b32 v12, 8, v0
    v_mov_b32_e64 v13, 1
buffer_store_dword v13, v12, s[32:35], s39 offen sc1
s_branch Lnoinit2
Lfin:
s_endpgm

.section .rodata,"a"
.p2align 6
.amdhsa_kernel recurrent_scan__spectral_fnet__mixer_s_mlp__prompt_kernel
  .amdhsa_next_free_vgpr 512
  .amdhsa_next_free_sgpr 102
  .amdhsa_accum_offset 256
  .amdhsa_group_segment_fixed_size 0
  .amdhsa_kernarg_size 104
  .amdhsa_user_sgpr_count 2
  .amdhsa_user_sgpr_kernarg_segment_ptr 1
  .amdhsa_system_sgpr_workgroup_id_x 1
  .amdhsa_float_denorm_mode_32 3
.end_amdhsa_kernel
```
